```python
import torch

def _softmax(x, axis=-1):
    return torch.softmax(x, dim=axis)
def _gelu(x):
    return torch.nn.functional.gelu(x, approximate="tanh")
def _silu(x):
    return torch.nn.functional.silu(x)
def _sigmoid(x):
    return torch.sigmoid(x)
def _layernorm(x, axis=-1, eps=1e-5):
    m = x.mean(dim=axis, keepdim=True)
    v = x.var(dim=axis, keepdim=True, unbiased=False)
    return (x - m) / torch.sqrt(v + eps)
def _scatter_add(tgt, idx, src, axis=0):
    return tgt.clone().index_add_(axis, idx, src)
def _segment_sum(src, seg, n):
    out = torch.zeros((n,) + src.shape[1:], dtype=src.dtype)
    return out.index_add_(0, seg, src)
def _pad(x, pw):
    flat = tuple(v for pair in reversed(pw) for v in pair)
    return torch.nn.functional.pad(x, flat)

kernel_name = 'interleave_layers__sliding_block__glu_gated_bilinear__prompt'

def setup_inputs():

    _w = (lambda a: (lambda t: t.to(torch.bfloat16) if t.is_floating_point() else t)(torch.as_tensor(a)))
    def _A_setup():
        B, S, D = 1, 2048, 640
        return {
            "x": _w((lambda *s: torch.randn(*s, dtype=torch.bfloat16) * 0.05)(B, S, D)),
            "wqkv": _w((lambda *s: torch.randn(*s, dtype=torch.bfloat16) * 0.05)(D, 3 * D)),
            "wo": _w((lambda *s: torch.randn(*s, dtype=torch.bfloat16) * 0.05)(D, D)),
        }
    _A_in = _A_setup()

    def _B_setup():
        B, S, D, F = 1, 2048, 640, 1536
        return {
            "x": _w((lambda *s: torch.randn(*s, dtype=torch.bfloat16) * 0.05)(B, S, D)),
            "w_gate": _w((lambda *s: torch.randn(*s, dtype=torch.bfloat16) * 0.8)(D, F) * (D ** -0.5)),
            "w_up": _w((lambda *s: torch.randn(*s, dtype=torch.bfloat16) * 0.8)(D, F) * (D ** -0.5)),
            "w_down": _w((lambda *s: torch.randn(*s, dtype=torch.bfloat16) * 0.8)(F, D) * (F ** -0.5)),
        }
    _B_in = _B_setup()

    return {
        "A_x": _A_in["x"],
        "A_wqkv": _A_in["wqkv"],
        "A_wo": _A_in["wo"],
        "B_x": _B_in["x"],
        "B_w_gate": _B_in["w_gate"],
        "B_w_up": _B_in["w_up"],
        "B_w_down": _B_in["w_down"],
    }

def reference(A_x, A_wqkv, A_wo, B_x, B_w_gate, B_w_up, B_w_down):
    def _A_ref(x, wqkv, wo):
        B, S, D = x.shape
        H = 32; Dh = D // H; W = 256
        qkv = (lambda x, *d: x.permute(*d))((x @ wqkv).reshape(B, S, 3, H, Dh), 2, 0, 3, 1, 4)
        q, k, v = qkv[0], qkv[1], qkv[2]
        scores = torch.einsum("bhqd,bhkd->bhqk", q, k) * (Dh ** -0.5)
        idx = torch.arange(S)
        mask = (idx[:, None] - idx[None, :] >= 0) & (idx[:, None] - idx[None, :] < W)
        scores = torch.where(mask[None, None], scores, -1e9)
        p = _softmax(scores, axis=-1)
        o = torch.einsum("bhqk,bhkd->bhqd", p, v)
        return (lambda x, *d: x.permute(*d))(o, 0, 2, 1, 3).reshape(B, S, D) @ wo

    def _B_ref(x, w_gate, w_up, w_down):
        g = torch.einsum("bsd,df->bsf", x, w_gate)
        u = torch.einsum("bsd,df->bsf", x, w_up)
        h = g * u
        return torch.einsum("bsf,fd->bsd", h, w_down)

    x = A_x
    x = x + _A_ref(_layernorm(x, axis=-1), A_wqkv, A_wo)
    x = x + _B_ref(_layernorm(x, axis=-1), B_w_gate, B_w_up, B_w_down)
    x = x + _A_ref(_layernorm(x, axis=-1), A_wqkv, A_wo)
    x = x + _B_ref(_layernorm(x, axis=-1), B_w_gate, B_w_up, B_w_down)
    return x
```

```asm
; @launch kernel=prep_kernel grid=(698,1,1) block=(256,1,1) lds=24576
; @launch kernel=main_kernel grid=(256,1,1) block=(512,1,1) lds=163840
.amdgcn_target "amdgcn-amd-amdhsa--gfx950"
.text
.globl prep_kernel
.p2align 8
.type prep_kernel,@function
prep_kernel:
  s_cmp_ge_u32 s2, 698
  s_cbranch_scc1 LP_done
  s_load_dwordx4 s[40:43], s[0:1], 0
  s_load_dwordx2 s[76:77], s[0:1], 16
  s_load_dwordx4 s[68:71], s[0:1], 32
  s_load_dwordx2 s[82:83], s[0:1], 48
  s_load_dwordx2 s[36:37], s[0:1], 72
  v_mov_b32 v50, v0
  v_lshrrev_b32 v1, 6, v0
  s_nop 0
  v_readfirstlane_b32 s3, v1
  v_and_b32 v0, 63, v0
  v_lshlrev_b32 v1, 4, v0
  v_and_b32 v2, 15, v0
  v_lshrrev_b32 v3, 4, v0
  s_waitcnt lgkmcnt(0)
  s_mov_b32 s16, s36
  s_mov_b32 s17, s37
  s_mov_b32 s18, 268435456
  s_mov_b32 s19, 0x20000
  s_mov_b32 s78, s68
  s_mov_b32 s79, s69
  s_mov_b32 s80, s70
  s_mov_b32 s81, s71
  s_cmp_ge_u32 s2, 570
  s_cbranch_scc1 LP_rowstat
  s_cmp_ge_u32 s2, 410
  s_cbranch_scc1 LP_wq
  s_cmp_lt_u32 s2, 96
  s_cbranch_scc0 LP_noz
  s_cmp_eq_u32 s3, 0
  s_cbranch_scc0 LP_noz
  s_lshl_b32 s20, s2, 10
  v_mov_b32 v4, 0
  v_mov_b32 v5, 0
  v_mov_b32 v6, 0
  v_mov_b32 v7, 0
  buffer_store_dwordx4 v[4:7], v1, s[16:19], s20 offen
  LP_noz:
  s_lshl_b32 s73, s2, 2
  s_add_u32 s73, s73, s3
  s_mul_i32 s60, s3, 6144
  v_bfe_u32 v4, v0, 2, 2
  v_lshl_add_u32 v4, v3, 3, v4
  v_lshlrev_b32 v4, 7, v4
  v_and_b32 v5, 3, v0
  v_lshl_add_u32 v20, v5, 3, v4

  s_mov_b32 s87, 0x20000
  s_cmp_lt_u32 s73, 480
  s_cbranch_scc1 Ug_1
  s_cmp_lt_u32 s73, 960
  s_cbranch_scc1 Uu_2
  s_cmp_lt_u32 s73, 1440
  s_cbranch_scc1 Ud_3
  s_sub_u32 s98, s73, 1440
  s_mov_b32 s84, s76
  s_mov_b32 s85, s77
  s_mov_b32 s86, 819200
  s_mov_b32 s95, 1
  s_mov_b32 s96, 393216
  s_mov_b32 s97, 102400
  s_branch U5_4
  Ud_3:
  s_sub_u32 s98, s73, 960
  s_mov_b32 s84, s82
  s_mov_b32 s85, s83
  s_mov_b32 s86, 1966080
  s_mov_b32 s95, 0
  s_mov_b32 s96, 5144576
  s_mov_b32 s97, 245760
  U5_4:
  s_mul_i32 s92, s98, 6554
  s_lshr_b32 s92, s92, 16
  s_mul_i32 s99, s92, 10
  s_sub_u32 s93, s98, s99
  s_movk_i32 s94, 1280
  s_mov_b32 s74, -1
  s_mul_i32 s99, s92, 5120
  s_add_u32 s96, s96, s99

  s_lshl_b32 s98, s93, 2
  s_add_u32 s98, s98, 0
  s_mul_i32 s99, s98, 13108
  s_lshr_b32 s99, s99, 16
  s_mul_i32 s88, s99, s97
  s_mul_i32 s99, s99, 5
  s_sub_u32 s98, s98, s99
  s_lshl_b32 s98, s98, 10
  s_add_u32 s88, s88, s98
  s_add_u32 s88, s88, s96

  s_lshl_b32 s98, s93, 2
  s_add_u32 s98, s98, 1
  s_mul_i32 s99, s98, 13108
  s_lshr_b32 s99, s99, 16
  s_mul_i32 s89, s99, s97
  s_mul_i32 s99, s99, 5
  s_sub_u32 s98, s98, s99
  s_lshl_b32 s98, s98, 10
  s_add_u32 s89, s89, s98
  s_add_u32 s89, s89, s96

  s_lshl_b32 s98, s93, 2
  s_add_u32 s98, s98, 2
  s_mul_i32 s99, s98, 13108
  s_lshr_b32 s99, s99, 16
  s_mul_i32 s90, s99, s97
  s_mul_i32 s99, s99, 5
  s_sub_u32 s98, s98, s99
  s_lshl_b32 s98, s98, 10
  s_add_u32 s90, s90, s98
  s_add_u32 s90, s90, s96

  s_lshl_b32 s98, s93, 2
  s_add_u32 s98, s98, 3
  s_mul_i32 s99, s98, 13108
  s_lshr_b32 s99, s99, 16
  s_mul_i32 s91, s99, s97
  s_mul_i32 s99, s99, 5
  s_sub_u32 s98, s98, s99
  s_lshl_b32 s98, s98, 10
  s_add_u32 s91, s91, s98
  s_add_u32 s91, s91, s96

  s_branch Uld_6
  Ug_1:
  s_mov_b32 s98, s73
  s_mov_b32 s84, s78
  s_mov_b32 s85, s79
  s_mov_b32 s97, 0
  s_branch Ugu_5
  Uu_2:
  s_sub_u32 s98, s73, 480
  s_mov_b32 s84, s80
  s_mov_b32 s85, s81
  s_mov_b32 s97, 1
  Ugu_5:
  s_mov_b32 s86, 1966080
  s_movk_i32 s94, 3072
  s_mov_b32 s95, 0
  s_mul_i32 s92, s98, 2731
  s_lshr_b32 s92, s92, 16
  s_mul_i32 s99, s92, 24
  s_sub_u32 s93, s98, s99
  s_lshl_b32 s99, s92, 1
  s_add_u32 s99, s99, s97
  s_mul_i32 s74, s99, 6144
  s_lshl_b32 s99, s93, 8
  s_add_u32 s74, s74, s99
  s_add_u32 s74, s74, 10485760
  s_mul_i32 s96, s92, 12288
  s_mul_i32 s99, s97, 6144
  s_add_u32 s96, s96, s99
  s_add_u32 s96, s96, 1212416

  s_lshl_b32 s98, s93, 2
  s_add_u32 s98, s98, 0
  s_mul_i32 s99, s98, 10923
  s_lshr_b32 s99, s99, 16
  s_mul_i32 s88, s99, 245760
  s_mul_i32 s99, s99, 6
  s_sub_u32 s98, s98, s99
  s_lshl_b32 s98, s98, 10
  s_add_u32 s88, s88, s98
  s_add_u32 s88, s88, s96

  s_lshl_b32 s98, s93, 2
  s_add_u32 s98, s98, 1
  s_mul_i32 s99, s98, 10923
  s_lshr_b32 s99, s99, 16
  s_mul_i32 s89, s99, 245760
  s_mul_i32 s99, s99, 6
  s_sub_u32 s98, s98, s99
  s_lshl_b32 s98, s98, 10
  s_add_u32 s89, s89, s98
  s_add_u32 s89, s89, s96

  s_lshl_b32 s98, s93, 2
  s_add_u32 s98, s98, 2
  s_mul_i32 s99, s98, 10923
  s_lshr_b32 s99, s99, 16
  s_mul_i32 s90, s99, 245760
  s_mul_i32 s99, s99, 6
  s_sub_u32 s98, s98, s99
  s_lshl_b32 s98, s98, 10
  s_add_u32 s90, s90, s98
  s_add_u32 s90, s90, s96

  s_lshl_b32 s98, s93, 2
  s_add_u32 s98, s98, 3
  s_mul_i32 s99, s98, 10923
  s_lshr_b32 s99, s99, 16
  s_mul_i32 s91, s99, 245760
  s_mul_i32 s99, s99, 6
  s_sub_u32 s98, s98, s99
  s_lshl_b32 s98, s98, 10
  s_add_u32 s91, s91, s98
  s_add_u32 s91, s91, s96

Uld_6:
  v_lshrrev_b32 v4, 3, v0
  s_lshl_b32 s98, s92, 5
  s_add_u32 s98, s98, 0
  v_add_u32 v4, s98, v4
  s_cmp_eq_u32 s95, 1
  s_cbranch_scc0 Unp_8
  s_movk_i32 s98, 1639
  v_mul_u32_u24 v5, s98, v4
  v_lshrrev_b32 v5, 16, v5
  v_mul_u32_u24 v5, 40, v5
  v_sub_u32 v6, v4, v5
  v_mov_b32 v4, v6
  v_add_u32 v7, 4, v6
  v_cmp_le_u32 vcc, 16, v6
  s_nop 1
  v_cndmask_b32 v4, v4, v7, vcc
  v_subrev_u32 v7, 16, v6
  v_cmp_le_u32 vcc, 32, v6
  s_nop 1
  v_cndmask_b32 v4, v4, v7, vcc
  v_cmp_le_u32 vcc, 36, v6
  s_nop 1
  v_cndmask_b32 v4, v4, v6, vcc
  v_add_u32 v4, v5, v4
  Unp_8:
  v_mul_lo_u32 v4, v4, s94
  v_and_b32 v5, 7, v0
  v_lshl_add_u32 v8, v5, 4, v4
  s_lshl_b32 s98, s93, 7
  s_add_u32 m0, s60, 0
  s_nop 0
  buffer_load_dwordx4 v8, s[84:87], s98 offen lds

  v_lshrrev_b32 v4, 3, v0
  s_lshl_b32 s98, s92, 5
  s_add_u32 s98, s98, 8
  v_add_u32 v4, s98, v4
  s_cmp_eq_u32 s95, 1
  s_cbranch_scc0 Unp_9
  s_movk_i32 s98, 1639
  v_mul_u32_u24 v5, s98, v4
  v_lshrrev_b32 v5, 16, v5
  v_mul_u32_u24 v5, 40, v5
  v_sub_u32 v6, v4, v5
  v_mov_b32 v4, v6
  v_add_u32 v7, 4, v6
  v_cmp_le_u32 vcc, 16, v6
  s_nop 1
  v_cndmask_b32 v4, v4, v7, vcc
  v_subrev_u32 v7, 16, v6
  v_cmp_le_u32 vcc, 32, v6
  s_nop 1
  v_cndmask_b32 v4, v4, v7, vcc
  v_cmp_le_u32 vcc, 36, v6
  s_nop 1
  v_cndmask_b32 v4, v4, v6, vcc
  v_add_u32 v4, v5, v4
  Unp_9:
  v_mul_lo_u32 v4, v4, s94
  v_and_b32 v5, 7, v0
  v_lshl_add_u32 v9, v5, 4, v4
  s_lshl_b32 s98, s93, 7
  s_add_u32 m0, s60, 1024
  s_nop 0
  buffer_load_dwordx4 v9, s[84:87], s98 offen lds

  v_lshrrev_b32 v4, 3, v0
  s_lshl_b32 s98, s92, 5
  s_add_u32 s98, s98, 16
  v_add_u32 v4, s98, v4
  s_cmp_eq_u32 s95, 1
  s_cbranch_scc0 Unp_10
  s_movk_i32 s98, 1639
  v_mul_u32_u24 v5, s98, v4
  v_lshrrev_b32 v5, 16, v5
  v_mul_u32_u24 v5, 40, v5
  v_sub_u32 v6, v4, v5
  v_mov_b32 v4, v6
  v_add_u32 v7, 4, v6
  v_cmp_le_u32 vcc, 16, v6
  s_nop 1
  v_cndmask_b32 v4, v4, v7, vcc
  v_subrev_u32 v7, 16, v6
  v_cmp_le_u32 vcc, 32, v6
  s_nop 1
  v_cndmask_b32 v4, v4, v7, vcc
  v_cmp_le_u32 vcc, 36, v6
  s_nop 1
  v_cndmask_b32 v4, v4, v6, vcc
  v_add_u32 v4, v5, v4
  Unp_10:
  v_mul_lo_u32 v4, v4, s94
  v_and_b32 v5, 7, v0
  v_lshl_add_u32 v10, v5, 4, v4
  s_lshl_b32 s98, s93, 7
  s_add_u32 m0, s60, 2048
  s_nop 0
  buffer_load_dwordx4 v10, s[84:87], s98 offen lds

  v_lshrrev_b32 v4, 3, v0
  s_lshl_b32 s98, s92, 5
  s_add_u32 s98, s98, 24
  v_add_u32 v4, s98, v4
  s_cmp_eq_u32 s95, 1
  s_cbranch_scc0 Unp_11
  s_movk_i32 s98, 1639
  v_mul_u32_u24 v5, s98, v4
  v_lshrrev_b32 v5, 16, v5
  v_mul_u32_u24 v5, 40, v5
  v_sub_u32 v6, v4, v5
  v_mov_b32 v4, v6
  v_add_u32 v7, 4, v6
  v_cmp_le_u32 vcc, 16, v6
  s_nop 1
  v_cndmask_b32 v4, v4, v7, vcc
  v_subrev_u32 v7, 16, v6
  v_cmp_le_u32 vcc, 32, v6
  s_nop 1
  v_cndmask_b32 v4, v4, v7, vcc
  v_cmp_le_u32 vcc, 36, v6
  s_nop 1
  v_cndmask_b32 v4, v4, v6, vcc
  v_add_u32 v4, v5, v4
  Unp_11:
  v_mul_lo_u32 v4, v4, s94
  v_and_b32 v5, 7, v0
  v_lshl_add_u32 v11, v5, 4, v4
  s_lshl_b32 s98, s93, 7
  s_add_u32 m0, s60, 3072
  s_nop 0
  buffer_load_dwordx4 v11, s[84:87], s98 offen lds

  s_waitcnt vmcnt(0)
  s_add_u32 s35, s60, 0
  v_add_u32 v4, s35, v20
  ds_read_b64_tr_b16 v[24:25], v4 offset:0
  ds_read_b64_tr_b16 v[26:27], v4 offset:512
  ds_read_b64_tr_b16 v[28:29], v4 offset:32
  ds_read_b64_tr_b16 v[30:31], v4 offset:544
  ds_read_b64_tr_b16 v[32:33], v4 offset:64
  ds_read_b64_tr_b16 v[34:35], v4 offset:576
  ds_read_b64_tr_b16 v[36:37], v4 offset:96
  ds_read_b64_tr_b16 v[38:39], v4 offset:608
  s_waitcnt lgkmcnt(0)
  buffer_store_dwordx4 v[24:27], v1, s[16:19], s88 offen
  buffer_store_dwordx4 v[28:31], v1, s[16:19], s89 offen
  buffer_store_dwordx4 v[32:35], v1, s[16:19], s90 offen
  buffer_store_dwordx4 v[36:39], v1, s[16:19], s91 offen
  s_cmp_eq_u32 s74, -1
  s_cbranch_scc1 Unc_12
  s_mov_b32 s36, 0x3f803f80
  v_mov_b32 v40, 0
  v_mov_b32 v41, 0
  v_mov_b32 v42, 0
  v_mov_b32 v43, 0
  v_dot2_f32_bf16 v40, v24, s36, v40
  v_dot2_f32_bf16 v41, v28, s36, v41
  v_dot2_f32_bf16 v42, v32, s36, v42
  v_dot2_f32_bf16 v43, v36, s36, v43
  v_dot2_f32_bf16 v40, v25, s36, v40
  v_dot2_f32_bf16 v41, v29, s36, v41
  v_dot2_f32_bf16 v42, v33, s36, v42
  v_dot2_f32_bf16 v43, v37, s36, v43
  v_dot2_f32_bf16 v40, v26, s36, v40
  v_dot2_f32_bf16 v41, v30, s36, v41
  v_dot2_f32_bf16 v42, v34, s36, v42
  v_dot2_f32_bf16 v43, v38, s36, v43
  v_dot2_f32_bf16 v40, v27, s36, v40
  v_dot2_f32_bf16 v41, v31, s36, v41
  v_dot2_f32_bf16 v42, v35, s36, v42
  v_dot2_f32_bf16 v43, v39, s36, v43
  s_nop 3
  v_mov_b32 v5, v40
  s_nop 1
  v_permlane16_swap_b32 v40, v5
  s_nop 1
  v_add_f32 v40, v40, v5
  v_mov_b32 v5, v40
  s_nop 1
  v_permlane32_swap_b32 v40, v5
  s_nop 1
  v_add_f32 v40, v40, v5

  v_mov_b32 v5, v41
  s_nop 1
  v_permlane16_swap_b32 v41, v5
  s_nop 1
  v_add_f32 v41, v41, v5
  v_mov_b32 v5, v41
  s_nop 1
  v_permlane32_swap_b32 v41, v5
  s_nop 1
  v_add_f32 v41, v41, v5

  v_mov_b32 v5, v42
  s_nop 1
  v_permlane16_swap_b32 v42, v5
  s_nop 1
  v_add_f32 v42, v42, v5
  v_mov_b32 v5, v42
  s_nop 1
  v_permlane32_swap_b32 v42, v5
  s_nop 1
  v_add_f32 v42, v42, v5

  v_mov_b32 v5, v43
  s_nop 1
  v_permlane16_swap_b32 v43, v5
  s_nop 1
  v_add_f32 v43, v43, v5
  v_mov_b32 v5, v43
  s_nop 1
  v_permlane32_swap_b32 v43, v5
  s_nop 1
  v_add_f32 v43, v43, v5

  v_cmp_eq_u32 vcc, 1, v3
  s_nop 1
  v_cndmask_b32 v40, v40, v41, vcc
  v_cmp_eq_u32 vcc, 2, v3
  s_nop 1
  v_cndmask_b32 v40, v40, v42, vcc
  v_cmp_eq_u32 vcc, 3, v3
  s_nop 1
  v_cndmask_b32 v40, v40, v43, vcc
  v_lshlrev_b32 v5, 2, v0
  buffer_store_dword v40, v5, s[16:19], s74 offen
  Unc_12:

  s_endpgm
  LP_wq:
  s_sub_u32 s24, s2, 410
  s_lshl_b32 s24, s24, 2
  s_add_u32 s24, s24, s3
  s_lshr_b32 s22, s24, 5
  s_and_b32 s23, s24, 31
  s_mov_b32 s12, s42
  s_mov_b32 s13, s43
  s_mov_b32 s14, 2457600
  s_mov_b32 s15, 0x20000
  s_mul_i32 s25, s23, 40
  s_and_b32 s26, s25, 15
  s_andn2_b32 s25, s25, 15
  s_mul_i32 s27, s22, 122880
  s_add_u32 s27, s27, s25
  v_lshrrev_b32 v2, 2, v0
  v_mul_u32_u24 v2, 3840, v2
  v_and_b32 v3, 3, v0
  v_lshl_add_u32 v2, v3, 4, v2
  s_mul_i32 s28, s3, 6144

  s_add_u32 m0, s28, 0
  s_add_u32 s29, s27, 0
  buffer_load_dwordx4 v2, s[12:15], s29 offen lds

  s_add_u32 m0, s28, 1024
  s_add_u32 s29, s27, 61440
  buffer_load_dwordx4 v2, s[12:15], s29 offen lds

  s_add_u32 m0, s28, 2048
  s_add_u32 s29, s27, 1280
  buffer_load_dwordx4 v2, s[12:15], s29 offen lds

  s_add_u32 m0, s28, 3072
  s_add_u32 s29, s27, 62720
  buffer_load_dwordx4 v2, s[12:15], s29 offen lds

  s_add_u32 m0, s28, 4096
  s_add_u32 s29, s27, 2560
  buffer_load_dwordx4 v2, s[12:15], s29 offen lds

  s_add_u32 m0, s28, 5120
  s_add_u32 s29, s27, 64000
  buffer_load_dwordx4 v2, s[12:15], s29 offen lds

  s_waitcnt vmcnt(0)
  v_lshrrev_b32 v3, 4, v0
  v_bfe_u32 v4, v0, 2, 2
  v_and_b32 v5, 3, v0
  v_lshl_add_u32 v6, v3, 3, v4
  v_lshlrev_b32 v6, 6, v6
  s_add_u32 s28, s28, s26
  v_add_u32 v6, s28, v6
  v_lshl_add_u32 v7, v5, 3, v6
  v_min_u32 v5, 2, v5
  v_lshl_add_u32 v9, v5, 11, v6
  ds_read_b64_tr_b16 v[12:13], v7
  ds_read_b64_tr_b16 v[14:15], v7 offset:256
  ds_read_b64_tr_b16 v[16:17], v7 offset:2048
  ds_read_b64_tr_b16 v[18:19], v7 offset:2304
  ds_read_b64_tr_b16 v[20:21], v7 offset:4096
  ds_read_b64_tr_b16 v[22:23], v7 offset:4352
  ds_read_b64_tr_b16 v[24:25], v9 offset:32
  ds_read_b64_tr_b16 v[26:27], v9 offset:288
  s_waitcnt lgkmcnt(0)
  s_mul_i32 s27, s23, 81920
  s_lshl_b32 s29, s22, 12
  s_add_u32 s27, s27, s29
  s_add_u32 s27, s27, 7340032
  buffer_store_dwordx4 v[12:15], v1, s[16:19], s27 offen
  buffer_store_dwordx4 v[16:19], v1, s[16:19], s27 offen offset:1024
  buffer_store_dwordx4 v[20:23], v1, s[16:19], s27 offen offset:2048
  buffer_store_dwordx4 v[24:27], v1, s[16:19], s27 offen offset:3072
  s_endpgm
  LP_rowstat:
  s_sub_u32 s24, s2, 570
  s_mov_b32 s12, s40
  s_mov_b32 s13, s41
  s_mov_b32 s14, 2621440
  s_mov_b32 s15, 0x20000
  v_lshrrev_b32 v2, 4, v50
  v_and_b32 v3, 15, v50
  v_mul_u32_u24 v4, 1280, v2
  v_mul_u32_u24 v5, 80, v3
  v_add_u32 v4, v4, v5
  s_mul_i32 s25, s24, 20480

  buffer_load_dwordx4 v[24:27], v4, s[12:15], s25 offen offset:0
  buffer_load_dwordx4 v[28:31], v4, s[12:15], s25 offen offset:16
  buffer_load_dwordx4 v[32:35], v4, s[12:15], s25 offen offset:32
  buffer_load_dwordx4 v[36:39], v4, s[12:15], s25 offen offset:48
  buffer_load_dwordx4 v[40:43], v4, s[12:15], s25 offen offset:64
  v_mov_b32 v8, 0
  v_mov_b32 v9, 0
  s_mov_b32 s26, 0x3f803f80
  s_waitcnt vmcnt(0)

  v_dot2_f32_bf16 v8, v24, s26, v8
  v_dot2_f32_bf16 v9, v24, v24, v9
  v_dot2_f32_bf16 v8, v25, s26, v8
  v_dot2_f32_bf16 v9, v25, v25, v9
  v_dot2_f32_bf16 v8, v26, s26, v8
  v_dot2_f32_bf16 v9, v26, v26, v9
  v_dot2_f32_bf16 v8, v27, s26, v8
  v_dot2_f32_bf16 v9, v27, v27, v9
  v_dot2_f32_bf16 v8, v28, s26, v8
  v_dot2_f32_bf16 v9, v28, v28, v9
  v_dot2_f32_bf16 v8, v29, s26, v8
  v_dot2_f32_bf16 v9, v29, v29, v9
  v_dot2_f32_bf16 v8, v30, s26, v8
  v_dot2_f32_bf16 v9, v30, v30, v9
  v_dot2_f32_bf16 v8, v31, s26, v8
  v_dot2_f32_bf16 v9, v31, v31, v9
  v_dot2_f32_bf16 v8, v32, s26, v8
  v_dot2_f32_bf16 v9, v32, v32, v9
  v_dot2_f32_bf16 v8, v33, s26, v8
  v_dot2_f32_bf16 v9, v33, v33, v9
  v_dot2_f32_bf16 v8, v34, s26, v8
  v_dot2_f32_bf16 v9, v34, v34, v9
  v_dot2_f32_bf16 v8, v35, s26, v8
  v_dot2_f32_bf16 v9, v35, v35, v9
  v_dot2_f32_bf16 v8, v36, s26, v8
  v_dot2_f32_bf16 v9, v36, v36, v9
  v_dot2_f32_bf16 v8, v37, s26, v8
  v_dot2_f32_bf16 v9, v37, v37, v9
  v_dot2_f32_bf16 v8, v38, s26, v8
  v_dot2_f32_bf16 v9, v38, v38, v9
  v_dot2_f32_bf16 v8, v39, s26, v8
  v_dot2_f32_bf16 v9, v39, v39, v9
  v_dot2_f32_bf16 v8, v40, s26, v8
  v_dot2_f32_bf16 v9, v40, v40, v9
  v_dot2_f32_bf16 v8, v41, s26, v8
  v_dot2_f32_bf16 v9, v41, v41, v9
  v_dot2_f32_bf16 v8, v42, s26, v8
  v_dot2_f32_bf16 v9, v42, v42, v9
  v_dot2_f32_bf16 v8, v43, s26, v8
  v_dot2_f32_bf16 v9, v43, v43, v9
  s_nop 4
  v_add_f32_dpp v8, v8, v8 row_ror:8
  v_add_f32_dpp v9, v9, v9 row_ror:8
  s_nop 1

  v_add_f32_dpp v8, v8, v8 row_ror:4
  v_add_f32_dpp v9, v9, v9 row_ror:4
  s_nop 1

  v_add_f32_dpp v8, v8, v8 row_ror:2
  v_add_f32_dpp v9, v9, v9 row_ror:2
  s_nop 1

  v_add_f32_dpp v8, v8, v8 row_ror:1
  v_add_f32_dpp v9, v9, v9 row_ror:1
  s_nop 1

  v_cmp_eq_u32 vcc, 0, v3
  s_nop 1
  v_cndmask_b32 v8, 0, v8, vcc
  v_cndmask_b32 v9, 0, v9, vcc
  v_lshlrev_b32 v6, 7, v3
  v_lshl_add_u32 v6, v2, 3, v6
  s_lshl_b32 s25, s24, 10
  s_add_u32 s25, s25, 196608
  v_cmp_gt_u32 vcc, 8, v3
  s_and_saveexec_b64 s[30:31], vcc
  buffer_store_dwordx2 v[8:9], v6, s[16:19], s25 offen
  LP_done:
  s_endpgm

.globl main_kernel
.p2align 8
.type main_kernel,@function
main_kernel:
  s_cmp_ge_u32 s2, 256
  s_cbranch_scc1 LM_exit
  s_load_dwordx4 s[4:7], s[0:1], 0
  s_load_dwordx2 s[34:35], s[0:1], 56
  s_load_dwordx2 s[36:37], s[0:1], 72
  v_lshrrev_b32 v1, 6, v0
  s_nop 0
  v_readfirstlane_b32 s3, v1
  v_and_b32 v0, 63, v0
  v_lshlrev_b32 v1, 4, v0
  v_and_b32 v2, 15, v0
  v_lshrrev_b32 v3, 4, v0
  s_waitcnt lgkmcnt(0)
  s_mov_b32 s8, s4
  s_mov_b32 s9, s5
  s_mov_b32 s10, 2621440
  s_mov_b32 s11, 0x20000
  s_mov_b32 s12, s6
  s_mov_b32 s13, s7
  s_mov_b32 s14, 2457600
  s_mov_b32 s15, 0x20000
  s_mov_b32 s16, s36
  s_mov_b32 s17, s37
  s_mov_b32 s18, 268435456
  s_mov_b32 s19, 0x20000
  s_mov_b32 s20, s34
  s_mov_b32 s21, s35
  s_mov_b32 s22, 2621440
  s_mov_b32 s23, 0x20000
  s_mov_b32 s24, s4
  s_mov_b32 s25, s5
  s_mov_b32 s26, 2621440
  s_mov_b32 s27, 0x20000
  s_and_b32 s34, s2, 7
  s_lshr_b32 s35, s2, 3
  s_lshl_b32 s36, s34, 1
  s_lshr_b32 s37, s35, 4
  s_add_u32 s28, s36, s37
  s_and_b32 s29, s35, 15
  s_mov_b32 s48, s34
  s_mov_b32 s49, s35
  s_and_b32 s36, s29, 1
  s_lshl_b32 s52, s28, 1
  s_add_u32 s52, s52, s36
  s_lshr_b32 s53, s29, 1
  s_and_b32 s33, s3, 3
  s_mov_b32 s30, 0
  s_mov_b32 s32, 12582912
  s_lshl_b32 s46, s28, 9
  s_add_u32 s46, s46, 0
  s_mov_b32 s72, 0
  v_mov_b32 v245, 0
  s_mov_b32 s31, 1

  s_cmp_ge_u32 s3, 4
  s_cbranch_scc1 LM_loader

  s_lshl_b32 s34, s52, 2
  s_add_u32 s34, s34, s33
  s_mul_i32 s34, s34, 20480
  s_mul_i32 s35, s53, 160
  s_add_u32 s34, s34, s35
  v_mul_u32_u24 v4, 1280, v2
  v_lshl_add_u32 v4, v3, 3, v4

  buffer_load_dwordx2 v[246:247], v4, s[8:11], s34 offen offset:0
  buffer_load_dwordx2 v[248:249], v4, s[8:11], s34 offen offset:32
  buffer_load_dwordx2 v[250:251], v4, s[8:11], s34 offen offset:64
  buffer_load_dwordx2 v[252:253], v4, s[8:11], s34 offen offset:96
  buffer_load_dwordx2 v[254:255], v4, s[8:11], s34 offen offset:128
  v_mov_b32 v4, 2048
  v_mov_b32 v6, 0
  v_mov_b32 v7, 0
  ds_write_b64 v4, v[6:7]

  s_waitcnt lgkmcnt(0)
  v_lshrrev_b32 v4, 1, v2
  v_xor_b32 v4, v4, v3
  v_lshlrev_b32 v5, 7, v2
  v_lshl_add_u32 v8, v4, 4, v5
  v_xor_b32 v9, 64, v8

  s_lshl_b32 s35, s33, 13
  s_add_u32 s35, s35, 53248
  v_add_u32 v8, s35, v8
  v_add_u32 v9, s35, v9
  v_add_u32 v22, 0x10000, v8
  v_add_u32 v23, 0x10000, v9

  v_mov_b32 v10, v1
  v_add_u32 v11, 0x10000, v1
  v_mov_b32 v152, 0
  v_mov_b32 v153, 0
  v_mov_b32 v154, 0
  v_mov_b32 v155, 0
  v_mov_b32 v156, 0
  v_mov_b32 v157, 0
  v_mov_b32 v158, 0
  v_mov_b32 v159, 0
  v_mov_b32 v160, 0
  v_mov_b32 v161, 0
  v_mov_b32 v162, 0
  v_mov_b32 v163, 0
  v_mov_b32 v164, 0
  v_mov_b32 v165, 0
  v_mov_b32 v166, 0
  v_mov_b32 v167, 0
  v_mov_b32 v168, 0x3f803f80
  v_mov_b32 v169, 0x3f803f80
  v_mov_b32 v170, 0x3f803f80
  v_mov_b32 v171, 0x3f803f80
  v_mov_b32 v24, 0
  v_mov_b32 v25, 0
  v_mov_b32 v26, 0
  v_mov_b32 v27, 0
  v_mov_b32 v28, 0
  v_mov_b32 v29, 0
  v_mov_b32 v30, 0
  v_mov_b32 v31, 0
  v_mov_b32 v32, 0
  v_mov_b32 v33, 0
  v_mov_b32 v34, 0
  v_mov_b32 v35, 0
  v_mov_b32 v36, 0
  v_mov_b32 v37, 0
  v_mov_b32 v38, 0
  v_mov_b32 v39, 0
  v_mov_b32 v40, 0
  v_mov_b32 v41, 0
  v_mov_b32 v42, 0
  v_mov_b32 v43, 0
  v_mov_b32 v44, 0
  v_mov_b32 v45, 0
  v_mov_b32 v46, 0
  v_mov_b32 v47, 0
  v_mov_b32 v48, 0
  v_mov_b32 v49, 0
  v_mov_b32 v50, 0
  v_mov_b32 v51, 0
  v_mov_b32 v52, 0
  v_mov_b32 v53, 0
  v_mov_b32 v54, 0
  v_mov_b32 v55, 0
  v_mov_b32 v56, 0
  v_mov_b32 v57, 0
  v_mov_b32 v58, 0
  v_mov_b32 v59, 0
  v_mov_b32 v60, 0
  v_mov_b32 v61, 0
  v_mov_b32 v62, 0
  v_mov_b32 v63, 0
  v_mov_b32 v64, 0
  v_mov_b32 v65, 0
  v_mov_b32 v66, 0
  v_mov_b32 v67, 0
  v_mov_b32 v68, 0
  v_mov_b32 v69, 0
  v_mov_b32 v70, 0
  v_mov_b32 v71, 0
  v_mov_b32 v72, 0
  v_mov_b32 v73, 0
  v_mov_b32 v74, 0
  v_mov_b32 v75, 0
  v_mov_b32 v76, 0
  v_mov_b32 v77, 0
  v_mov_b32 v78, 0
  v_mov_b32 v79, 0
  v_mov_b32 v80, 0
  v_mov_b32 v81, 0
  v_mov_b32 v82, 0
  v_mov_b32 v83, 0
  v_mov_b32 v84, 0
  v_mov_b32 v85, 0
  v_mov_b32 v86, 0
  v_mov_b32 v87, 0
  s_barrier
  ds_read_b128 v[88:91], v8 offset:0
  ds_read_b128 v[104:107], v10 offset:4096
  ds_read_b128 v[92:95], v8 offset:2048
  ds_read_b128 v[108:111], v10 offset:5120
  ds_read_b128 v[96:99], v8 offset:4096
  ds_read_b128 v[112:115], v10 offset:6144
  ds_read_b128 v[100:103], v8 offset:6144
  ds_read_b128 v[116:119], v10 offset:7168
  s_waitcnt lgkmcnt(0)
  v_mfma_f32_16x16x32_bf16 v[24:27], v[88:91], v[104:107], v[24:27]
  ds_read_b128 v[120:123], v9 offset:0
  v_mfma_f32_16x16x32_bf16 v[28:31], v[88:91], v[108:111], v[28:31]
  ds_read_b128 v[136:139], v10 offset:8192
  v_mfma_f32_16x16x32_bf16 v[32:35], v[88:91], v[112:115], v[32:35]
  ds_read_b128 v[124:127], v9 offset:2048
  v_mfma_f32_16x16x32_bf16 v[36:39], v[88:91], v[116:119], v[36:39]
  ds_read_b128 v[140:143], v10 offset:9216
  v_mfma_f32_16x16x32_bf16 v[40:43], v[92:95], v[104:107], v[40:43]
  ds_read_b128 v[128:131], v9 offset:4096
  v_mfma_f32_16x16x32_bf16 v[44:47], v[92:95], v[108:111], v[44:47]
  ds_read_b128 v[144:147], v10 offset:10240
  v_mfma_f32_16x16x32_bf16 v[48:51], v[92:95], v[112:115], v[48:51]
  ds_read_b128 v[132:135], v9 offset:6144
  v_mfma_f32_16x16x32_bf16 v[52:55], v[92:95], v[116:119], v[52:55]
  ds_read_b128 v[148:151], v10 offset:11264
  v_mfma_f32_16x16x32_bf16 v[56:59], v[96:99], v[104:107], v[56:59]
  v_mfma_f32_16x16x32_bf16 v[60:63], v[96:99], v[108:111], v[60:63]
  v_mfma_f32_16x16x32_bf16 v[64:67], v[96:99], v[112:115], v[64:67]
  v_mfma_f32_16x16x32_bf16 v[68:71], v[96:99], v[116:119], v[68:71]
  v_mfma_f32_16x16x32_bf16 v[72:75], v[100:103], v[104:107], v[72:75]
  v_mfma_f32_16x16x32_bf16 v[76:79], v[100:103], v[108:111], v[76:79]
  v_mfma_f32_16x16x32_bf16 v[80:83], v[100:103], v[112:115], v[80:83]
  v_mfma_f32_16x16x32_bf16 v[84:87], v[100:103], v[116:119], v[84:87]
  v_mfma_f32_16x16x32_bf16 v[152:155], v[168:171], v[104:107], v[152:155]
  v_mfma_f32_16x16x32_bf16 v[156:159], v[168:171], v[108:111], v[156:159]
  v_mfma_f32_16x16x32_bf16 v[160:163], v[168:171], v[112:115], v[160:163]
  v_mfma_f32_16x16x32_bf16 v[164:167], v[168:171], v[116:119], v[164:167]
  s_waitcnt lgkmcnt(0)
  v_mfma_f32_16x16x32_bf16 v[24:27], v[120:123], v[136:139], v[24:27]
  v_mfma_f32_16x16x32_bf16 v[28:31], v[120:123], v[140:143], v[28:31]
  s_barrier
  v_mfma_f32_16x16x32_bf16 v[32:35], v[120:123], v[144:147], v[32:35]
  ds_read_b128 v[88:91], v8 offset:32768
  v_mfma_f32_16x16x32_bf16 v[36:39], v[120:123], v[148:151], v[36:39]
  ds_read_b128 v[104:107], v10 offset:12288
  v_mfma_f32_16x16x32_bf16 v[40:43], v[124:127], v[136:139], v[40:43]
  ds_read_b128 v[92:95], v8 offset:34816
  v_mfma_f32_16x16x32_bf16 v[44:47], v[124:127], v[140:143], v[44:47]
  ds_read_b128 v[108:111], v10 offset:13312
  v_mfma_f32_16x16x32_bf16 v[48:51], v[124:127], v[144:147], v[48:51]
  ds_read_b128 v[96:99], v8 offset:36864
  v_mfma_f32_16x16x32_bf16 v[52:55], v[124:127], v[148:151], v[52:55]
  ds_read_b128 v[112:115], v10 offset:14336
  v_mfma_f32_16x16x32_bf16 v[56:59], v[128:131], v[136:139], v[56:59]
  ds_read_b128 v[100:103], v8 offset:38912
  v_mfma_f32_16x16x32_bf16 v[60:63], v[128:131], v[140:143], v[60:63]
  ds_read_b128 v[116:119], v10 offset:15360
  v_mfma_f32_16x16x32_bf16 v[64:67], v[128:131], v[144:147], v[64:67]
  v_mfma_f32_16x16x32_bf16 v[68:71], v[128:131], v[148:151], v[68:71]
  v_mfma_f32_16x16x32_bf16 v[72:75], v[132:135], v[136:139], v[72:75]
  v_mfma_f32_16x16x32_bf16 v[76:79], v[132:135], v[140:143], v[76:79]
  v_mfma_f32_16x16x32_bf16 v[80:83], v[132:135], v[144:147], v[80:83]
  v_mfma_f32_16x16x32_bf16 v[84:87], v[132:135], v[148:151], v[84:87]
  v_mfma_f32_16x16x32_bf16 v[152:155], v[168:171], v[136:139], v[152:155]
  v_mfma_f32_16x16x32_bf16 v[156:159], v[168:171], v[140:143], v[156:159]
  v_mfma_f32_16x16x32_bf16 v[160:163], v[168:171], v[144:147], v[160:163]
  v_mfma_f32_16x16x32_bf16 v[164:167], v[168:171], v[148:151], v[164:167]
  s_waitcnt lgkmcnt(0)
  v_mfma_f32_16x16x32_bf16 v[24:27], v[88:91], v[104:107], v[24:27]
  ds_read_b128 v[120:123], v9 offset:32768
  v_mfma_f32_16x16x32_bf16 v[28:31], v[88:91], v[108:111], v[28:31]
  ds_read_b128 v[136:139], v10 offset:16384
  v_mfma_f32_16x16x32_bf16 v[32:35], v[88:91], v[112:115], v[32:35]
  ds_read_b128 v[124:127], v9 offset:34816
  v_mfma_f32_16x16x32_bf16 v[36:39], v[88:91], v[116:119], v[36:39]
  ds_read_b128 v[140:143], v10 offset:17408
  v_mfma_f32_16x16x32_bf16 v[40:43], v[92:95], v[104:107], v[40:43]
  ds_read_b128 v[128:131], v9 offset:36864
  v_mfma_f32_16x16x32_bf16 v[44:47], v[92:95], v[108:111], v[44:47]
  ds_read_b128 v[144:147], v10 offset:18432
  v_mfma_f32_16x16x32_bf16 v[48:51], v[92:95], v[112:115], v[48:51]
  ds_read_b128 v[132:135], v9 offset:38912
  v_mfma_f32_16x16x32_bf16 v[52:55], v[92:95], v[116:119], v[52:55]
  ds_read_b128 v[148:151], v10 offset:19456
  v_mfma_f32_16x16x32_bf16 v[56:59], v[96:99], v[104:107], v[56:59]
  v_mfma_f32_16x16x32_bf16 v[60:63], v[96:99], v[108:111], v[60:63]
  v_mfma_f32_16x16x32_bf16 v[64:67], v[96:99], v[112:115], v[64:67]
  v_mfma_f32_16x16x32_bf16 v[68:71], v[96:99], v[116:119], v[68:71]
  v_mfma_f32_16x16x32_bf16 v[72:75], v[100:103], v[104:107], v[72:75]
  v_mfma_f32_16x16x32_bf16 v[76:79], v[100:103], v[108:111], v[76:79]
  v_mfma_f32_16x16x32_bf16 v[80:83], v[100:103], v[112:115], v[80:83]
  v_mfma_f32_16x16x32_bf16 v[84:87], v[100:103], v[116:119], v[84:87]
  v_mfma_f32_16x16x32_bf16 v[152:155], v[168:171], v[104:107], v[152:155]
  v_mfma_f32_16x16x32_bf16 v[156:159], v[168:171], v[108:111], v[156:159]
  v_mfma_f32_16x16x32_bf16 v[160:163], v[168:171], v[112:115], v[160:163]
  v_mfma_f32_16x16x32_bf16 v[164:167], v[168:171], v[116:119], v[164:167]
  s_waitcnt lgkmcnt(0)
  v_mfma_f32_16x16x32_bf16 v[24:27], v[120:123], v[136:139], v[24:27]
  v_mfma_f32_16x16x32_bf16 v[28:31], v[120:123], v[140:143], v[28:31]
  s_barrier
  v_mfma_f32_16x16x32_bf16 v[32:35], v[120:123], v[144:147], v[32:35]
  ds_read_b128 v[88:91], v22 offset:0
  v_mfma_f32_16x16x32_bf16 v[36:39], v[120:123], v[148:151], v[36:39]
  ds_read_b128 v[104:107], v10 offset:20480
  v_mfma_f32_16x16x32_bf16 v[40:43], v[124:127], v[136:139], v[40:43]
  ds_read_b128 v[92:95], v22 offset:2048
  v_mfma_f32_16x16x32_bf16 v[44:47], v[124:127], v[140:143], v[44:47]
  ds_read_b128 v[108:111], v10 offset:21504
  v_mfma_f32_16x16x32_bf16 v[48:51], v[124:127], v[144:147], v[48:51]
  ds_read_b128 v[96:99], v22 offset:4096
  v_mfma_f32_16x16x32_bf16 v[52:55], v[124:127], v[148:151], v[52:55]
  ds_read_b128 v[112:115], v10 offset:22528
  v_mfma_f32_16x16x32_bf16 v[56:59], v[128:131], v[136:139], v[56:59]
  ds_read_b128 v[100:103], v22 offset:6144
  v_mfma_f32_16x16x32_bf16 v[60:63], v[128:131], v[140:143], v[60:63]
  ds_read_b128 v[116:119], v10 offset:23552
  v_mfma_f32_16x16x32_bf16 v[64:67], v[128:131], v[144:147], v[64:67]
  v_mfma_f32_16x16x32_bf16 v[68:71], v[128:131], v[148:151], v[68:71]
  v_mfma_f32_16x16x32_bf16 v[72:75], v[132:135], v[136:139], v[72:75]
  v_mfma_f32_16x16x32_bf16 v[76:79], v[132:135], v[140:143], v[76:79]
  v_mfma_f32_16x16x32_bf16 v[80:83], v[132:135], v[144:147], v[80:83]
  v_mfma_f32_16x16x32_bf16 v[84:87], v[132:135], v[148:151], v[84:87]
  v_mfma_f32_16x16x32_bf16 v[152:155], v[168:171], v[136:139], v[152:155]
  v_mfma_f32_16x16x32_bf16 v[156:159], v[168:171], v[140:143], v[156:159]
  v_mfma_f32_16x16x32_bf16 v[160:163], v[168:171], v[144:147], v[160:163]
  v_mfma_f32_16x16x32_bf16 v[164:167], v[168:171], v[148:151], v[164:167]
  s_waitcnt lgkmcnt(0)
  v_mfma_f32_16x16x32_bf16 v[24:27], v[88:91], v[104:107], v[24:27]
  ds_read_b128 v[120:123], v23 offset:0
  v_mfma_f32_16x16x32_bf16 v[28:31], v[88:91], v[108:111], v[28:31]
  ds_read_b128 v[136:139], v10 offset:24576
  v_mfma_f32_16x16x32_bf16 v[32:35], v[88:91], v[112:115], v[32:35]
  ds_read_b128 v[124:127], v23 offset:2048
  v_mfma_f32_16x16x32_bf16 v[36:39], v[88:91], v[116:119], v[36:39]
  ds_read_b128 v[140:143], v10 offset:25600
  v_mfma_f32_16x16x32_bf16 v[40:43], v[92:95], v[104:107], v[40:43]
  ds_read_b128 v[128:131], v23 offset:4096
  v_mfma_f32_16x16x32_bf16 v[44:47], v[92:95], v[108:111], v[44:47]
  ds_read_b128 v[144:147], v10 offset:26624
  v_mfma_f32_16x16x32_bf16 v[48:51], v[92:95], v[112:115], v[48:51]
  ds_read_b128 v[132:135], v23 offset:6144
  v_mfma_f32_16x16x32_bf16 v[52:55], v[92:95], v[116:119], v[52:55]
  ds_read_b128 v[148:151], v10 offset:27648
  v_mfma_f32_16x16x32_bf16 v[56:59], v[96:99], v[104:107], v[56:59]
  v_mfma_f32_16x16x32_bf16 v[60:63], v[96:99], v[108:111], v[60:63]
  v_mfma_f32_16x16x32_bf16 v[64:67], v[96:99], v[112:115], v[64:67]
  v_mfma_f32_16x16x32_bf16 v[68:71], v[96:99], v[116:119], v[68:71]
  v_mfma_f32_16x16x32_bf16 v[72:75], v[100:103], v[104:107], v[72:75]
  v_mfma_f32_16x16x32_bf16 v[76:79], v[100:103], v[108:111], v[76:79]
  v_mfma_f32_16x16x32_bf16 v[80:83], v[100:103], v[112:115], v[80:83]
  v_mfma_f32_16x16x32_bf16 v[84:87], v[100:103], v[116:119], v[84:87]
  v_mfma_f32_16x16x32_bf16 v[152:155], v[168:171], v[104:107], v[152:155]
  v_mfma_f32_16x16x32_bf16 v[156:159], v[168:171], v[108:111], v[156:159]
  v_mfma_f32_16x16x32_bf16 v[160:163], v[168:171], v[112:115], v[160:163]
  v_mfma_f32_16x16x32_bf16 v[164:167], v[168:171], v[116:119], v[164:167]
  s_waitcnt lgkmcnt(0)
  v_mfma_f32_16x16x32_bf16 v[24:27], v[120:123], v[136:139], v[24:27]
  v_mfma_f32_16x16x32_bf16 v[28:31], v[120:123], v[140:143], v[28:31]
  s_barrier
  v_mfma_f32_16x16x32_bf16 v[32:35], v[120:123], v[144:147], v[32:35]
  ds_read_b128 v[88:91], v8 offset:0
  v_mfma_f32_16x16x32_bf16 v[36:39], v[120:123], v[148:151], v[36:39]
  ds_read_b128 v[104:107], v10 offset:28672
  v_mfma_f32_16x16x32_bf16 v[40:43], v[124:127], v[136:139], v[40:43]
  ds_read_b128 v[92:95], v8 offset:2048
  v_mfma_f32_16x16x32_bf16 v[44:47], v[124:127], v[140:143], v[44:47]
  ds_read_b128 v[108:111], v10 offset:29696
  v_mfma_f32_16x16x32_bf16 v[48:51], v[124:127], v[144:147], v[48:51]
  ds_read_b128 v[96:99], v8 offset:4096
  v_mfma_f32_16x16x32_bf16 v[52:55], v[124:127], v[148:151], v[52:55]
  ds_read_b128 v[112:115], v10 offset:30720
  v_mfma_f32_16x16x32_bf16 v[56:59], v[128:131], v[136:139], v[56:59]
  ds_read_b128 v[100:103], v8 offset:6144
  v_mfma_f32_16x16x32_bf16 v[60:63], v[128:131], v[140:143], v[60:63]
  ds_read_b128 v[116:119], v10 offset:31744
  v_mfma_f32_16x16x32_bf16 v[64:67], v[128:131], v[144:147], v[64:67]
  v_mfma_f32_16x16x32_bf16 v[68:71], v[128:131], v[148:151], v[68:71]
  v_mfma_f32_16x16x32_bf16 v[72:75], v[132:135], v[136:139], v[72:75]
  v_mfma_f32_16x16x32_bf16 v[76:79], v[132:135], v[140:143], v[76:79]
  v_mfma_f32_16x16x32_bf16 v[80:83], v[132:135], v[144:147], v[80:83]
  v_mfma_f32_16x16x32_bf16 v[84:87], v[132:135], v[148:151], v[84:87]
  v_mfma_f32_16x16x32_bf16 v[152:155], v[168:171], v[136:139], v[152:155]
  v_mfma_f32_16x16x32_bf16 v[156:159], v[168:171], v[140:143], v[156:159]
  v_mfma_f32_16x16x32_bf16 v[160:163], v[168:171], v[144:147], v[160:163]
  v_mfma_f32_16x16x32_bf16 v[164:167], v[168:171], v[148:151], v[164:167]
  s_waitcnt lgkmcnt(0)
  v_mfma_f32_16x16x32_bf16 v[24:27], v[88:91], v[104:107], v[24:27]
  ds_read_b128 v[120:123], v9 offset:0
  v_mfma_f32_16x16x32_bf16 v[28:31], v[88:91], v[108:111], v[28:31]
  ds_read_b128 v[136:139], v10 offset:32768
  v_mfma_f32_16x16x32_bf16 v[32:35], v[88:91], v[112:115], v[32:35]
  ds_read_b128 v[124:127], v9 offset:2048
  v_mfma_f32_16x16x32_bf16 v[36:39], v[88:91], v[116:119], v[36:39]
  ds_read_b128 v[140:143], v10 offset:33792
  v_mfma_f32_16x16x32_bf16 v[40:43], v[92:95], v[104:107], v[40:43]
  ds_read_b128 v[128:131], v9 offset:4096
  v_mfma_f32_16x16x32_bf16 v[44:47], v[92:95], v[108:111], v[44:47]
  ds_read_b128 v[144:147], v10 offset:34816
  v_mfma_f32_16x16x32_bf16 v[48:51], v[92:95], v[112:115], v[48:51]
  ds_read_b128 v[132:135], v9 offset:6144
  v_mfma_f32_16x16x32_bf16 v[52:55], v[92:95], v[116:119], v[52:55]
  ds_read_b128 v[148:151], v10 offset:35840
  v_mfma_f32_16x16x32_bf16 v[56:59], v[96:99], v[104:107], v[56:59]
  v_mfma_f32_16x16x32_bf16 v[60:63], v[96:99], v[108:111], v[60:63]
  v_mfma_f32_16x16x32_bf16 v[64:67], v[96:99], v[112:115], v[64:67]
  v_mfma_f32_16x16x32_bf16 v[68:71], v[96:99], v[116:119], v[68:71]
  v_mfma_f32_16x16x32_bf16 v[72:75], v[100:103], v[104:107], v[72:75]
  v_mfma_f32_16x16x32_bf16 v[76:79], v[100:103], v[108:111], v[76:79]
  v_mfma_f32_16x16x32_bf16 v[80:83], v[100:103], v[112:115], v[80:83]
  v_mfma_f32_16x16x32_bf16 v[84:87], v[100:103], v[116:119], v[84:87]
  v_mfma_f32_16x16x32_bf16 v[152:155], v[168:171], v[104:107], v[152:155]
  v_mfma_f32_16x16x32_bf16 v[156:159], v[168:171], v[108:111], v[156:159]
  v_mfma_f32_16x16x32_bf16 v[160:163], v[168:171], v[112:115], v[160:163]
  v_mfma_f32_16x16x32_bf16 v[164:167], v[168:171], v[116:119], v[164:167]
  s_waitcnt lgkmcnt(0)
  v_mfma_f32_16x16x32_bf16 v[24:27], v[120:123], v[136:139], v[24:27]
  v_mfma_f32_16x16x32_bf16 v[28:31], v[120:123], v[140:143], v[28:31]
  s_barrier
  v_mfma_f32_16x16x32_bf16 v[32:35], v[120:123], v[144:147], v[32:35]
  ds_read_b128 v[88:91], v8 offset:32768
  v_mfma_f32_16x16x32_bf16 v[36:39], v[120:123], v[148:151], v[36:39]
  ds_read_b128 v[104:107], v10 offset:36864
  v_mfma_f32_16x16x32_bf16 v[40:43], v[124:127], v[136:139], v[40:43]
  ds_read_b128 v[92:95], v8 offset:34816
  v_mfma_f32_16x16x32_bf16 v[44:47], v[124:127], v[140:143], v[44:47]
  ds_read_b128 v[108:111], v10 offset:37888
  v_mfma_f32_16x16x32_bf16 v[48:51], v[124:127], v[144:147], v[48:51]
  ds_read_b128 v[96:99], v8 offset:36864
  v_mfma_f32_16x16x32_bf16 v[52:55], v[124:127], v[148:151], v[52:55]
  ds_read_b128 v[112:115], v10 offset:38912
  v_mfma_f32_16x16x32_bf16 v[56:59], v[128:131], v[136:139], v[56:59]
  ds_read_b128 v[100:103], v8 offset:38912
  v_mfma_f32_16x16x32_bf16 v[60:63], v[128:131], v[140:143], v[60:63]
  ds_read_b128 v[116:119], v10 offset:39936
  v_mfma_f32_16x16x32_bf16 v[64:67], v[128:131], v[144:147], v[64:67]
  v_mfma_f32_16x16x32_bf16 v[68:71], v[128:131], v[148:151], v[68:71]
  v_mfma_f32_16x16x32_bf16 v[72:75], v[132:135], v[136:139], v[72:75]
  v_mfma_f32_16x16x32_bf16 v[76:79], v[132:135], v[140:143], v[76:79]
  v_mfma_f32_16x16x32_bf16 v[80:83], v[132:135], v[144:147], v[80:83]
  v_mfma_f32_16x16x32_bf16 v[84:87], v[132:135], v[148:151], v[84:87]
  v_mfma_f32_16x16x32_bf16 v[152:155], v[168:171], v[136:139], v[152:155]
  v_mfma_f32_16x16x32_bf16 v[156:159], v[168:171], v[140:143], v[156:159]
  v_mfma_f32_16x16x32_bf16 v[160:163], v[168:171], v[144:147], v[160:163]
  v_mfma_f32_16x16x32_bf16 v[164:167], v[168:171], v[148:151], v[164:167]
  s_waitcnt lgkmcnt(0)
  v_mfma_f32_16x16x32_bf16 v[24:27], v[88:91], v[104:107], v[24:27]
  ds_read_b128 v[120:123], v9 offset:32768
  v_mfma_f32_16x16x32_bf16 v[28:31], v[88:91], v[108:111], v[28:31]
  ds_read_b128 v[136:139], v10 offset:40960
  v_mfma_f32_16x16x32_bf16 v[32:35], v[88:91], v[112:115], v[32:35]
  ds_read_b128 v[124:127], v9 offset:34816
  v_mfma_f32_16x16x32_bf16 v[36:39], v[88:91], v[116:119], v[36:39]
  ds_read_b128 v[140:143], v10 offset:41984
  v_mfma_f32_16x16x32_bf16 v[40:43], v[92:95], v[104:107], v[40:43]
  ds_read_b128 v[128:131], v9 offset:36864
  v_mfma_f32_16x16x32_bf16 v[44:47], v[92:95], v[108:111], v[44:47]
  ds_read_b128 v[144:147], v10 offset:43008
  v_mfma_f32_16x16x32_bf16 v[48:51], v[92:95], v[112:115], v[48:51]
  ds_read_b128 v[132:135], v9 offset:38912
  v_mfma_f32_16x16x32_bf16 v[52:55], v[92:95], v[116:119], v[52:55]
  ds_read_b128 v[148:151], v10 offset:44032
  v_mfma_f32_16x16x32_bf16 v[56:59], v[96:99], v[104:107], v[56:59]
  v_mfma_f32_16x16x32_bf16 v[60:63], v[96:99], v[108:111], v[60:63]
  v_mfma_f32_16x16x32_bf16 v[64:67], v[96:99], v[112:115], v[64:67]
  v_mfma_f32_16x16x32_bf16 v[68:71], v[96:99], v[116:119], v[68:71]
  v_mfma_f32_16x16x32_bf16 v[72:75], v[100:103], v[104:107], v[72:75]
  v_mfma_f32_16x16x32_bf16 v[76:79], v[100:103], v[108:111], v[76:79]
  v_mfma_f32_16x16x32_bf16 v[80:83], v[100:103], v[112:115], v[80:83]
  v_mfma_f32_16x16x32_bf16 v[84:87], v[100:103], v[116:119], v[84:87]
  v_mfma_f32_16x16x32_bf16 v[152:155], v[168:171], v[104:107], v[152:155]
  v_mfma_f32_16x16x32_bf16 v[156:159], v[168:171], v[108:111], v[156:159]
  v_mfma_f32_16x16x32_bf16 v[160:163], v[168:171], v[112:115], v[160:163]
  v_mfma_f32_16x16x32_bf16 v[164:167], v[168:171], v[116:119], v[164:167]
  s_waitcnt lgkmcnt(0)
  v_mfma_f32_16x16x32_bf16 v[24:27], v[120:123], v[136:139], v[24:27]
  v_mfma_f32_16x16x32_bf16 v[28:31], v[120:123], v[140:143], v[28:31]
  s_barrier
  v_mfma_f32_16x16x32_bf16 v[32:35], v[120:123], v[144:147], v[32:35]
  ds_read_b128 v[88:91], v22 offset:0
  v_mfma_f32_16x16x32_bf16 v[36:39], v[120:123], v[148:151], v[36:39]
  ds_read_b128 v[104:107], v10 offset:45056
  v_mfma_f32_16x16x32_bf16 v[40:43], v[124:127], v[136:139], v[40:43]
  ds_read_b128 v[92:95], v22 offset:2048
  v_mfma_f32_16x16x32_bf16 v[44:47], v[124:127], v[140:143], v[44:47]
  ds_read_b128 v[108:111], v10 offset:46080
  v_mfma_f32_16x16x32_bf16 v[48:51], v[124:127], v[144:147], v[48:51]
  ds_read_b128 v[96:99], v22 offset:4096
  v_mfma_f32_16x16x32_bf16 v[52:55], v[124:127], v[148:151], v[52:55]
  ds_read_b128 v[112:115], v10 offset:47104
  v_mfma_f32_16x16x32_bf16 v[56:59], v[128:131], v[136:139], v[56:59]
  ds_read_b128 v[100:103], v22 offset:6144
  v_mfma_f32_16x16x32_bf16 v[60:63], v[128:131], v[140:143], v[60:63]
  ds_read_b128 v[116:119], v10 offset:48128
  v_mfma_f32_16x16x32_bf16 v[64:67], v[128:131], v[144:147], v[64:67]
  v_mfma_f32_16x16x32_bf16 v[68:71], v[128:131], v[148:151], v[68:71]
  v_mfma_f32_16x16x32_bf16 v[72:75], v[132:135], v[136:139], v[72:75]
  v_mfma_f32_16x16x32_bf16 v[76:79], v[132:135], v[140:143], v[76:79]
  v_mfma_f32_16x16x32_bf16 v[80:83], v[132:135], v[144:147], v[80:83]
  v_mfma_f32_16x16x32_bf16 v[84:87], v[132:135], v[148:151], v[84:87]
  v_mfma_f32_16x16x32_bf16 v[152:155], v[168:171], v[136:139], v[152:155]
  v_mfma_f32_16x16x32_bf16 v[156:159], v[168:171], v[140:143], v[156:159]
  v_mfma_f32_16x16x32_bf16 v[160:163], v[168:171], v[144:147], v[160:163]
  v_mfma_f32_16x16x32_bf16 v[164:167], v[168:171], v[148:151], v[164:167]
  s_waitcnt lgkmcnt(0)
  v_mfma_f32_16x16x32_bf16 v[24:27], v[88:91], v[104:107], v[24:27]
  ds_read_b128 v[120:123], v23 offset:0
  v_mfma_f32_16x16x32_bf16 v[28:31], v[88:91], v[108:111], v[28:31]
  ds_read_b128 v[136:139], v10 offset:49152
  v_mfma_f32_16x16x32_bf16 v[32:35], v[88:91], v[112:115], v[32:35]
  ds_read_b128 v[124:127], v23 offset:2048
  v_mfma_f32_16x16x32_bf16 v[36:39], v[88:91], v[116:119], v[36:39]
  ds_read_b128 v[140:143], v10 offset:50176
  v_mfma_f32_16x16x32_bf16 v[40:43], v[92:95], v[104:107], v[40:43]
  ds_read_b128 v[128:131], v23 offset:4096
  v_mfma_f32_16x16x32_bf16 v[44:47], v[92:95], v[108:111], v[44:47]
  ds_read_b128 v[144:147], v10 offset:51200
  v_mfma_f32_16x16x32_bf16 v[48:51], v[92:95], v[112:115], v[48:51]
  ds_read_b128 v[132:135], v23 offset:6144
  v_mfma_f32_16x16x32_bf16 v[52:55], v[92:95], v[116:119], v[52:55]
  ds_read_b128 v[148:151], v10 offset:52224
  v_mfma_f32_16x16x32_bf16 v[56:59], v[96:99], v[104:107], v[56:59]
  v_mfma_f32_16x16x32_bf16 v[60:63], v[96:99], v[108:111], v[60:63]
  v_mfma_f32_16x16x32_bf16 v[64:67], v[96:99], v[112:115], v[64:67]
  v_mfma_f32_16x16x32_bf16 v[68:71], v[96:99], v[116:119], v[68:71]
  v_mfma_f32_16x16x32_bf16 v[72:75], v[100:103], v[104:107], v[72:75]
  v_mfma_f32_16x16x32_bf16 v[76:79], v[100:103], v[108:111], v[76:79]
  v_mfma_f32_16x16x32_bf16 v[80:83], v[100:103], v[112:115], v[80:83]
  v_mfma_f32_16x16x32_bf16 v[84:87], v[100:103], v[116:119], v[84:87]
  v_mfma_f32_16x16x32_bf16 v[152:155], v[168:171], v[104:107], v[152:155]
  v_mfma_f32_16x16x32_bf16 v[156:159], v[168:171], v[108:111], v[156:159]
  v_mfma_f32_16x16x32_bf16 v[160:163], v[168:171], v[112:115], v[160:163]
  v_mfma_f32_16x16x32_bf16 v[164:167], v[168:171], v[116:119], v[164:167]
  s_waitcnt lgkmcnt(0)
  v_mfma_f32_16x16x32_bf16 v[24:27], v[120:123], v[136:139], v[24:27]
  v_mfma_f32_16x16x32_bf16 v[28:31], v[120:123], v[140:143], v[28:31]
  s_barrier
  v_mfma_f32_16x16x32_bf16 v[32:35], v[120:123], v[144:147], v[32:35]
  ds_read_b128 v[88:91], v8 offset:0
  v_mfma_f32_16x16x32_bf16 v[36:39], v[120:123], v[148:151], v[36:39]
  ds_read_b128 v[104:107], v10 offset:4096
  v_mfma_f32_16x16x32_bf16 v[40:43], v[124:127], v[136:139], v[40:43]
  ds_read_b128 v[92:95], v8 offset:2048
  v_mfma_f32_16x16x32_bf16 v[44:47], v[124:127], v[140:143], v[44:47]
  ds_read_b128 v[108:111], v10 offset:5120
  v_mfma_f32_16x16x32_bf16 v[48:51], v[124:127], v[144:147], v[48:51]
  ds_read_b128 v[96:99], v8 offset:4096
  v_mfma_f32_16x16x32_bf16 v[52:55], v[124:127], v[148:151], v[52:55]
  ds_read_b128 v[112:115], v10 offset:6144
  v_mfma_f32_16x16x32_bf16 v[56:59], v[128:131], v[136:139], v[56:59]
  ds_read_b128 v[100:103], v8 offset:6144
  v_mfma_f32_16x16x32_bf16 v[60:63], v[128:131], v[140:143], v[60:63]
  ds_read_b128 v[116:119], v10 offset:7168
  v_mfma_f32_16x16x32_bf16 v[64:67], v[128:131], v[144:147], v[64:67]
  v_mfma_f32_16x16x32_bf16 v[68:71], v[128:131], v[148:151], v[68:71]
  v_mfma_f32_16x16x32_bf16 v[72:75], v[132:135], v[136:139], v[72:75]
  v_mfma_f32_16x16x32_bf16 v[76:79], v[132:135], v[140:143], v[76:79]
  v_mfma_f32_16x16x32_bf16 v[80:83], v[132:135], v[144:147], v[80:83]
  v_mfma_f32_16x16x32_bf16 v[84:87], v[132:135], v[148:151], v[84:87]
  v_mfma_f32_16x16x32_bf16 v[152:155], v[168:171], v[136:139], v[152:155]
  v_mfma_f32_16x16x32_bf16 v[156:159], v[168:171], v[140:143], v[156:159]
  v_mfma_f32_16x16x32_bf16 v[160:163], v[168:171], v[144:147], v[160:163]
  v_mfma_f32_16x16x32_bf16 v[164:167], v[168:171], v[148:151], v[164:167]
  s_waitcnt lgkmcnt(0)
  v_mfma_f32_16x16x32_bf16 v[24:27], v[88:91], v[104:107], v[24:27]
  ds_read_b128 v[120:123], v9 offset:0
  v_mfma_f32_16x16x32_bf16 v[28:31], v[88:91], v[108:111], v[28:31]
  ds_read_b128 v[136:139], v10 offset:8192
  v_mfma_f32_16x16x32_bf16 v[32:35], v[88:91], v[112:115], v[32:35]
  ds_read_b128 v[124:127], v9 offset:2048
  v_mfma_f32_16x16x32_bf16 v[36:39], v[88:91], v[116:119], v[36:39]
  ds_read_b128 v[140:143], v10 offset:9216
  v_mfma_f32_16x16x32_bf16 v[40:43], v[92:95], v[104:107], v[40:43]
  ds_read_b128 v[128:131], v9 offset:4096
  v_mfma_f32_16x16x32_bf16 v[44:47], v[92:95], v[108:111], v[44:47]
  ds_read_b128 v[144:147], v10 offset:10240
  v_mfma_f32_16x16x32_bf16 v[48:51], v[92:95], v[112:115], v[48:51]
  ds_read_b128 v[132:135], v9 offset:6144
  v_mfma_f32_16x16x32_bf16 v[52:55], v[92:95], v[116:119], v[52:55]
  ds_read_b128 v[148:151], v10 offset:11264
  v_mfma_f32_16x16x32_bf16 v[56:59], v[96:99], v[104:107], v[56:59]
  v_mfma_f32_16x16x32_bf16 v[60:63], v[96:99], v[108:111], v[60:63]
  v_mfma_f32_16x16x32_bf16 v[64:67], v[96:99], v[112:115], v[64:67]
  v_mfma_f32_16x16x32_bf16 v[68:71], v[96:99], v[116:119], v[68:71]
  v_mfma_f32_16x16x32_bf16 v[72:75], v[100:103], v[104:107], v[72:75]
  v_mfma_f32_16x16x32_bf16 v[76:79], v[100:103], v[108:111], v[76:79]
  v_mfma_f32_16x16x32_bf16 v[80:83], v[100:103], v[112:115], v[80:83]
  v_mfma_f32_16x16x32_bf16 v[84:87], v[100:103], v[116:119], v[84:87]
  v_mfma_f32_16x16x32_bf16 v[152:155], v[168:171], v[104:107], v[152:155]
  v_mfma_f32_16x16x32_bf16 v[156:159], v[168:171], v[108:111], v[156:159]
  v_mfma_f32_16x16x32_bf16 v[160:163], v[168:171], v[112:115], v[160:163]
  v_mfma_f32_16x16x32_bf16 v[164:167], v[168:171], v[116:119], v[164:167]
  s_waitcnt lgkmcnt(0)
  v_mfma_f32_16x16x32_bf16 v[24:27], v[120:123], v[136:139], v[24:27]
  v_mfma_f32_16x16x32_bf16 v[28:31], v[120:123], v[140:143], v[28:31]
  s_barrier
  v_mfma_f32_16x16x32_bf16 v[32:35], v[120:123], v[144:147], v[32:35]
  ds_read_b128 v[88:91], v8 offset:32768
  v_mfma_f32_16x16x32_bf16 v[36:39], v[120:123], v[148:151], v[36:39]
  ds_read_b128 v[104:107], v10 offset:12288
  v_mfma_f32_16x16x32_bf16 v[40:43], v[124:127], v[136:139], v[40:43]
  ds_read_b128 v[92:95], v8 offset:34816
  v_mfma_f32_16x16x32_bf16 v[44:47], v[124:127], v[140:143], v[44:47]
  ds_read_b128 v[108:111], v10 offset:13312
  v_mfma_f32_16x16x32_bf16 v[48:51], v[124:127], v[144:147], v[48:51]
  ds_read_b128 v[96:99], v8 offset:36864
  v_mfma_f32_16x16x32_bf16 v[52:55], v[124:127], v[148:151], v[52:55]
  ds_read_b128 v[112:115], v10 offset:14336
  v_mfma_f32_16x16x32_bf16 v[56:59], v[128:131], v[136:139], v[56:59]
  ds_read_b128 v[100:103], v8 offset:38912
  v_mfma_f32_16x16x32_bf16 v[60:63], v[128:131], v[140:143], v[60:63]
  ds_read_b128 v[116:119], v10 offset:15360
  v_mfma_f32_16x16x32_bf16 v[64:67], v[128:131], v[144:147], v[64:67]
  v_mfma_f32_16x16x32_bf16 v[68:71], v[128:131], v[148:151], v[68:71]
  v_mfma_f32_16x16x32_bf16 v[72:75], v[132:135], v[136:139], v[72:75]
  v_mfma_f32_16x16x32_bf16 v[76:79], v[132:135], v[140:143], v[76:79]
  v_mfma_f32_16x16x32_bf16 v[80:83], v[132:135], v[144:147], v[80:83]
  v_mfma_f32_16x16x32_bf16 v[84:87], v[132:135], v[148:151], v[84:87]
  v_mfma_f32_16x16x32_bf16 v[152:155], v[168:171], v[136:139], v[152:155]
  v_mfma_f32_16x16x32_bf16 v[156:159], v[168:171], v[140:143], v[156:159]
  v_mfma_f32_16x16x32_bf16 v[160:163], v[168:171], v[144:147], v[160:163]
  v_mfma_f32_16x16x32_bf16 v[164:167], v[168:171], v[148:151], v[164:167]
  s_waitcnt lgkmcnt(0)
  v_mfma_f32_16x16x32_bf16 v[24:27], v[88:91], v[104:107], v[24:27]
  ds_read_b128 v[120:123], v9 offset:32768
  v_mfma_f32_16x16x32_bf16 v[28:31], v[88:91], v[108:111], v[28:31]
  ds_read_b128 v[136:139], v10 offset:16384
  v_mfma_f32_16x16x32_bf16 v[32:35], v[88:91], v[112:115], v[32:35]
  ds_read_b128 v[124:127], v9 offset:34816
  v_mfma_f32_16x16x32_bf16 v[36:39], v[88:91], v[116:119], v[36:39]
  ds_read_b128 v[140:143], v10 offset:17408
  v_mfma_f32_16x16x32_bf16 v[40:43], v[92:95], v[104:107], v[40:43]
  ds_read_b128 v[128:131], v9 offset:36864
  v_mfma_f32_16x16x32_bf16 v[44:47], v[92:95], v[108:111], v[44:47]
  ds_read_b128 v[144:147], v10 offset:18432
  v_mfma_f32_16x16x32_bf16 v[48:51], v[92:95], v[112:115], v[48:51]
  ds_read_b128 v[132:135], v9 offset:38912
  v_mfma_f32_16x16x32_bf16 v[52:55], v[92:95], v[116:119], v[52:55]
  ds_read_b128 v[148:151], v10 offset:19456
  v_mfma_f32_16x16x32_bf16 v[56:59], v[96:99], v[104:107], v[56:59]
  v_mfma_f32_16x16x32_bf16 v[60:63], v[96:99], v[108:111], v[60:63]
  v_mfma_f32_16x16x32_bf16 v[64:67], v[96:99], v[112:115], v[64:67]
  v_mfma_f32_16x16x32_bf16 v[68:71], v[96:99], v[116:119], v[68:71]
  v_mfma_f32_16x16x32_bf16 v[72:75], v[100:103], v[104:107], v[72:75]
  v_mfma_f32_16x16x32_bf16 v[76:79], v[100:103], v[108:111], v[76:79]
  v_mfma_f32_16x16x32_bf16 v[80:83], v[100:103], v[112:115], v[80:83]
  v_mfma_f32_16x16x32_bf16 v[84:87], v[100:103], v[116:119], v[84:87]
  v_mfma_f32_16x16x32_bf16 v[152:155], v[168:171], v[104:107], v[152:155]
  v_mfma_f32_16x16x32_bf16 v[156:159], v[168:171], v[108:111], v[156:159]
  v_mfma_f32_16x16x32_bf16 v[160:163], v[168:171], v[112:115], v[160:163]
  v_mfma_f32_16x16x32_bf16 v[164:167], v[168:171], v[116:119], v[164:167]
  s_waitcnt lgkmcnt(0)
  v_mfma_f32_16x16x32_bf16 v[24:27], v[120:123], v[136:139], v[24:27]
  v_mfma_f32_16x16x32_bf16 v[28:31], v[120:123], v[140:143], v[28:31]
  s_barrier
  v_mfma_f32_16x16x32_bf16 v[32:35], v[120:123], v[144:147], v[32:35]
  ds_read_b128 v[88:91], v22 offset:0
  v_mfma_f32_16x16x32_bf16 v[36:39], v[120:123], v[148:151], v[36:39]
  ds_read_b128 v[104:107], v10 offset:20480
  v_mfma_f32_16x16x32_bf16 v[40:43], v[124:127], v[136:139], v[40:43]
  ds_read_b128 v[92:95], v22 offset:2048
  v_mfma_f32_16x16x32_bf16 v[44:47], v[124:127], v[140:143], v[44:47]
  ds_read_b128 v[108:111], v10 offset:21504
  v_mfma_f32_16x16x32_bf16 v[48:51], v[124:127], v[144:147], v[48:51]
  ds_read_b128 v[96:99], v22 offset:4096
  v_mfma_f32_16x16x32_bf16 v[52:55], v[124:127], v[148:151], v[52:55]
  ds_read_b128 v[112:115], v10 offset:22528
  v_mfma_f32_16x16x32_bf16 v[56:59], v[128:131], v[136:139], v[56:59]
  ds_read_b128 v[100:103], v22 offset:6144
  v_mfma_f32_16x16x32_bf16 v[60:63], v[128:131], v[140:143], v[60:63]
  ds_read_b128 v[116:119], v10 offset:23552
  v_mfma_f32_16x16x32_bf16 v[64:67], v[128:131], v[144:147], v[64:67]
  v_mfma_f32_16x16x32_bf16 v[68:71], v[128:131], v[148:151], v[68:71]
  v_mfma_f32_16x16x32_bf16 v[72:75], v[132:135], v[136:139], v[72:75]
  v_mfma_f32_16x16x32_bf16 v[76:79], v[132:135], v[140:143], v[76:79]
  v_mfma_f32_16x16x32_bf16 v[80:83], v[132:135], v[144:147], v[80:83]
  v_mfma_f32_16x16x32_bf16 v[84:87], v[132:135], v[148:151], v[84:87]
  v_mfma_f32_16x16x32_bf16 v[152:155], v[168:171], v[136:139], v[152:155]
  v_mfma_f32_16x16x32_bf16 v[156:159], v[168:171], v[140:143], v[156:159]
  v_mfma_f32_16x16x32_bf16 v[160:163], v[168:171], v[144:147], v[160:163]
  v_mfma_f32_16x16x32_bf16 v[164:167], v[168:171], v[148:151], v[164:167]
  s_waitcnt lgkmcnt(0)
  v_mfma_f32_16x16x32_bf16 v[24:27], v[88:91], v[104:107], v[24:27]
  ds_read_b128 v[120:123], v23 offset:0
  v_mfma_f32_16x16x32_bf16 v[28:31], v[88:91], v[108:111], v[28:31]
  ds_read_b128 v[136:139], v10 offset:24576
  v_mfma_f32_16x16x32_bf16 v[32:35], v[88:91], v[112:115], v[32:35]
  ds_read_b128 v[124:127], v23 offset:2048
  v_mfma_f32_16x16x32_bf16 v[36:39], v[88:91], v[116:119], v[36:39]
  ds_read_b128 v[140:143], v10 offset:25600
  v_mfma_f32_16x16x32_bf16 v[40:43], v[92:95], v[104:107], v[40:43]
  ds_read_b128 v[128:131], v23 offset:4096
  v_mfma_f32_16x16x32_bf16 v[44:47], v[92:95], v[108:111], v[44:47]
  ds_read_b128 v[144:147], v10 offset:26624
  v_mfma_f32_16x16x32_bf16 v[48:51], v[92:95], v[112:115], v[48:51]
  ds_read_b128 v[132:135], v23 offset:6144
  v_mfma_f32_16x16x32_bf16 v[52:55], v[92:95], v[116:119], v[52:55]
  ds_read_b128 v[148:151], v10 offset:27648
  v_mfma_f32_16x16x32_bf16 v[56:59], v[96:99], v[104:107], v[56:59]
  v_mfma_f32_16x16x32_bf16 v[60:63], v[96:99], v[108:111], v[60:63]
  v_mfma_f32_16x16x32_bf16 v[64:67], v[96:99], v[112:115], v[64:67]
  v_mfma_f32_16x16x32_bf16 v[68:71], v[96:99], v[116:119], v[68:71]
  v_mfma_f32_16x16x32_bf16 v[72:75], v[100:103], v[104:107], v[72:75]
  v_mfma_f32_16x16x32_bf16 v[76:79], v[100:103], v[108:111], v[76:79]
  v_mfma_f32_16x16x32_bf16 v[80:83], v[100:103], v[112:115], v[80:83]
  v_mfma_f32_16x16x32_bf16 v[84:87], v[100:103], v[116:119], v[84:87]
  v_mfma_f32_16x16x32_bf16 v[152:155], v[168:171], v[104:107], v[152:155]
  v_mfma_f32_16x16x32_bf16 v[156:159], v[168:171], v[108:111], v[156:159]
  v_mfma_f32_16x16x32_bf16 v[160:163], v[168:171], v[112:115], v[160:163]
  v_mfma_f32_16x16x32_bf16 v[164:167], v[168:171], v[116:119], v[164:167]
  s_waitcnt lgkmcnt(0)
  v_mfma_f32_16x16x32_bf16 v[24:27], v[120:123], v[136:139], v[24:27]
  v_mfma_f32_16x16x32_bf16 v[28:31], v[120:123], v[140:143], v[28:31]
  s_barrier
  v_mfma_f32_16x16x32_bf16 v[32:35], v[120:123], v[144:147], v[32:35]
  ds_read_b128 v[88:91], v8 offset:0
  v_mfma_f32_16x16x32_bf16 v[36:39], v[120:123], v[148:151], v[36:39]
  ds_read_b128 v[104:107], v10 offset:28672
  v_mfma_f32_16x16x32_bf16 v[40:43], v[124:127], v[136:139], v[40:43]
  ds_read_b128 v[92:95], v8 offset:2048
  v_mfma_f32_16x16x32_bf16 v[44:47], v[124:127], v[140:143], v[44:47]
  ds_read_b128 v[108:111], v10 offset:29696
  v_mfma_f32_16x16x32_bf16 v[48:51], v[124:127], v[144:147], v[48:51]
  ds_read_b128 v[96:99], v8 offset:4096
  v_mfma_f32_16x16x32_bf16 v[52:55], v[124:127], v[148:151], v[52:55]
  ds_read_b128 v[112:115], v10 offset:30720
  v_mfma_f32_16x16x32_bf16 v[56:59], v[128:131], v[136:139], v[56:59]
  ds_read_b128 v[100:103], v8 offset:6144
  v_mfma_f32_16x16x32_bf16 v[60:63], v[128:131], v[140:143], v[60:63]
  ds_read_b128 v[116:119], v10 offset:31744
  v_mfma_f32_16x16x32_bf16 v[64:67], v[128:131], v[144:147], v[64:67]
  v_mfma_f32_16x16x32_bf16 v[68:71], v[128:131], v[148:151], v[68:71]
  v_mfma_f32_16x16x32_bf16 v[72:75], v[132:135], v[136:139], v[72:75]
  v_mfma_f32_16x16x32_bf16 v[76:79], v[132:135], v[140:143], v[76:79]
  v_mfma_f32_16x16x32_bf16 v[80:83], v[132:135], v[144:147], v[80:83]
  v_mfma_f32_16x16x32_bf16 v[84:87], v[132:135], v[148:151], v[84:87]
  v_mfma_f32_16x16x32_bf16 v[152:155], v[168:171], v[136:139], v[152:155]
  v_mfma_f32_16x16x32_bf16 v[156:159], v[168:171], v[140:143], v[156:159]
  v_mfma_f32_16x16x32_bf16 v[160:163], v[168:171], v[144:147], v[160:163]
  v_mfma_f32_16x16x32_bf16 v[164:167], v[168:171], v[148:151], v[164:167]
  s_waitcnt lgkmcnt(0)
  v_mfma_f32_16x16x32_bf16 v[24:27], v[88:91], v[104:107], v[24:27]
  ds_read_b128 v[120:123], v9 offset:0
  v_mfma_f32_16x16x32_bf16 v[28:31], v[88:91], v[108:111], v[28:31]
  ds_read_b128 v[136:139], v10 offset:32768
  v_mfma_f32_16x16x32_bf16 v[32:35], v[88:91], v[112:115], v[32:35]
  ds_read_b128 v[124:127], v9 offset:2048
  v_mfma_f32_16x16x32_bf16 v[36:39], v[88:91], v[116:119], v[36:39]
  ds_read_b128 v[140:143], v10 offset:33792
  v_mfma_f32_16x16x32_bf16 v[40:43], v[92:95], v[104:107], v[40:43]
  ds_read_b128 v[128:131], v9 offset:4096
  v_mfma_f32_16x16x32_bf16 v[44:47], v[92:95], v[108:111], v[44:47]
  ds_read_b128 v[144:147], v10 offset:34816
  v_mfma_f32_16x16x32_bf16 v[48:51], v[92:95], v[112:115], v[48:51]
  ds_read_b128 v[132:135], v9 offset:6144
  v_mfma_f32_16x16x32_bf16 v[52:55], v[92:95], v[116:119], v[52:55]
  ds_read_b128 v[148:151], v10 offset:35840
  v_mfma_f32_16x16x32_bf16 v[56:59], v[96:99], v[104:107], v[56:59]
  v_mfma_f32_16x16x32_bf16 v[60:63], v[96:99], v[108:111], v[60:63]
  v_mfma_f32_16x16x32_bf16 v[64:67], v[96:99], v[112:115], v[64:67]
  v_mfma_f32_16x16x32_bf16 v[68:71], v[96:99], v[116:119], v[68:71]
  v_mfma_f32_16x16x32_bf16 v[72:75], v[100:103], v[104:107], v[72:75]
  v_mfma_f32_16x16x32_bf16 v[76:79], v[100:103], v[108:111], v[76:79]
  v_mfma_f32_16x16x32_bf16 v[80:83], v[100:103], v[112:115], v[80:83]
  v_mfma_f32_16x16x32_bf16 v[84:87], v[100:103], v[116:119], v[84:87]
  v_mfma_f32_16x16x32_bf16 v[152:155], v[168:171], v[104:107], v[152:155]
  v_mfma_f32_16x16x32_bf16 v[156:159], v[168:171], v[108:111], v[156:159]
  v_mfma_f32_16x16x32_bf16 v[160:163], v[168:171], v[112:115], v[160:163]
  v_mfma_f32_16x16x32_bf16 v[164:167], v[168:171], v[116:119], v[164:167]
  s_waitcnt lgkmcnt(0)
  v_mfma_f32_16x16x32_bf16 v[24:27], v[120:123], v[136:139], v[24:27]
  v_mfma_f32_16x16x32_bf16 v[28:31], v[120:123], v[140:143], v[28:31]
  v_mfma_f32_16x16x32_bf16 v[32:35], v[120:123], v[144:147], v[32:35]
  v_mfma_f32_16x16x32_bf16 v[36:39], v[120:123], v[148:151], v[36:39]
  v_mfma_f32_16x16x32_bf16 v[40:43], v[124:127], v[136:139], v[40:43]
  v_mfma_f32_16x16x32_bf16 v[44:47], v[124:127], v[140:143], v[44:47]
  v_mfma_f32_16x16x32_bf16 v[48:51], v[124:127], v[144:147], v[48:51]
  v_mfma_f32_16x16x32_bf16 v[52:55], v[124:127], v[148:151], v[52:55]
  v_mfma_f32_16x16x32_bf16 v[56:59], v[128:131], v[136:139], v[56:59]
  v_mfma_f32_16x16x32_bf16 v[60:63], v[128:131], v[140:143], v[60:63]
  v_mfma_f32_16x16x32_bf16 v[64:67], v[128:131], v[144:147], v[64:67]
  v_mfma_f32_16x16x32_bf16 v[68:71], v[128:131], v[148:151], v[68:71]
  v_mfma_f32_16x16x32_bf16 v[72:75], v[132:135], v[136:139], v[72:75]
  v_mfma_f32_16x16x32_bf16 v[76:79], v[132:135], v[140:143], v[76:79]
  v_mfma_f32_16x16x32_bf16 v[80:83], v[132:135], v[144:147], v[80:83]
  v_mfma_f32_16x16x32_bf16 v[84:87], v[132:135], v[148:151], v[84:87]
  v_mfma_f32_16x16x32_bf16 v[152:155], v[168:171], v[136:139], v[152:155]
  v_mfma_f32_16x16x32_bf16 v[156:159], v[168:171], v[140:143], v[156:159]
  v_mfma_f32_16x16x32_bf16 v[160:163], v[168:171], v[144:147], v[160:163]
  v_mfma_f32_16x16x32_bf16 v[164:167], v[168:171], v[148:151], v[164:167]
  s_barrier
  s_nop 7
  s_lshl_b32 s37, s33, 8
  v_lshl_add_u32 v4, v3, 4, s37

  ds_read_b128 v[88:91], v4 offset:0
  ds_read_b128 v[104:107], v4 offset:1024
  ds_read_b128 v[92:95], v4 offset:64
  ds_read_b128 v[108:111], v4 offset:1088
  ds_read_b128 v[96:99], v4 offset:128
  ds_read_b128 v[112:115], v4 offset:1152
  ds_read_b128 v[100:103], v4 offset:192
  ds_read_b128 v[116:119], v4 offset:1216
  s_mul_i32 s37, s33, 2560
  v_and_b32 v5, 7, v2
  v_xor_b32 v5, v5, v3
  v_lshlrev_b32 v5, 3, v5
  v_lshl_add_u32 v5, v2, 6, v5
  s_add_u32 s38, s37, 126976
  v_add_u32 v8, s38, v5
  v_xor_b32 v16, 32, v8
  s_add_u32 s38, s37, 96256
  v_add_u32 v9, s38, v5
  v_xor_b32 v17, 32, v9
  v_and_b32 v6, 1, v3
  v_mul_u32_u24 v6, 320, v6
  v_lshrrev_b32 v7, 1, v3
  v_lshl_add_u32 v6, v7, 3, v6
  v_lshl_add_u32 v7, v2, 4, v6
  s_add_u32 s38, s37, 116736
  v_add_u32 v10, s38, v7
  v_and_b32 v5, 3, v2
  v_add_u32 v7, 16, v5
  v_lshl_add_u32 v12, v7, 4, v6
  v_add_u32 v12, s38, v12
  v_xor_b32 v5, v5, v3
  v_lshlrev_b32 v5, 3, v5
  v_lshl_add_u32 v11, v7, 6, v5
  v_mov_b32 v5, 126976
  v_mov_b32 v6, 96256
  v_cmp_gt_u32 vcc, 4, v2
  s_nop 1
  v_cndmask_b32 v5, v6, v5, vcc
  v_add_u32 v11, v11, v5
  v_add_u32 v11, s37, v11
  v_xor_b32 v18, 32, v11
  v_mov_b32 v14, 1.0
  v_mov_b32 v15, 0x3ea52b5c
  v_cndmask_b32 v14, v14, v15, vcc
  s_mov_b32 s60, 0x3ea52b5c
  s_mov_b32 s61, 0x3ea52b5c
  s_mov_b32 s56, 0x00ff00ff
  s_mov_b32 s57, 0x00ff00ff
  s_mov_b32 s58, 0x0f000f00
  s_mov_b32 s59, 0x0f000f00
  s_waitcnt vmcnt(0) lgkmcnt(0)

  v_pk_mul_f32 v[88:89], v[88:89], v[104:105]
  v_pk_mul_f32 v[90:91], v[90:91], v[106:107]
  v_pk_mul_f32 v[92:93], v[92:93], v[108:109]
  v_pk_mul_f32 v[94:95], v[94:95], v[110:111]
  v_pk_mul_f32 v[96:97], v[96:97], v[112:113]
  v_pk_mul_f32 v[98:99], v[98:99], v[114:115]
  v_pk_mul_f32 v[100:101], v[100:101], v[116:117]
  v_pk_mul_f32 v[102:103], v[102:103], v[118:119]
  v_pk_mul_f32 v[180:181], v[88:89], v[152:153] op_sel_hi:[1,0]
  v_pk_mul_f32 v[182:183], v[90:91], v[152:153] op_sel_hi:[1,0]
  v_pk_mul_f32 v[184:185], v[88:89], v[156:157] op_sel_hi:[1,0]
  v_pk_mul_f32 v[186:187], v[90:91], v[156:157] op_sel_hi:[1,0]
  v_pk_fma_f32 v[24:25], v[104:105], v[24:25], v[180:181] neg_lo:[0,0,1] neg_hi:[0,0,1]
  v_pk_fma_f32 v[26:27], v[106:107], v[26:27], v[182:183] neg_lo:[0,0,1] neg_hi:[0,0,1]
  v_pk_mul_f32 v[180:181], v[88:89], v[160:161] op_sel_hi:[1,0]
  v_pk_mul_f32 v[182:183], v[90:91], v[160:161] op_sel_hi:[1,0]
  v_pk_fma_f32 v[28:29], v[104:105], v[28:29], v[184:185] neg_lo:[0,0,1] neg_hi:[0,0,1]
  v_pk_fma_f32 v[30:31], v[106:107], v[30:31], v[186:187] neg_lo:[0,0,1] neg_hi:[0,0,1]
  v_pk_mul_f32 v[24:25], v[24:25], s[60:61]
  v_pk_mul_f32 v[26:27], v[26:27], s[60:61]
  v_pk_mul_f32 v[184:185], v[88:89], v[164:165] op_sel_hi:[1,0]
  v_pk_mul_f32 v[186:187], v[90:91], v[164:165] op_sel_hi:[1,0]
  v_pk_fma_f32 v[32:33], v[104:105], v[32:33], v[180:181] neg_lo:[0,0,1] neg_hi:[0,0,1]
  v_pk_fma_f32 v[34:35], v[106:107], v[34:35], v[182:183] neg_lo:[0,0,1] neg_hi:[0,0,1]
  v_cvt_pk_bf16_f32 v120, v24, v25
  v_cvt_pk_bf16_f32 v121, v26, v27
  v_pk_mul_f32 v[180:181], v[92:93], v[152:153] op_sel_hi:[1,0]
  v_pk_mul_f32 v[182:183], v[94:95], v[152:153] op_sel_hi:[1,0]
  v_pk_fma_f32 v[36:37], v[104:105], v[36:37], v[184:185] neg_lo:[0,0,1] neg_hi:[0,0,1]
  v_pk_fma_f32 v[38:39], v[106:107], v[38:39], v[186:187] neg_lo:[0,0,1] neg_hi:[0,0,1]
  v_cvt_pk_bf16_f32 v122, v28, v29
  v_cvt_pk_bf16_f32 v123, v30, v31
  ds_write_b64 v8, v[120:121] offset:0
  v_pk_mul_f32 v[184:185], v[92:93], v[156:157] op_sel_hi:[1,0]
  v_pk_mul_f32 v[186:187], v[94:95], v[156:157] op_sel_hi:[1,0]
  v_pk_fma_f32 v[40:41], v[108:109], v[40:41], v[180:181] neg_lo:[0,0,1] neg_hi:[0,0,1]
  v_pk_fma_f32 v[42:43], v[110:111], v[42:43], v[182:183] neg_lo:[0,0,1] neg_hi:[0,0,1]
  v_pk_mul_f32 v[36:37], v[36:37], v[14:15] op_sel_hi:[1,0]
  v_pk_mul_f32 v[38:39], v[38:39], v[14:15] op_sel_hi:[1,0]
  v_cvt_pk_bf16_f32 v124, v32, v33
  v_cvt_pk_bf16_f32 v125, v34, v35
  ds_write_b64 v9, v[122:123] offset:0
  v_pk_mul_f32 v[180:181], v[92:93], v[160:161] op_sel_hi:[1,0]
  v_pk_mul_f32 v[182:183], v[94:95], v[160:161] op_sel_hi:[1,0]
  v_pk_fma_f32 v[44:45], v[108:109], v[44:45], v[184:185] neg_lo:[0,0,1] neg_hi:[0,0,1]
  v_pk_fma_f32 v[46:47], v[110:111], v[46:47], v[186:187] neg_lo:[0,0,1] neg_hi:[0,0,1]
  v_pk_mul_f32 v[40:41], v[40:41], s[60:61]
  v_pk_mul_f32 v[42:43], v[42:43], s[60:61]
  v_cvt_pk_bf16_f32 v126, v36, v37
  v_cvt_pk_bf16_f32 v127, v38, v39
  ds_write_b64 v10, v[124:125] offset:0
  v_pk_mul_f32 v[184:185], v[92:93], v[164:165] op_sel_hi:[1,0]
  v_pk_mul_f32 v[186:187], v[94:95], v[164:165] op_sel_hi:[1,0]
  v_pk_fma_f32 v[48:49], v[108:109], v[48:49], v[180:181] neg_lo:[0,0,1] neg_hi:[0,0,1]
  v_pk_fma_f32 v[50:51], v[110:111], v[50:51], v[182:183] neg_lo:[0,0,1] neg_hi:[0,0,1]
  v_cvt_pk_bf16_f32 v128, v40, v41
  v_cvt_pk_bf16_f32 v129, v42, v43
  s_mov_b64 exec, s[56:57]
  ds_write_b64 v11, v[126:127] offset:0
  s_mov_b64 exec, s[58:59]
  ds_write_b64 v12, v[126:127] offset:0
  s_mov_b64 exec, -1
  v_pk_mul_f32 v[180:181], v[96:97], v[152:153] op_sel_hi:[1,0]
  v_pk_mul_f32 v[182:183], v[98:99], v[152:153] op_sel_hi:[1,0]
  v_pk_fma_f32 v[52:53], v[108:109], v[52:53], v[184:185] neg_lo:[0,0,1] neg_hi:[0,0,1]
  v_pk_fma_f32 v[54:55], v[110:111], v[54:55], v[186:187] neg_lo:[0,0,1] neg_hi:[0,0,1]
  v_cvt_pk_bf16_f32 v130, v44, v45
  v_cvt_pk_bf16_f32 v131, v46, v47
  ds_write_b64 v16, v[128:129] offset:0
  v_pk_mul_f32 v[184:185], v[96:97], v[156:157] op_sel_hi:[1,0]
  v_pk_mul_f32 v[186:187], v[98:99], v[156:157] op_sel_hi:[1,0]
  v_pk_fma_f32 v[56:57], v[112:113], v[56:57], v[180:181] neg_lo:[0,0,1] neg_hi:[0,0,1]
  v_pk_fma_f32 v[58:59], v[114:115], v[58:59], v[182:183] neg_lo:[0,0,1] neg_hi:[0,0,1]
  v_pk_mul_f32 v[52:53], v[52:53], v[14:15] op_sel_hi:[1,0]
  v_pk_mul_f32 v[54:55], v[54:55], v[14:15] op_sel_hi:[1,0]
  v_cvt_pk_bf16_f32 v132, v48, v49
  v_cvt_pk_bf16_f32 v133, v50, v51
  ds_write_b64 v17, v[130:131] offset:0
  v_pk_mul_f32 v[180:181], v[96:97], v[160:161] op_sel_hi:[1,0]
  v_pk_mul_f32 v[182:183], v[98:99], v[160:161] op_sel_hi:[1,0]
  v_pk_fma_f32 v[60:61], v[112:113], v[60:61], v[184:185] neg_lo:[0,0,1] neg_hi:[0,0,1]
  v_pk_fma_f32 v[62:63], v[114:115], v[62:63], v[186:187] neg_lo:[0,0,1] neg_hi:[0,0,1]
  v_pk_mul_f32 v[56:57], v[56:57], s[60:61]
  v_pk_mul_f32 v[58:59], v[58:59], s[60:61]
  v_cvt_pk_bf16_f32 v134, v52, v53
  v_cvt_pk_bf16_f32 v135, v54, v55
  ds_write_b64 v10, v[132:133] offset:640
  v_pk_mul_f32 v[184:185], v[96:97], v[164:165] op_sel_hi:[1,0]
  v_pk_mul_f32 v[186:187], v[98:99], v[164:165] op_sel_hi:[1,0]
  v_pk_fma_f32 v[64:65], v[112:113], v[64:65], v[180:181] neg_lo:[0,0,1] neg_hi:[0,0,1]
  v_pk_fma_f32 v[66:67], v[114:115], v[66:67], v[182:183] neg_lo:[0,0,1] neg_hi:[0,0,1]
  v_cvt_pk_bf16_f32 v120, v56, v57
  v_cvt_pk_bf16_f32 v121, v58, v59
  s_mov_b64 exec, s[56:57]
  ds_write_b64 v18, v[134:135] offset:0
  s_mov_b64 exec, s[58:59]
  ds_write_b64 v12, v[134:135] offset:640
  s_mov_b64 exec, -1
  v_pk_mul_f32 v[180:181], v[100:101], v[152:153] op_sel_hi:[1,0]
  v_pk_mul_f32 v[182:183], v[102:103], v[152:153] op_sel_hi:[1,0]
  v_pk_fma_f32 v[68:69], v[112:113], v[68:69], v[184:185] neg_lo:[0,0,1] neg_hi:[0,0,1]
  v_pk_fma_f32 v[70:71], v[114:115], v[70:71], v[186:187] neg_lo:[0,0,1] neg_hi:[0,0,1]
  v_cvt_pk_bf16_f32 v122, v60, v61
  v_cvt_pk_bf16_f32 v123, v62, v63
  ds_write_b64 v8, v[120:121] offset:1280
  v_pk_mul_f32 v[184:185], v[100:101], v[156:157] op_sel_hi:[1,0]
  v_pk_mul_f32 v[186:187], v[102:103], v[156:157] op_sel_hi:[1,0]
  v_pk_fma_f32 v[72:73], v[116:117], v[72:73], v[180:181] neg_lo:[0,0,1] neg_hi:[0,0,1]
  v_pk_fma_f32 v[74:75], v[118:119], v[74:75], v[182:183] neg_lo:[0,0,1] neg_hi:[0,0,1]
  v_pk_mul_f32 v[68:69], v[68:69], v[14:15] op_sel_hi:[1,0]
  v_pk_mul_f32 v[70:71], v[70:71], v[14:15] op_sel_hi:[1,0]
  v_cvt_pk_bf16_f32 v124, v64, v65
  v_cvt_pk_bf16_f32 v125, v66, v67
  ds_write_b64 v9, v[122:123] offset:1280
  v_pk_mul_f32 v[180:181], v[100:101], v[160:161] op_sel_hi:[1,0]
  v_pk_mul_f32 v[182:183], v[102:103], v[160:161] op_sel_hi:[1,0]
  v_pk_fma_f32 v[76:77], v[116:117], v[76:77], v[184:185] neg_lo:[0,0,1] neg_hi:[0,0,1]
  v_pk_fma_f32 v[78:79], v[118:119], v[78:79], v[186:187] neg_lo:[0,0,1] neg_hi:[0,0,1]
  v_pk_mul_f32 v[72:73], v[72:73], s[60:61]
  v_pk_mul_f32 v[74:75], v[74:75], s[60:61]
  v_cvt_pk_bf16_f32 v126, v68, v69
  v_cvt_pk_bf16_f32 v127, v70, v71
  ds_write_b64 v10, v[124:125] offset:1280
  v_pk_mul_f32 v[184:185], v[100:101], v[164:165] op_sel_hi:[1,0]
  v_pk_mul_f32 v[186:187], v[102:103], v[164:165] op_sel_hi:[1,0]
  v_pk_fma_f32 v[80:81], v[116:117], v[80:81], v[180:181] neg_lo:[0,0,1] neg_hi:[0,0,1]
  v_pk_fma_f32 v[82:83], v[118:119], v[82:83], v[182:183] neg_lo:[0,0,1] neg_hi:[0,0,1]
  v_cvt_pk_bf16_f32 v128, v72, v73
  v_cvt_pk_bf16_f32 v129, v74, v75
  s_mov_b64 exec, s[56:57]
  ds_write_b64 v11, v[126:127] offset:1280
  s_mov_b64 exec, s[58:59]
  ds_write_b64 v12, v[126:127] offset:1280
  s_mov_b64 exec, -1
  v_pk_fma_f32 v[84:85], v[116:117], v[84:85], v[184:185] neg_lo:[0,0,1] neg_hi:[0,0,1]
  v_pk_fma_f32 v[86:87], v[118:119], v[86:87], v[186:187] neg_lo:[0,0,1] neg_hi:[0,0,1]
  v_cvt_pk_bf16_f32 v130, v76, v77
  v_cvt_pk_bf16_f32 v131, v78, v79
  ds_write_b64 v16, v[128:129] offset:1280
  v_pk_mul_f32 v[84:85], v[84:85], v[14:15] op_sel_hi:[1,0]
  v_pk_mul_f32 v[86:87], v[86:87], v[14:15] op_sel_hi:[1,0]
  v_cvt_pk_bf16_f32 v132, v80, v81
  v_cvt_pk_bf16_f32 v133, v82, v83
  ds_write_b64 v17, v[130:131] offset:1280
  v_cvt_pk_bf16_f32 v134, v84, v85
  v_cvt_pk_bf16_f32 v135, v86, v87
  ds_write_b64 v10, v[132:133] offset:1920
  s_mov_b64 exec, s[56:57]
  ds_write_b64 v18, v[134:135] offset:1280
  s_mov_b64 exec, s[58:59]
  ds_write_b64 v12, v[134:135] offset:1920
  s_mov_b64 exec, -1
  s_waitcnt lgkmcnt(0)
LC_common:
  s_barrier
  s_cmp_ge_u32 s3, 2
  s_cbranch_scc1 Lsa_13
  s_lshl_b32 s35, s48, 5
  s_add_u32 s35, s35, s49
  s_mul_i32 s35, s35, 20480
  s_add_u32 s35, s35, s32
  s_add_u32 s35, s35, 0
  s_mul_i32 s36, s3, 10240
  s_add_u32 s35, s35, s36
  s_mul_i32 s37, s3, 20480
  s_add_u32 s37, s37, 96256
  v_add_u32 v4, s37, v1

  ds_read_b128 v[16:19], v4 offset:0
  ds_read_b128 v[20:23], v4 offset:1024
  ds_read_b128 v[24:27], v4 offset:2048
  ds_read_b128 v[28:31], v4 offset:3072
  ds_read_b128 v[32:35], v4 offset:4096
  ds_read_b128 v[36:39], v4 offset:5120
  ds_read_b128 v[40:43], v4 offset:6144
  ds_read_b128 v[44:47], v4 offset:7168
  ds_read_b128 v[48:51], v4 offset:8192
  ds_read_b128 v[52:55], v4 offset:9216
  s_waitcnt lgkmcnt(9)
  buffer_store_dwordx4 v[16:19], v1, s[16:19], s35 offen sc0 sc1
  s_waitcnt lgkmcnt(8)
  buffer_store_dwordx4 v[20:23], v1, s[16:19], s35 offen offset:1024 sc0 sc1
  s_waitcnt lgkmcnt(7)
  buffer_store_dwordx4 v[24:27], v1, s[16:19], s35 offen offset:2048 sc0 sc1
  s_waitcnt lgkmcnt(6)
  buffer_store_dwordx4 v[28:31], v1, s[16:19], s35 offen offset:3072 sc0 sc1
  s_add_u32 s35, s35, 4096
  s_waitcnt lgkmcnt(5)
  buffer_store_dwordx4 v[32:35], v1, s[16:19], s35 offen sc0 sc1
  s_waitcnt lgkmcnt(4)
  buffer_store_dwordx4 v[36:39], v1, s[16:19], s35 offen offset:1024 sc0 sc1
  s_waitcnt lgkmcnt(3)
  buffer_store_dwordx4 v[40:43], v1, s[16:19], s35 offen offset:2048 sc0 sc1
  s_waitcnt lgkmcnt(2)
  buffer_store_dwordx4 v[44:47], v1, s[16:19], s35 offen offset:3072 sc0 sc1
  s_add_u32 s35, s35, 4096
  s_waitcnt lgkmcnt(1)
  buffer_store_dwordx4 v[48:51], v1, s[16:19], s35 offen sc0 sc1
  s_waitcnt lgkmcnt(0)
  buffer_store_dwordx4 v[52:55], v1, s[16:19], s35 offen offset:1024 sc0 sc1
  s_nop 1
Lsa_13:
  s_sub_u32 s36, 11, s3
  s_cmp_lt_u32 s3, 4
  s_cselect_b32 s50, s3, s36
  s_mul_i32 s38, s50, 1280
  s_add_u32 s37, s38, 86016
  v_lshrrev_b32 v4, 1, v3
  v_bfe_u32 v5, v0, 2, 2
  v_and_b32 v6, 3, v0
  v_and_b32 v7, 1, v3
  v_lshl_add_u32 v7, v7, 2, v6
  v_xor_b32 v7, v7, v5
  v_lshlrev_b32 v7, 3, v7
  v_lshl_add_u32 v6, v4, 3, v5
  v_lshl_add_u32 v8, v6, 6, v7
  v_add_u32 v6, 16, v5
  v_lshl_add_u32 v9, v6, 6, v7
  s_add_u32 s39, s38, 126976
  v_add_u32 v208, s39, v8
  v_add_u32 v209, s39, v9
  v_xor_b32 v210, 32, v208
  v_add_u32 v8, s37, v8
  v_add_u32 v9, s37, v9
  v_xor_b32 v15, 32, v8
  ds_read_b64_tr_b16 v[184:185], v208
  ds_read_b64_tr_b16 v[186:187], v210 offset:256
  ds_read_b64_tr_b16 v[188:189], v209
  v_and_b32 v6, 31, v0
  v_mul_u32_u24 v7, 320, v4
  v_lshl_add_u32 v10, v6, 4, v7
  s_add_u32 s37, s37, 20480
  v_add_u32 v10, s37, v10
  v_lshlrev_b32 v7, 2, v4
  v_sub_u32 v11, v6, v7
  v_mov_b32 v12, 0xf149f2ca
  v_mov_b32 v13, 0
  s_sub_u32 s62, 8, s50
  s_sub_u32 s63, 7, s50
  v_mov_b32 v7, 0x3f803f80
  v_cmp_eq_u32 vcc, 20, v6
  s_nop 1
  v_cndmask_b32 v7, 0, v7, vcc
  s_mov_b32 s56, 0xfffff
  s_mov_b32 s57, 0xfffff

  ds_read_b64_tr_b16 v[160:161], v8 offset:10240
  ds_read_b64_tr_b16 v[162:163], v15 offset:10496
  ds_read_b64_tr_b16 v[164:165], v9 offset:10240
  ds_read_b64_tr_b16 v[154:155], v8 offset:8960
  ds_read_b64_tr_b16 v[156:157], v15 offset:9216
  ds_read_b64_tr_b16 v[158:159], v9 offset:8960
  ds_read_b64_tr_b16 v[148:149], v8 offset:7680
  ds_read_b64_tr_b16 v[150:151], v15 offset:7936
  ds_read_b64_tr_b16 v[152:153], v9 offset:7680
  v_mov_b32 v168, v7
  v_mov_b32 v169, v7
  v_mov_b32 v170, v7
  v_mov_b32 v171, v7
  v_mov_b32 v172, v7
  v_mov_b32 v173, v7
  v_mov_b32 v174, v7
  v_mov_b32 v175, v7
  v_mov_b32 v176, v7
  v_mov_b32 v177, v7
  v_mov_b32 v178, v7
  v_mov_b32 v179, v7
  v_mov_b32 v180, v7
  v_mov_b32 v181, v7
  v_mov_b32 v182, v7
  v_mov_b32 v183, v7
  v_mov_b32 v96, 0
  v_mov_b32 v97, 0
  v_mov_b32 v98, 0
  v_mov_b32 v99, 0
  v_mov_b32 v100, 0
  v_mov_b32 v101, 0
  v_mov_b32 v102, 0
  v_mov_b32 v103, 0
  v_mov_b32 v104, 0
  v_mov_b32 v105, 0
  v_mov_b32 v106, 0
  v_mov_b32 v107, 0
  v_mov_b32 v108, 0
  v_mov_b32 v109, 0
  v_mov_b32 v110, 0
  v_mov_b32 v111, 0
  v_cmp_gt_i32 s[64:65], 0, v11
  v_cmp_gt_i32 s[66:67], 1, v11
  v_cmp_gt_i32 s[68:69], 2, v11
  v_cmp_gt_i32 s[70:71], 3, v11
  s_nop 1
  v_cndmask_b32 v64, v12, v13, s[64:65]
  v_cndmask_b32 v80, v13, v12, s[64:65]
  v_cndmask_b32 v65, v12, v13, s[66:67]
  v_cndmask_b32 v81, v13, v12, s[66:67]
  v_cndmask_b32 v66, v12, v13, s[68:69]
  v_cndmask_b32 v82, v13, v12, s[68:69]
  v_cndmask_b32 v67, v12, v13, s[70:71]
  v_cndmask_b32 v83, v13, v12, s[70:71]
  v_cmp_gt_i32 s[64:65], 8, v11
  v_cmp_gt_i32 s[66:67], 9, v11
  v_cmp_gt_i32 s[68:69], 10, v11
  v_cmp_gt_i32 s[70:71], 11, v11
  s_nop 1
  v_cndmask_b32 v68, v12, v13, s[64:65]
  v_cndmask_b32 v84, v13, v12, s[64:65]
  v_cndmask_b32 v69, v12, v13, s[66:67]
  v_cndmask_b32 v85, v13, v12, s[66:67]
  v_cndmask_b32 v70, v12, v13, s[68:69]
  v_cndmask_b32 v86, v13, v12, s[68:69]
  v_cndmask_b32 v71, v12, v13, s[70:71]
  v_cndmask_b32 v87, v13, v12, s[70:71]
  v_cmp_gt_i32 s[64:65], 16, v11
  v_cmp_gt_i32 s[66:67], 17, v11
  v_cmp_gt_i32 s[68:69], 18, v11
  v_cmp_gt_i32 s[70:71], 19, v11
  s_nop 1
  v_cndmask_b32 v72, v12, v13, s[64:65]
  v_cndmask_b32 v88, v13, v12, s[64:65]
  v_cndmask_b32 v73, v12, v13, s[66:67]
  v_cndmask_b32 v89, v13, v12, s[66:67]
  v_cndmask_b32 v74, v12, v13, s[68:69]
  v_cndmask_b32 v90, v13, v12, s[68:69]
  v_cndmask_b32 v75, v12, v13, s[70:71]
  v_cndmask_b32 v91, v13, v12, s[70:71]
  v_cmp_gt_i32 s[64:65], 24, v11
  v_cmp_gt_i32 s[66:67], 25, v11
  v_cmp_gt_i32 s[68:69], 26, v11
  v_cmp_gt_i32 s[70:71], 27, v11
  s_nop 1
  v_cndmask_b32 v76, v12, v13, s[64:65]
  v_cndmask_b32 v92, v13, v12, s[64:65]
  v_cndmask_b32 v77, v12, v13, s[66:67]
  v_cndmask_b32 v93, v13, v12, s[66:67]
  v_cndmask_b32 v78, v12, v13, s[68:69]
  v_cndmask_b32 v94, v13, v12, s[68:69]
  v_cndmask_b32 v79, v12, v13, s[70:71]
  v_cndmask_b32 v95, v13, v12, s[70:71]
  s_waitcnt lgkmcnt(9)
  s_mov_b32 exec_lo, 0
  v_mov_b32 v188, 0
  v_mov_b32 v189, 0
  s_mov_b32 exec_lo, -1

  v_mov_b32 v4, v12
  v_mov_b32 v5, v12
  v_mov_b32 v6, v12
  v_mov_b32 v7, v12
  v_mov_b32 v32, v12
  v_mov_b32 v33, v12
  v_mov_b32 v34, v12
  v_mov_b32 v35, v12
  v_mov_b32 v36, v12
  v_mov_b32 v37, v12
  v_mov_b32 v38, v12
  v_mov_b32 v39, v12
  v_mov_b32 v40, v12
  v_mov_b32 v41, v12
  v_mov_b32 v42, v12
  v_mov_b32 v43, v12
  v_mov_b32 v44, v12
  v_mov_b32 v45, v12
  v_mov_b32 v46, v12
  v_mov_b32 v47, v12
  s_waitcnt lgkmcnt(6)
  v_mfma_f32_32x32x16_bf16 v[16:31], v[160:163], v[184:187], v[80:95]
  ds_read_b64_tr_b16 v[142:143], v8 offset:6400
  ds_read_b64_tr_b16 v[144:145], v15 offset:6656
  ds_read_b64_tr_b16 v[146:147], v9 offset:6400
  v_mfma_f32_32x32x8_bf16 v[16:31], v[164:165], v[188:189], v[16:31]
  s_cmp_eq_u32 s62, 8
  s_cbranch_scc1 Lx1_14
  s_waitcnt lgkmcnt(6)
  v_mfma_f32_32x32x16_bf16 v[32:47], v[154:157], v[184:187], 0
  ds_read_b64_tr_b16 v[136:137], v8 offset:5120
  ds_read_b64_tr_b16 v[138:139], v15 offset:5376
  ds_read_b64_tr_b16 v[140:141], v9 offset:5120
  s_nop 0
  v_max3_f32 v4, v4, v16, v17
  v_max3_f32 v5, v5, v18, v19
  v_max3_f32 v6, v6, v20, v21
  v_max3_f32 v7, v7, v22, v23
  v_mfma_f32_32x32x8_bf16 v[32:47], v[158:159], v[188:189], v[32:47]
  v_max3_f32 v4, v4, v24, v25
  v_max3_f32 v5, v5, v26, v27
  v_max3_f32 v6, v6, v28, v29
  v_max3_f32 v7, v7, v30, v31
  s_cmp_eq_u32 s62, 7
  s_cbranch_scc1 Lx1_14
  s_waitcnt lgkmcnt(6)
  v_mfma_f32_32x32x16_bf16 v[16:31], v[148:151], v[184:187], 0
  ds_read_b64_tr_b16 v[130:131], v8 offset:3840
  ds_read_b64_tr_b16 v[132:133], v15 offset:4096
  ds_read_b64_tr_b16 v[134:135], v9 offset:3840
  s_nop 0
  v_max3_f32 v4, v4, v32, v33
  v_max3_f32 v5, v5, v34, v35
  v_max3_f32 v6, v6, v36, v37
  v_max3_f32 v7, v7, v38, v39
  v_mfma_f32_32x32x8_bf16 v[16:31], v[152:153], v[188:189], v[16:31]
  v_max3_f32 v4, v4, v40, v41
  v_max3_f32 v5, v5, v42, v43
  v_max3_f32 v6, v6, v44, v45
  v_max3_f32 v7, v7, v46, v47
  s_cmp_eq_u32 s62, 6
  s_cbranch_scc1 Lx1_14
  s_waitcnt lgkmcnt(6)
  v_mfma_f32_32x32x16_bf16 v[32:47], v[142:145], v[184:187], 0
  ds_read_b64_tr_b16 v[124:125], v8 offset:2560
  ds_read_b64_tr_b16 v[126:127], v15 offset:2816
  ds_read_b64_tr_b16 v[128:129], v9 offset:2560
  s_nop 0
  v_max3_f32 v4, v4, v16, v17
  v_max3_f32 v5, v5, v18, v19
  v_max3_f32 v6, v6, v20, v21
  v_max3_f32 v7, v7, v22, v23
  v_mfma_f32_32x32x8_bf16 v[32:47], v[146:147], v[188:189], v[32:47]
  v_max3_f32 v4, v4, v24, v25
  v_max3_f32 v5, v5, v26, v27
  v_max3_f32 v6, v6, v28, v29
  v_max3_f32 v7, v7, v30, v31
  s_cmp_eq_u32 s62, 5
  s_cbranch_scc1 Lx1_14
  s_waitcnt lgkmcnt(6)
  v_mfma_f32_32x32x16_bf16 v[16:31], v[136:139], v[184:187], 0
  ds_read_b64_tr_b16 v[118:119], v8 offset:1280
  ds_read_b64_tr_b16 v[120:121], v15 offset:1536
  ds_read_b64_tr_b16 v[122:123], v9 offset:1280
  s_nop 0
  v_max3_f32 v4, v4, v32, v33
  v_max3_f32 v5, v5, v34, v35
  v_max3_f32 v6, v6, v36, v37
  v_max3_f32 v7, v7, v38, v39
  v_mfma_f32_32x32x8_bf16 v[16:31], v[140:141], v[188:189], v[16:31]
  v_max3_f32 v4, v4, v40, v41
  v_max3_f32 v5, v5, v42, v43
  v_max3_f32 v6, v6, v44, v45
  v_max3_f32 v7, v7, v46, v47
  s_cmp_eq_u32 s62, 4
  s_cbranch_scc1 Lx1_14
  s_waitcnt lgkmcnt(6)
  v_mfma_f32_32x32x16_bf16 v[32:47], v[130:133], v[184:187], 0
  s_nop 3
  v_max3_f32 v4, v4, v16, v17
  v_max3_f32 v5, v5, v18, v19
  v_max3_f32 v6, v6, v20, v21
  v_max3_f32 v7, v7, v22, v23
  v_mfma_f32_32x32x8_bf16 v[32:47], v[134:135], v[188:189], v[32:47]
  v_max3_f32 v4, v4, v24, v25
  v_max3_f32 v5, v5, v26, v27
  v_max3_f32 v6, v6, v28, v29
  v_max3_f32 v7, v7, v30, v31
  s_cmp_eq_u32 s62, 3
  s_cbranch_scc1 Lx1_14
  s_waitcnt lgkmcnt(3)
  v_mfma_f32_32x32x16_bf16 v[16:31], v[124:127], v[184:187], 0
  s_nop 3
  v_max3_f32 v4, v4, v32, v33
  v_max3_f32 v5, v5, v34, v35
  v_max3_f32 v6, v6, v36, v37
  v_max3_f32 v7, v7, v38, v39
  v_mfma_f32_32x32x8_bf16 v[16:31], v[128:129], v[188:189], v[16:31]
  v_max3_f32 v4, v4, v40, v41
  v_max3_f32 v5, v5, v42, v43
  v_max3_f32 v6, v6, v44, v45
  v_max3_f32 v7, v7, v46, v47
  s_cmp_eq_u32 s62, 2
  s_cbranch_scc1 Lx1_14
  s_waitcnt lgkmcnt(0)
  v_mfma_f32_32x32x16_bf16 v[32:47], v[118:121], v[184:187], 0
  s_nop 3
  v_max3_f32 v4, v4, v16, v17
  v_max3_f32 v5, v5, v18, v19
  v_max3_f32 v6, v6, v20, v21
  v_max3_f32 v7, v7, v22, v23
  v_mfma_f32_32x32x8_bf16 v[32:47], v[122:123], v[188:189], v[32:47]
  v_max3_f32 v4, v4, v24, v25
  v_max3_f32 v5, v5, v26, v27
  v_max3_f32 v6, v6, v28, v29
  v_max3_f32 v7, v7, v30, v31
Lx1_14:
  s_nop 13
  v_max3_f32 v4, v4, v16, v17
  v_max3_f32 v5, v5, v18, v19
  v_max3_f32 v6, v6, v20, v21
  v_max3_f32 v7, v7, v22, v23
  v_max3_f32 v4, v4, v24, v25
  v_max3_f32 v5, v5, v26, v27
  v_max3_f32 v6, v6, v28, v29
  v_max3_f32 v7, v7, v30, v31
  v_max3_f32 v4, v4, v32, v33
  v_max3_f32 v5, v5, v34, v35
  v_max3_f32 v6, v6, v36, v37
  v_max3_f32 v7, v7, v38, v39
  v_max3_f32 v4, v4, v40, v41
  v_max3_f32 v5, v5, v42, v43
  v_max3_f32 v6, v6, v44, v45
  v_max3_f32 v7, v7, v46, v47
  v_max3_f32 v4, v4, v5, v6
  v_max_f32 v4, v4, v7
  v_mov_b32 v5, v4
  s_nop 1
  v_permlane32_swap_b32 v4, v5
  s_nop 1
  v_max_f32 v4, v4, v5

  v_mov_b32 v14, v4
  v_sub_f32 v48, 0, v14
  v_sub_f32 v49, 0, v14
  v_sub_f32 v50, 0, v14
  v_sub_f32 v51, 0, v14
  v_sub_f32 v52, 0, v14
  v_sub_f32 v53, 0, v14
  v_sub_f32 v54, 0, v14
  v_sub_f32 v55, 0, v14
  v_sub_f32 v56, 0, v14
  v_sub_f32 v57, 0, v14
  v_sub_f32 v58, 0, v14
  v_sub_f32 v59, 0, v14
  v_sub_f32 v60, 0, v14
  v_sub_f32 v61, 0, v14
  v_sub_f32 v62, 0, v14
  v_sub_f32 v63, 0, v14
  v_sub_f32 v80, v80, v14
  v_sub_f32 v81, v81, v14
  v_sub_f32 v82, v82, v14
  v_sub_f32 v83, v83, v14
  v_sub_f32 v84, v84, v14
  v_sub_f32 v85, v85, v14
  v_sub_f32 v86, v86, v14
  v_sub_f32 v87, v87, v14
  v_sub_f32 v88, v88, v14
  v_sub_f32 v89, v89, v14
  v_sub_f32 v90, v90, v14
  v_sub_f32 v91, v91, v14
  v_sub_f32 v92, v92, v14
  v_sub_f32 v93, v93, v14
  v_sub_f32 v94, v94, v14
  v_sub_f32 v95, v95, v14
  s_waitcnt lgkmcnt(0)
  s_mov_b64 exec, s[56:57]
  ds_read_b128 v[168:171], v10 offset:10240
  ds_read_b128 v[172:175], v10 offset:10880
  s_mov_b64 exec, -1
  v_mfma_f32_32x32x16_bf16 v[16:31], v[160:163], v[184:187], v[80:95]
  v_mfma_f32_32x32x8_bf16 v[16:31], v[164:165], v[188:189], v[16:31]
  s_nop 11
  v_mfma_f32_32x32x16_bf16 v[32:47], v[154:157], v[184:187], v[48:63]
  v_exp_f32 v16, v16
  v_exp_f32 v17, v17
  v_exp_f32 v18, v18
  v_exp_f32 v19, v19
  v_cvt_pk_bf16_f32 v192, v16, v17
  v_mfma_f32_32x32x8_bf16 v[32:47], v[158:159], v[188:189], v[32:47]
  v_exp_f32 v20, v20
  v_exp_f32 v21, v21
  v_cvt_pk_bf16_f32 v193, v18, v19
  v_exp_f32 v22, v22
  v_exp_f32 v23, v23
  v_cvt_pk_bf16_f32 v194, v20, v21
  v_exp_f32 v24, v24
  v_exp_f32 v25, v25
  v_cvt_pk_bf16_f32 v195, v22, v23
  v_exp_f32 v26, v26
  v_exp_f32 v27, v27
  v_cvt_pk_bf16_f32 v196, v24, v25
  v_exp_f32 v28, v28
  v_exp_f32 v29, v29
  v_cvt_pk_bf16_f32 v197, v26, v27
  v_exp_f32 v30, v30
  v_exp_f32 v31, v31
  v_cvt_pk_bf16_f32 v198, v28, v29
  s_nop 0
  v_cvt_pk_bf16_f32 v199, v30, v31
  s_mov_b64 exec, s[56:57]
  ds_read_b128 v[176:179], v10 offset:8960
  ds_read_b128 v[180:183], v10 offset:9600
  s_mov_b64 exec, -1
  s_cmp_eq_u32 s62, 8
  s_cbranch_scc1 Lst_16
  v_mfma_f32_32x32x16_bf16 v[16:31], v[148:151], v[184:187], v[48:63]
  v_exp_f32 v32, v32
  v_exp_f32 v33, v33
  v_exp_f32 v34, v34
  v_exp_f32 v35, v35
  v_cvt_pk_bf16_f32 v200, v32, v33
  s_waitcnt lgkmcnt(2)
  v_mfma_f32_32x32x16_bf16 v[96:111], v[168:171], v[192:195], v[96:111]
  v_exp_f32 v36, v36
  v_exp_f32 v37, v37
  v_cvt_pk_bf16_f32 v201, v34, v35
  v_exp_f32 v38, v38
  v_exp_f32 v39, v39
  v_cvt_pk_bf16_f32 v202, v36, v37
  v_mfma_f32_32x32x8_bf16 v[16:31], v[152:153], v[188:189], v[16:31]
  v_exp_f32 v40, v40
  v_exp_f32 v41, v41
  v_cvt_pk_bf16_f32 v203, v38, v39
  v_exp_f32 v42, v42
  v_exp_f32 v43, v43
  v_cvt_pk_bf16_f32 v204, v40, v41
  v_mfma_f32_32x32x16_bf16 v[96:111], v[172:175], v[196:199], v[96:111]
  v_exp_f32 v44, v44
  v_exp_f32 v45, v45
  v_cvt_pk_bf16_f32 v205, v42, v43
  v_exp_f32 v46, v46
  v_exp_f32 v47, v47
  v_cvt_pk_bf16_f32 v206, v44, v45
  s_nop 0
  v_cvt_pk_bf16_f32 v207, v46, v47
  s_mov_b64 exec, s[56:57]
  ds_read_b128 v[168:171], v10 offset:7680
  ds_read_b128 v[172:175], v10 offset:8320
  s_mov_b64 exec, -1
  s_cmp_eq_u32 s62, 7
  s_cbranch_scc1 Lst_17
  v_mfma_f32_32x32x16_bf16 v[32:47], v[142:145], v[184:187], v[48:63]
  v_exp_f32 v16, v16
  v_exp_f32 v17, v17
  v_exp_f32 v18, v18
  v_exp_f32 v19, v19
  v_cvt_pk_bf16_f32 v192, v16, v17
  s_waitcnt lgkmcnt(2)
  v_mfma_f32_32x32x16_bf16 v[96:111], v[176:179], v[200:203], v[96:111]
  v_exp_f32 v20, v20
  v_exp_f32 v21, v21
  v_cvt_pk_bf16_f32 v193, v18, v19
  v_exp_f32 v22, v22
  v_exp_f32 v23, v23
  v_cvt_pk_bf16_f32 v194, v20, v21
  v_mfma_f32_32x32x8_bf16 v[32:47], v[146:147], v[188:189], v[32:47]
  v_exp_f32 v24, v24
  v_exp_f32 v25, v25
  v_cvt_pk_bf16_f32 v195, v22, v23
  v_exp_f32 v26, v26
  v_exp_f32 v27, v27
  v_cvt_pk_bf16_f32 v196, v24, v25
  v_mfma_f32_32x32x16_bf16 v[96:111], v[180:183], v[204:207], v[96:111]
  v_exp_f32 v28, v28
  v_exp_f32 v29, v29
  v_cvt_pk_bf16_f32 v197, v26, v27
  v_exp_f32 v30, v30
  v_exp_f32 v31, v31
  v_cvt_pk_bf16_f32 v198, v28, v29
  s_nop 0
  v_cvt_pk_bf16_f32 v199, v30, v31
  s_mov_b64 exec, s[56:57]
  ds_read_b128 v[176:179], v10 offset:6400
  ds_read_b128 v[180:183], v10 offset:7040
  s_mov_b64 exec, -1
  s_cmp_eq_u32 s62, 6
  s_cbranch_scc1 Lst_18
  v_mfma_f32_32x32x16_bf16 v[16:31], v[136:139], v[184:187], v[48:63]
  v_exp_f32 v32, v32
  v_exp_f32 v33, v33
  v_exp_f32 v34, v34
  v_exp_f32 v35, v35
  v_cvt_pk_bf16_f32 v200, v32, v33
  s_waitcnt lgkmcnt(2)
  v_mfma_f32_32x32x16_bf16 v[96:111], v[168:171], v[192:195], v[96:111]
  v_exp_f32 v36, v36
  v_exp_f32 v37, v37
  v_cvt_pk_bf16_f32 v201, v34, v35
  v_exp_f32 v38, v38
  v_exp_f32 v39, v39
  v_cvt_pk_bf16_f32 v202, v36, v37
  v_mfma_f32_32x32x8_bf16 v[16:31], v[140:141], v[188:189], v[16:31]
  v_exp_f32 v40, v40
  v_exp_f32 v41, v41
  v_cvt_pk_bf16_f32 v203, v38, v39
  v_exp_f32 v42, v42
  v_exp_f32 v43, v43
  v_cvt_pk_bf16_f32 v204, v40, v41
  v_mfma_f32_32x32x16_bf16 v[96:111], v[172:175], v[196:199], v[96:111]
  v_exp_f32 v44, v44
  v_exp_f32 v45, v45
  v_cvt_pk_bf16_f32 v205, v42, v43
  v_exp_f32 v46, v46
  v_exp_f32 v47, v47
  v_cvt_pk_bf16_f32 v206, v44, v45
  s_nop 0
  v_cvt_pk_bf16_f32 v207, v46, v47
  s_mov_b64 exec, s[56:57]
  ds_read_b128 v[168:171], v10 offset:5120
  ds_read_b128 v[172:175], v10 offset:5760
  s_mov_b64 exec, -1
  s_cmp_eq_u32 s62, 5
  s_cbranch_scc1 Lst_19
  v_mfma_f32_32x32x16_bf16 v[32:47], v[130:133], v[184:187], v[48:63]
  v_exp_f32 v16, v16
  v_exp_f32 v17, v17
  v_exp_f32 v18, v18
  v_exp_f32 v19, v19
  v_cvt_pk_bf16_f32 v192, v16, v17
  s_waitcnt lgkmcnt(2)
  v_mfma_f32_32x32x16_bf16 v[96:111], v[176:179], v[200:203], v[96:111]
  v_exp_f32 v20, v20
  v_exp_f32 v21, v21
  v_cvt_pk_bf16_f32 v193, v18, v19
  v_exp_f32 v22, v22
  v_exp_f32 v23, v23
  v_cvt_pk_bf16_f32 v194, v20, v21
  v_mfma_f32_32x32x8_bf16 v[32:47], v[134:135], v[188:189], v[32:47]
  v_exp_f32 v24, v24
  v_exp_f32 v25, v25
  v_cvt_pk_bf16_f32 v195, v22, v23
  v_exp_f32 v26, v26
  v_exp_f32 v27, v27
  v_cvt_pk_bf16_f32 v196, v24, v25
  v_mfma_f32_32x32x16_bf16 v[96:111], v[180:183], v[204:207], v[96:111]
  v_exp_f32 v28, v28
  v_exp_f32 v29, v29
  v_cvt_pk_bf16_f32 v197, v26, v27
  v_exp_f32 v30, v30
  v_exp_f32 v31, v31
  v_cvt_pk_bf16_f32 v198, v28, v29
  s_nop 0
  v_cvt_pk_bf16_f32 v199, v30, v31
  s_mov_b64 exec, s[56:57]
  ds_read_b128 v[176:179], v10 offset:3840
  ds_read_b128 v[180:183], v10 offset:4480
  s_mov_b64 exec, -1
  s_cmp_eq_u32 s62, 4
  s_cbranch_scc1 Lst_20
  v_mfma_f32_32x32x16_bf16 v[16:31], v[124:127], v[184:187], v[48:63]
  v_exp_f32 v32, v32
  v_exp_f32 v33, v33
  v_exp_f32 v34, v34
  v_exp_f32 v35, v35
  v_cvt_pk_bf16_f32 v200, v32, v33
  s_waitcnt lgkmcnt(2)
  v_mfma_f32_32x32x16_bf16 v[96:111], v[168:171], v[192:195], v[96:111]
  v_exp_f32 v36, v36
  v_exp_f32 v37, v37
  v_cvt_pk_bf16_f32 v201, v34, v35
  v_exp_f32 v38, v38
  v_exp_f32 v39, v39
  v_cvt_pk_bf16_f32 v202, v36, v37
  v_mfma_f32_32x32x8_bf16 v[16:31], v[128:129], v[188:189], v[16:31]
  v_exp_f32 v40, v40
  v_exp_f32 v41, v41
  v_cvt_pk_bf16_f32 v203, v38, v39
  v_exp_f32 v42, v42
  v_exp_f32 v43, v43
  v_cvt_pk_bf16_f32 v204, v40, v41
  v_mfma_f32_32x32x16_bf16 v[96:111], v[172:175], v[196:199], v[96:111]
  v_exp_f32 v44, v44
  v_exp_f32 v45, v45
  v_cvt_pk_bf16_f32 v205, v42, v43
  v_exp_f32 v46, v46
  v_exp_f32 v47, v47
  v_cvt_pk_bf16_f32 v206, v44, v45
  s_nop 0
  v_cvt_pk_bf16_f32 v207, v46, v47
  s_mov_b64 exec, s[56:57]
  ds_read_b128 v[168:171], v10 offset:2560
  ds_read_b128 v[172:175], v10 offset:3200
  s_mov_b64 exec, -1
  s_cmp_eq_u32 s62, 3
  s_cbranch_scc1 Lst_21
  v_mfma_f32_32x32x16_bf16 v[32:47], v[118:121], v[184:187], v[48:63]
  v_exp_f32 v16, v16
  v_exp_f32 v17, v17
  v_exp_f32 v18, v18
  v_exp_f32 v19, v19
  v_cvt_pk_bf16_f32 v192, v16, v17
  s_waitcnt lgkmcnt(2)
  v_mfma_f32_32x32x16_bf16 v[96:111], v[176:179], v[200:203], v[96:111]
  v_exp_f32 v20, v20
  v_exp_f32 v21, v21
  v_cvt_pk_bf16_f32 v193, v18, v19
  v_exp_f32 v22, v22
  v_exp_f32 v23, v23
  v_cvt_pk_bf16_f32 v194, v20, v21
  v_mfma_f32_32x32x8_bf16 v[32:47], v[122:123], v[188:189], v[32:47]
  v_exp_f32 v24, v24
  v_exp_f32 v25, v25
  v_cvt_pk_bf16_f32 v195, v22, v23
  v_exp_f32 v26, v26
  v_exp_f32 v27, v27
  v_cvt_pk_bf16_f32 v196, v24, v25
  v_mfma_f32_32x32x16_bf16 v[96:111], v[180:183], v[204:207], v[96:111]
  v_exp_f32 v28, v28
  v_exp_f32 v29, v29
  v_cvt_pk_bf16_f32 v197, v26, v27
  v_exp_f32 v30, v30
  v_exp_f32 v31, v31
  v_cvt_pk_bf16_f32 v198, v28, v29
  s_nop 0
  v_cvt_pk_bf16_f32 v199, v30, v31
  s_mov_b64 exec, s[56:57]
  ds_read_b128 v[176:179], v10 offset:1280
  ds_read_b128 v[180:183], v10 offset:1920
  s_mov_b64 exec, -1
  s_cmp_eq_u32 s62, 2
  s_cbranch_scc1 Lst_22
  s_waitcnt lgkmcnt(2)
  v_mfma_f32_32x32x16_bf16 v[96:111], v[168:171], v[192:195], v[96:111]
  v_exp_f32 v32, v32
  v_exp_f32 v33, v33
  v_exp_f32 v34, v34
  v_exp_f32 v35, v35
  v_cvt_pk_bf16_f32 v200, v32, v33
  v_mfma_f32_32x32x16_bf16 v[96:111], v[172:175], v[196:199], v[96:111]
  v_exp_f32 v36, v36
  v_exp_f32 v37, v37
  v_cvt_pk_bf16_f32 v201, v34, v35
  v_exp_f32 v38, v38
  v_exp_f32 v39, v39
  v_cvt_pk_bf16_f32 v202, v36, v37
  v_exp_f32 v40, v40
  v_exp_f32 v41, v41
  v_cvt_pk_bf16_f32 v203, v38, v39
  v_exp_f32 v42, v42
  v_exp_f32 v43, v43
  v_cvt_pk_bf16_f32 v204, v40, v41
  v_exp_f32 v44, v44
  v_exp_f32 v45, v45
  v_cvt_pk_bf16_f32 v205, v42, v43
  v_exp_f32 v46, v46
  v_exp_f32 v47, v47
  v_cvt_pk_bf16_f32 v206, v44, v45
  s_nop 0
  v_cvt_pk_bf16_f32 v207, v46, v47
  s_waitcnt lgkmcnt(0)
  s_nop 0
  v_mfma_f32_32x32x16_bf16 v[96:111], v[176:179], v[200:203], v[96:111]
  v_mfma_f32_32x32x16_bf16 v[96:111], v[180:183], v[204:207], v[96:111]
  s_branch Lx2_15
Lst_16:
  s_waitcnt lgkmcnt(0)
  s_nop 0
  v_mfma_f32_32x32x16_bf16 v[96:111], v[168:171], v[192:195], v[96:111]
  v_mfma_f32_32x32x16_bf16 v[96:111], v[172:175], v[196:199], v[96:111]
  s_branch Lx2_15
Lst_17:
  s_waitcnt lgkmcnt(0)
  s_nop 0
  v_mfma_f32_32x32x16_bf16 v[96:111], v[176:179], v[200:203], v[96:111]
  v_mfma_f32_32x32x16_bf16 v[96:111], v[180:183], v[204:207], v[96:111]
  s_branch Lx2_15
Lst_18:
  s_waitcnt lgkmcnt(0)
  s_nop 0
  v_mfma_f32_32x32x16_bf16 v[96:111], v[168:171], v[192:195], v[96:111]
  v_mfma_f32_32x32x16_bf16 v[96:111], v[172:175], v[196:199], v[96:111]
  s_branch Lx2_15
Lst_19:
  s_waitcnt lgkmcnt(0)
  s_nop 0
  v_mfma_f32_32x32x16_bf16 v[96:111], v[176:179], v[200:203], v[96:111]
  v_mfma_f32_32x32x16_bf16 v[96:111], v[180:183], v[204:207], v[96:111]
  s_branch Lx2_15
Lst_20:
  s_waitcnt lgkmcnt(0)
  s_nop 0
  v_mfma_f32_32x32x16_bf16 v[96:111], v[168:171], v[192:195], v[96:111]
  v_mfma_f32_32x32x16_bf16 v[96:111], v[172:175], v[196:199], v[96:111]
  s_branch Lx2_15
Lst_21:
  s_waitcnt lgkmcnt(0)
  s_nop 0
  v_mfma_f32_32x32x16_bf16 v[96:111], v[176:179], v[200:203], v[96:111]
  v_mfma_f32_32x32x16_bf16 v[96:111], v[180:183], v[204:207], v[96:111]
  s_branch Lx2_15
Lst_22:
  s_waitcnt lgkmcnt(0)
  s_nop 0
  v_mfma_f32_32x32x16_bf16 v[96:111], v[168:171], v[192:195], v[96:111]
  v_mfma_f32_32x32x16_bf16 v[96:111], v[172:175], v[196:199], v[96:111]
  s_branch Lx2_15
Lx2_15:
  s_waitcnt lgkmcnt(0)
  s_cmp_ge_u32 s3, 2
  s_cbranch_scc1 Lsb_23
  s_waitcnt vmcnt(0)
  s_add_u32 s39, s30, 1
  s_cmp_eq_u32 s3, 0
  s_cbranch_scc0 Lsb1_24

  v_mov_b32 v4, 2048
  Lspin_27:
  ds_read_b32 v5, v4
  s_waitcnt lgkmcnt(0)
  v_readfirstlane_b32 s34, v5
  s_cmp_lg_u32 s34, s39
  s_cbranch_scc1 Lspin_27

  s_lshl_b32 s34, s29, 2
  s_add_u32 s34, s34, s46
  s_add_u32 s34, s34, 0
  v_mov_b32 v4, s34
  v_mov_b32 v5, s31
  s_mov_b64 exec, 1
  buffer_store_dword v5, v4, s[16:19], 0 offen offset:128
  buffer_store_dword v5, v4, s[16:19], 0 offen sc1
  s_mov_b64 exec, -1

  s_cmp_eq_u32 s48, 0
  s_cbranch_scc1 Lsbn_26
  s_lshl_b32 s34, s29, 2
  s_add_u32 s34, s34, s46
  s_sub_u32 s34, s34, 1024
  v_mov_b32 v4, s34
  s_mov_b64 exec, 1
  Lpp_28:
  buffer_load_dword v5, v4, s[16:19], 0 offen sc1
  s_waitcnt vmcnt(0)
  v_cmp_ne_u32 vcc, s31, v5
  s_cmp_eq_u64 vcc, 0
  s_cbranch_scc0 Lpp_28
  s_mov_b64 exec, -1
  Lsbn_26:
  v_mov_b32 v4, 2052
  v_mov_b32 v5, s39
  ds_write_b32 v4, v5
  s_branch Lsbj_25
  Lsb1_24:
  v_mov_b32 v4, 2048
  v_mov_b32 v5, s39
  ds_write_b32 v4, v5

  v_mov_b32 v4, 2052
  Lspin_29:
  ds_read_b32 v5, v4
  s_waitcnt lgkmcnt(0)
  v_readfirstlane_b32 s34, v5
  s_cmp_lg_u32 s34, s39
  s_cbranch_scc1 Lspin_29

Lsbj_25:
  s_cmp_eq_u32 s48, 0
  s_cbranch_scc1 Lsbd_30
  s_lshl_b32 s35, s48, 5
  s_add_u32 s35, s35, s49
  s_sub_u32 s35, s35, 32
  s_mul_i32 s35, s35, 20480
  s_add_u32 s35, s35, s32
  s_add_u32 s35, s35, 0
  s_mul_i32 s36, s3, 10240
  s_add_u32 s35, s35, s36
  s_mul_i32 s37, s3, 20480

  s_add_u32 m0, s37, 86016
  s_add_u32 s34, s35, 0
  buffer_load_dwordx4 v1, s[16:19], s34 offen sc1 lds
  buffer_load_dwordx4 v1, s[16:19], s34 offen offset:1024 sc1 lds
  buffer_load_dwordx4 v1, s[16:19], s34 offen offset:2048 sc1 lds
  buffer_load_dwordx4 v1, s[16:19], s34 offen offset:3072 sc1 lds
  s_add_u32 m0, s37, 90112
  s_add_u32 s34, s35, 4096
  buffer_load_dwordx4 v1, s[16:19], s34 offen sc1 lds
  buffer_load_dwordx4 v1, s[16:19], s34 offen offset:1024 sc1 lds
  buffer_load_dwordx4 v1, s[16:19], s34 offen offset:2048 sc1 lds
  buffer_load_dwordx4 v1, s[16:19], s34 offen offset:3072 sc1 lds
  s_add_u32 m0, s37, 94208
  s_add_u32 s34, s35, 8192
  buffer_load_dwordx4 v1, s[16:19], s34 offen sc1 lds
  buffer_load_dwordx4 v1, s[16:19], s34 offen offset:1024 sc1 lds
  s_waitcnt vmcnt(0)
  Lsbd_30:

Lsb_23:
  s_waitcnt lgkmcnt(0)
  s_barrier
  s_cmp_eq_u32 s48, 0
  s_cbranch_scc1 Lafin_31
  ds_read_b64_tr_b16 v[112:113], v8 offset:0
  ds_read_b64_tr_b16 v[114:115], v15 offset:256
  ds_read_b64_tr_b16 v[116:117], v9 offset:0
  ds_read_b64_tr_b16 v[118:119], v8 offset:1280
  ds_read_b64_tr_b16 v[120:121], v15 offset:1536
  ds_read_b64_tr_b16 v[122:123], v9 offset:1280
  ds_read_b64_tr_b16 v[124:125], v8 offset:2560
  ds_read_b64_tr_b16 v[126:127], v15 offset:2816
  ds_read_b64_tr_b16 v[128:129], v9 offset:2560
  v_mov_b32 v4, v12
  v_mov_b32 v5, v12
  v_mov_b32 v6, v12
  v_mov_b32 v7, v12
  v_mov_b32 v32, v12
  v_mov_b32 v33, v12
  v_mov_b32 v34, v12
  v_mov_b32 v35, v12
  v_mov_b32 v36, v12
  v_mov_b32 v37, v12
  v_mov_b32 v38, v12
  v_mov_b32 v39, v12
  v_mov_b32 v40, v12
  v_mov_b32 v41, v12
  v_mov_b32 v42, v12
  v_mov_b32 v43, v12
  v_mov_b32 v44, v12
  v_mov_b32 v45, v12
  v_mov_b32 v46, v12
  v_mov_b32 v47, v12
  s_waitcnt lgkmcnt(6)
  v_mfma_f32_32x32x16_bf16 v[16:31], v[112:115], v[184:187], v[64:79]
  ds_read_b64_tr_b16 v[130:131], v8 offset:3840
  ds_read_b64_tr_b16 v[132:133], v15 offset:4096
  ds_read_b64_tr_b16 v[134:135], v9 offset:3840
  v_mfma_f32_32x32x8_bf16 v[16:31], v[116:117], v[188:189], v[16:31]
  s_cmp_eq_u32 s63, 0
  s_cbranch_scc1 Lx1_32
  s_waitcnt lgkmcnt(6)
  v_mfma_f32_32x32x16_bf16 v[32:47], v[118:121], v[184:187], 0
  ds_read_b64_tr_b16 v[136:137], v8 offset:5120
  ds_read_b64_tr_b16 v[138:139], v15 offset:5376
  ds_read_b64_tr_b16 v[140:141], v9 offset:5120
  s_nop 0
  v_max3_f32 v4, v4, v16, v17
  v_max3_f32 v5, v5, v18, v19
  v_max3_f32 v6, v6, v20, v21
  v_max3_f32 v7, v7, v22, v23
  v_mfma_f32_32x32x8_bf16 v[32:47], v[122:123], v[188:189], v[32:47]
  v_max3_f32 v4, v4, v24, v25
  v_max3_f32 v5, v5, v26, v27
  v_max3_f32 v6, v6, v28, v29
  v_max3_f32 v7, v7, v30, v31
  s_cmp_eq_u32 s63, 1
  s_cbranch_scc1 Lx1_32
  s_waitcnt lgkmcnt(6)
  v_mfma_f32_32x32x16_bf16 v[16:31], v[124:127], v[184:187], 0
  ds_read_b64_tr_b16 v[142:143], v8 offset:6400
  ds_read_b64_tr_b16 v[144:145], v15 offset:6656
  ds_read_b64_tr_b16 v[146:147], v9 offset:6400
  s_nop 0
  v_max3_f32 v4, v4, v32, v33
  v_max3_f32 v5, v5, v34, v35
  v_max3_f32 v6, v6, v36, v37
  v_max3_f32 v7, v7, v38, v39
  v_mfma_f32_32x32x8_bf16 v[16:31], v[128:129], v[188:189], v[16:31]
  v_max3_f32 v4, v4, v40, v41
  v_max3_f32 v5, v5, v42, v43
  v_max3_f32 v6, v6, v44, v45
  v_max3_f32 v7, v7, v46, v47
  s_cmp_eq_u32 s63, 2
  s_cbranch_scc1 Lx1_32
  s_waitcnt lgkmcnt(6)
  v_mfma_f32_32x32x16_bf16 v[32:47], v[130:133], v[184:187], 0
  ds_read_b64_tr_b16 v[148:149], v8 offset:7680
  ds_read_b64_tr_b16 v[150:151], v15 offset:7936
  ds_read_b64_tr_b16 v[152:153], v9 offset:7680
  s_nop 0
  v_max3_f32 v4, v4, v16, v17
  v_max3_f32 v5, v5, v18, v19
  v_max3_f32 v6, v6, v20, v21
  v_max3_f32 v7, v7, v22, v23
  v_mfma_f32_32x32x8_bf16 v[32:47], v[134:135], v[188:189], v[32:47]
  v_max3_f32 v4, v4, v24, v25
  v_max3_f32 v5, v5, v26, v27
  v_max3_f32 v6, v6, v28, v29
  v_max3_f32 v7, v7, v30, v31
  s_cmp_eq_u32 s63, 3
  s_cbranch_scc1 Lx1_32
  s_waitcnt lgkmcnt(6)
  v_mfma_f32_32x32x16_bf16 v[16:31], v[136:139], v[184:187], 0
  ds_read_b64_tr_b16 v[154:155], v8 offset:8960
  ds_read_b64_tr_b16 v[156:157], v15 offset:9216
  ds_read_b64_tr_b16 v[158:159], v9 offset:8960
  s_nop 0
  v_max3_f32 v4, v4, v32, v33
  v_max3_f32 v5, v5, v34, v35
  v_max3_f32 v6, v6, v36, v37
  v_max3_f32 v7, v7, v38, v39
  v_mfma_f32_32x32x8_bf16 v[16:31], v[140:141], v[188:189], v[16:31]
  v_max3_f32 v4, v4, v40, v41
  v_max3_f32 v5, v5, v42, v43
  v_max3_f32 v6, v6, v44, v45
  v_max3_f32 v7, v7, v46, v47
  s_cmp_eq_u32 s63, 4
  s_cbranch_scc1 Lx1_32
  s_waitcnt lgkmcnt(6)
  v_mfma_f32_32x32x16_bf16 v[32:47], v[142:145], v[184:187], 0
  s_nop 3
  v_max3_f32 v4, v4, v16, v17
  v_max3_f32 v5, v5, v18, v19
  v_max3_f32 v6, v6, v20, v21
  v_max3_f32 v7, v7, v22, v23
  v_mfma_f32_32x32x8_bf16 v[32:47], v[146:147], v[188:189], v[32:47]
  v_max3_f32 v4, v4, v24, v25
  v_max3_f32 v5, v5, v26, v27
  v_max3_f32 v6, v6, v28, v29
  v_max3_f32 v7, v7, v30, v31
  s_cmp_eq_u32 s63, 5
  s_cbranch_scc1 Lx1_32
  s_waitcnt lgkmcnt(3)
  v_mfma_f32_32x32x16_bf16 v[16:31], v[148:151], v[184:187], 0
  s_nop 3
  v_max3_f32 v4, v4, v32, v33
  v_max3_f32 v5, v5, v34, v35
  v_max3_f32 v6, v6, v36, v37
  v_max3_f32 v7, v7, v38, v39
  v_mfma_f32_32x32x8_bf16 v[16:31], v[152:153], v[188:189], v[16:31]
  v_max3_f32 v4, v4, v40, v41
  v_max3_f32 v5, v5, v42, v43
  v_max3_f32 v6, v6, v44, v45
  v_max3_f32 v7, v7, v46, v47
  s_cmp_eq_u32 s63, 6
  s_cbranch_scc1 Lx1_32
  s_waitcnt lgkmcnt(0)
  v_mfma_f32_32x32x16_bf16 v[32:47], v[154:157], v[184:187], 0
  s_nop 3
  v_max3_f32 v4, v4, v16, v17
  v_max3_f32 v5, v5, v18, v19
  v_max3_f32 v6, v6, v20, v21
  v_max3_f32 v7, v7, v22, v23
  v_mfma_f32_32x32x8_bf16 v[32:47], v[158:159], v[188:189], v[32:47]
  v_max3_f32 v4, v4, v24, v25
  v_max3_f32 v5, v5, v26, v27
  v_max3_f32 v6, v6, v28, v29
  v_max3_f32 v7, v7, v30, v31
Lx1_32:
  s_nop 13
  v_max3_f32 v4, v4, v16, v17
  v_max3_f32 v5, v5, v18, v19
  v_max3_f32 v6, v6, v20, v21
  v_max3_f32 v7, v7, v22, v23
  v_max3_f32 v4, v4, v24, v25
  v_max3_f32 v5, v5, v26, v27
  v_max3_f32 v6, v6, v28, v29
  v_max3_f32 v7, v7, v30, v31
  v_max3_f32 v4, v4, v32, v33
  v_max3_f32 v5, v5, v34, v35
  v_max3_f32 v6, v6, v36, v37
  v_max3_f32 v7, v7, v38, v39
  v_max3_f32 v4, v4, v40, v41
  v_max3_f32 v5, v5, v42, v43
  v_max3_f32 v6, v6, v44, v45
  v_max3_f32 v7, v7, v46, v47
  v_max3_f32 v4, v4, v5, v6
  v_max_f32 v4, v4, v7
  v_mov_b32 v5, v4
  s_nop 1
  v_permlane32_swap_b32 v4, v5
  s_nop 1
  v_max_f32 v4, v4, v5

  v_max_f32 v4, v4, v14
  v_sub_f32 v5, v14, v4
  v_exp_f32 v5, v5
  v_mov_b32 v14, v4
  s_nop 0

  v_mul_f32 v96, v96, v5
  v_mul_f32 v97, v97, v5
  v_mul_f32 v98, v98, v5
  v_mul_f32 v99, v99, v5
  v_mul_f32 v100, v100, v5
  v_mul_f32 v101, v101, v5
  v_mul_f32 v102, v102, v5
  v_mul_f32 v103, v103, v5
  v_mul_f32 v104, v104, v5
  v_mul_f32 v105, v105, v5
  v_mul_f32 v106, v106, v5
  v_mul_f32 v107, v107, v5
  v_mul_f32 v108, v108, v5
  v_mul_f32 v109, v109, v5
  v_mul_f32 v110, v110, v5
  v_mul_f32 v111, v111, v5
  v_sub_f32 v48, 0, v14
  v_sub_f32 v49, 0, v14
  v_sub_f32 v50, 0, v14
  v_sub_f32 v51, 0, v14
  v_sub_f32 v52, 0, v14
  v_sub_f32 v53, 0, v14
  v_sub_f32 v54, 0, v14
  v_sub_f32 v55, 0, v14
  v_sub_f32 v56, 0, v14
  v_sub_f32 v57, 0, v14
  v_sub_f32 v58, 0, v14
  v_sub_f32 v59, 0, v14
  v_sub_f32 v60, 0, v14
  v_sub_f32 v61, 0, v14
  v_sub_f32 v62, 0, v14
  v_sub_f32 v63, 0, v14
  v_sub_f32 v64, v64, v14
  v_sub_f32 v65, v65, v14
  v_sub_f32 v66, v66, v14
  v_sub_f32 v67, v67, v14
  v_sub_f32 v68, v68, v14
  v_sub_f32 v69, v69, v14
  v_sub_f32 v70, v70, v14
  v_sub_f32 v71, v71, v14
  v_sub_f32 v72, v72, v14
  v_sub_f32 v73, v73, v14
  v_sub_f32 v74, v74, v14
  v_sub_f32 v75, v75, v14
  v_sub_f32 v76, v76, v14
  v_sub_f32 v77, v77, v14
  v_sub_f32 v78, v78, v14
  v_sub_f32 v79, v79, v14
  s_waitcnt lgkmcnt(0)
  s_mov_b64 exec, s[56:57]
  ds_read_b128 v[168:171], v10 offset:0
  ds_read_b128 v[172:175], v10 offset:640
  s_mov_b64 exec, -1
  v_mfma_f32_32x32x16_bf16 v[16:31], v[112:115], v[184:187], v[64:79]
  v_mfma_f32_32x32x8_bf16 v[16:31], v[116:117], v[188:189], v[16:31]
  s_nop 11
  v_mfma_f32_32x32x16_bf16 v[32:47], v[118:121], v[184:187], v[48:63]
  v_exp_f32 v16, v16
  v_exp_f32 v17, v17
  v_exp_f32 v18, v18
  v_exp_f32 v19, v19
  v_cvt_pk_bf16_f32 v192, v16, v17
  v_mfma_f32_32x32x8_bf16 v[32:47], v[122:123], v[188:189], v[32:47]
  v_exp_f32 v20, v20
  v_exp_f32 v21, v21
  v_cvt_pk_bf16_f32 v193, v18, v19
  v_exp_f32 v22, v22
  v_exp_f32 v23, v23
  v_cvt_pk_bf16_f32 v194, v20, v21
  v_exp_f32 v24, v24
  v_exp_f32 v25, v25
  v_cvt_pk_bf16_f32 v195, v22, v23
  v_exp_f32 v26, v26
  v_exp_f32 v27, v27
  v_cvt_pk_bf16_f32 v196, v24, v25
  v_exp_f32 v28, v28
  v_exp_f32 v29, v29
  v_cvt_pk_bf16_f32 v197, v26, v27
  v_exp_f32 v30, v30
  v_exp_f32 v31, v31
  v_cvt_pk_bf16_f32 v198, v28, v29
  s_nop 0
  v_cvt_pk_bf16_f32 v199, v30, v31
  s_mov_b64 exec, s[56:57]
  ds_read_b128 v[176:179], v10 offset:1280
  ds_read_b128 v[180:183], v10 offset:1920
  s_mov_b64 exec, -1
  s_cmp_eq_u32 s63, 0
  s_cbranch_scc1 Lst_34
  v_mfma_f32_32x32x16_bf16 v[16:31], v[124:127], v[184:187], v[48:63]
  v_exp_f32 v32, v32
  v_exp_f32 v33, v33
  v_exp_f32 v34, v34
  v_exp_f32 v35, v35
  v_cvt_pk_bf16_f32 v200, v32, v33
  s_waitcnt lgkmcnt(2)
  v_mfma_f32_32x32x16_bf16 v[96:111], v[168:171], v[192:195], v[96:111]
  v_exp_f32 v36, v36
  v_exp_f32 v37, v37
  v_cvt_pk_bf16_f32 v201, v34, v35
  v_exp_f32 v38, v38
  v_exp_f32 v39, v39
  v_cvt_pk_bf16_f32 v202, v36, v37
  v_mfma_f32_32x32x8_bf16 v[16:31], v[128:129], v[188:189], v[16:31]
  v_exp_f32 v40, v40
  v_exp_f32 v41, v41
  v_cvt_pk_bf16_f32 v203, v38, v39
  v_exp_f32 v42, v42
  v_exp_f32 v43, v43
  v_cvt_pk_bf16_f32 v204, v40, v41
  v_mfma_f32_32x32x16_bf16 v[96:111], v[172:175], v[196:199], v[96:111]
  v_exp_f32 v44, v44
  v_exp_f32 v45, v45
  v_cvt_pk_bf16_f32 v205, v42, v43
  v_exp_f32 v46, v46
  v_exp_f32 v47, v47
  v_cvt_pk_bf16_f32 v206, v44, v45
  s_nop 0
  v_cvt_pk_bf16_f32 v207, v46, v47
  s_mov_b64 exec, s[56:57]
  ds_read_b128 v[168:171], v10 offset:2560
  ds_read_b128 v[172:175], v10 offset:3200
  s_mov_b64 exec, -1
  s_cmp_eq_u32 s63, 1
  s_cbranch_scc1 Lst_35
  v_mfma_f32_32x32x16_bf16 v[32:47], v[130:133], v[184:187], v[48:63]
  v_exp_f32 v16, v16
  v_exp_f32 v17, v17
  v_exp_f32 v18, v18
  v_exp_f32 v19, v19
  v_cvt_pk_bf16_f32 v192, v16, v17
  s_waitcnt lgkmcnt(2)
  v_mfma_f32_32x32x16_bf16 v[96:111], v[176:179], v[200:203], v[96:111]
  v_exp_f32 v20, v20
  v_exp_f32 v21, v21
  v_cvt_pk_bf16_f32 v193, v18, v19
  v_exp_f32 v22, v22
  v_exp_f32 v23, v23
  v_cvt_pk_bf16_f32 v194, v20, v21
  v_mfma_f32_32x32x8_bf16 v[32:47], v[134:135], v[188:189], v[32:47]
  v_exp_f32 v24, v24
  v_exp_f32 v25, v25
  v_cvt_pk_bf16_f32 v195, v22, v23
  v_exp_f32 v26, v26
  v_exp_f32 v27, v27
  v_cvt_pk_bf16_f32 v196, v24, v25
  v_mfma_f32_32x32x16_bf16 v[96:111], v[180:183], v[204:207], v[96:111]
  v_exp_f32 v28, v28
  v_exp_f32 v29, v29
  v_cvt_pk_bf16_f32 v197, v26, v27
  v_exp_f32 v30, v30
  v_exp_f32 v31, v31
  v_cvt_pk_bf16_f32 v198, v28, v29
  s_nop 0
  v_cvt_pk_bf16_f32 v199, v30, v31
  s_mov_b64 exec, s[56:57]
  ds_read_b128 v[176:179], v10 offset:3840
  ds_read_b128 v[180:183], v10 offset:4480
  s_mov_b64 exec, -1
  s_cmp_eq_u32 s63, 2
  s_cbranch_scc1 Lst_36
  v_mfma_f32_32x32x16_bf16 v[16:31], v[136:139], v[184:187], v[48:63]
  v_exp_f32 v32, v32
  v_exp_f32 v33, v33
  v_exp_f32 v34, v34
  v_exp_f32 v35, v35
  v_cvt_pk_bf16_f32 v200, v32, v33
  s_waitcnt lgkmcnt(2)
  v_mfma_f32_32x32x16_bf16 v[96:111], v[168:171], v[192:195], v[96:111]
  v_exp_f32 v36, v36
  v_exp_f32 v37, v37
  v_cvt_pk_bf16_f32 v201, v34, v35
  v_exp_f32 v38, v38
  v_exp_f32 v39, v39
  v_cvt_pk_bf16_f32 v202, v36, v37
  v_mfma_f32_32x32x8_bf16 v[16:31], v[140:141], v[188:189], v[16:31]
  v_exp_f32 v40, v40
  v_exp_f32 v41, v41
  v_cvt_pk_bf16_f32 v203, v38, v39
  v_exp_f32 v42, v42
  v_exp_f32 v43, v43
  v_cvt_pk_bf16_f32 v204, v40, v41
  v_mfma_f32_32x32x16_bf16 v[96:111], v[172:175], v[196:199], v[96:111]
  v_exp_f32 v44, v44
  v_exp_f32 v45, v45
  v_cvt_pk_bf16_f32 v205, v42, v43
  v_exp_f32 v46, v46
  v_exp_f32 v47, v47
  v_cvt_pk_bf16_f32 v206, v44, v45
  s_nop 0
  v_cvt_pk_bf16_f32 v207, v46, v47
  s_mov_b64 exec, s[56:57]
  ds_read_b128 v[168:171], v10 offset:5120
  ds_read_b128 v[172:175], v10 offset:5760
  s_mov_b64 exec, -1
  s_cmp_eq_u32 s63, 3
  s_cbranch_scc1 Lst_37
  v_mfma_f32_32x32x16_bf16 v[32:47], v[142:145], v[184:187], v[48:63]
  v_exp_f32 v16, v16
  v_exp_f32 v17, v17
  v_exp_f32 v18, v18
  v_exp_f32 v19, v19
  v_cvt_pk_bf16_f32 v192, v16, v17
  s_waitcnt lgkmcnt(2)
  v_mfma_f32_32x32x16_bf16 v[96:111], v[176:179], v[200:203], v[96:111]
  v_exp_f32 v20, v20
  v_exp_f32 v21, v21
  v_cvt_pk_bf16_f32 v193, v18, v19
  v_exp_f32 v22, v22
  v_exp_f32 v23, v23
  v_cvt_pk_bf16_f32 v194, v20, v21
  v_mfma_f32_32x32x8_bf16 v[32:47], v[146:147], v[188:189], v[32:47]
  v_exp_f32 v24, v24
  v_exp_f32 v25, v25
  v_cvt_pk_bf16_f32 v195, v22, v23
  v_exp_f32 v26, v26
  v_exp_f32 v27, v27
  v_cvt_pk_bf16_f32 v196, v24, v25
  v_mfma_f32_32x32x16_bf16 v[96:111], v[180:183], v[204:207], v[96:111]
  v_exp_f32 v28, v28
  v_exp_f32 v29, v29
  v_cvt_pk_bf16_f32 v197, v26, v27
  v_exp_f32 v30, v30
  v_exp_f32 v31, v31
  v_cvt_pk_bf16_f32 v198, v28, v29
  s_nop 0
  v_cvt_pk_bf16_f32 v199, v30, v31
  s_mov_b64 exec, s[56:57]
  ds_read_b128 v[176:179], v10 offset:6400
  ds_read_b128 v[180:183], v10 offset:7040
  s_mov_b64 exec, -1
  s_cmp_eq_u32 s63, 4
  s_cbranch_scc1 Lst_38
  v_mfma_f32_32x32x16_bf16 v[16:31], v[148:151], v[184:187], v[48:63]
  v_exp_f32 v32, v32
  v_exp_f32 v33, v33
  v_exp_f32 v34, v34
  v_exp_f32 v35, v35
  v_cvt_pk_bf16_f32 v200, v32, v33
  s_waitcnt lgkmcnt(2)
  v_mfma_f32_32x32x16_bf16 v[96:111], v[168:171], v[192:195], v[96:111]
  v_exp_f32 v36, v36
  v_exp_f32 v37, v37
  v_cvt_pk_bf16_f32 v201, v34, v35
  v_exp_f32 v38, v38
  v_exp_f32 v39, v39
  v_cvt_pk_bf16_f32 v202, v36, v37
  v_mfma_f32_32x32x8_bf16 v[16:31], v[152:153], v[188:189], v[16:31]
  v_exp_f32 v40, v40
  v_exp_f32 v41, v41
  v_cvt_pk_bf16_f32 v203, v38, v39
  v_exp_f32 v42, v42
  v_exp_f32 v43, v43
  v_cvt_pk_bf16_f32 v204, v40, v41
  v_mfma_f32_32x32x16_bf16 v[96:111], v[172:175], v[196:199], v[96:111]
  v_exp_f32 v44, v44
  v_exp_f32 v45, v45
  v_cvt_pk_bf16_f32 v205, v42, v43
  v_exp_f32 v46, v46
  v_exp_f32 v47, v47
  v_cvt_pk_bf16_f32 v206, v44, v45
  s_nop 0
  v_cvt_pk_bf16_f32 v207, v46, v47
  s_mov_b64 exec, s[56:57]
  ds_read_b128 v[168:171], v10 offset:7680
  ds_read_b128 v[172:175], v10 offset:8320
  s_mov_b64 exec, -1
  s_cmp_eq_u32 s63, 5
  s_cbranch_scc1 Lst_39
  v_mfma_f32_32x32x16_bf16 v[32:47], v[154:157], v[184:187], v[48:63]
  v_exp_f32 v16, v16
  v_exp_f32 v17, v17
  v_exp_f32 v18, v18
  v_exp_f32 v19, v19
  v_cvt_pk_bf16_f32 v192, v16, v17
  s_waitcnt lgkmcnt(2)
  v_mfma_f32_32x32x16_bf16 v[96:111], v[176:179], v[200:203], v[96:111]
  v_exp_f32 v20, v20
  v_exp_f32 v21, v21
  v_cvt_pk_bf16_f32 v193, v18, v19
  v_exp_f32 v22, v22
  v_exp_f32 v23, v23
  v_cvt_pk_bf16_f32 v194, v20, v21
  v_mfma_f32_32x32x8_bf16 v[32:47], v[158:159], v[188:189], v[32:47]
  v_exp_f32 v24, v24
  v_exp_f32 v25, v25
  v_cvt_pk_bf16_f32 v195, v22, v23
  v_exp_f32 v26, v26
  v_exp_f32 v27, v27
  v_cvt_pk_bf16_f32 v196, v24, v25
  v_mfma_f32_32x32x16_bf16 v[96:111], v[180:183], v[204:207], v[96:111]
  v_exp_f32 v28, v28
  v_exp_f32 v29, v29
  v_cvt_pk_bf16_f32 v197, v26, v27
  v_exp_f32 v30, v30
  v_exp_f32 v31, v31
  v_cvt_pk_bf16_f32 v198, v28, v29
  s_nop 0
  v_cvt_pk_bf16_f32 v199, v30, v31
  s_mov_b64 exec, s[56:57]
  ds_read_b128 v[176:179], v10 offset:8960
  ds_read_b128 v[180:183], v10 offset:9600
  s_mov_b64 exec, -1
  s_cmp_eq_u32 s63, 6
  s_cbranch_scc1 Lst_40
  s_waitcnt lgkmcnt(2)
  v_mfma_f32_32x32x16_bf16 v[96:111], v[168:171], v[192:195], v[96:111]
  v_exp_f32 v32, v32
  v_exp_f32 v33, v33
  v_exp_f32 v34, v34
  v_exp_f32 v35, v35
  v_cvt_pk_bf16_f32 v200, v32, v33
  v_mfma_f32_32x32x16_bf16 v[96:111], v[172:175], v[196:199], v[96:111]
  v_exp_f32 v36, v36
  v_exp_f32 v37, v37
  v_cvt_pk_bf16_f32 v201, v34, v35
  v_exp_f32 v38, v38
  v_exp_f32 v39, v39
  v_cvt_pk_bf16_f32 v202, v36, v37
  v_exp_f32 v40, v40
  v_exp_f32 v41, v41
  v_cvt_pk_bf16_f32 v203, v38, v39
  v_exp_f32 v42, v42
  v_exp_f32 v43, v43
  v_cvt_pk_bf16_f32 v204, v40, v41
  v_exp_f32 v44, v44
  v_exp_f32 v45, v45
  v_cvt_pk_bf16_f32 v205, v42, v43
  v_exp_f32 v46, v46
  v_exp_f32 v47, v47
  v_cvt_pk_bf16_f32 v206, v44, v45
  s_nop 0
  v_cvt_pk_bf16_f32 v207, v46, v47
  s_waitcnt lgkmcnt(0)
  s_nop 0
  v_mfma_f32_32x32x16_bf16 v[96:111], v[176:179], v[200:203], v[96:111]
  v_mfma_f32_32x32x16_bf16 v[96:111], v[180:183], v[204:207], v[96:111]
  s_branch Lx2_33
Lst_34:
  s_waitcnt lgkmcnt(0)
  s_nop 0
  v_mfma_f32_32x32x16_bf16 v[96:111], v[168:171], v[192:195], v[96:111]
  v_mfma_f32_32x32x16_bf16 v[96:111], v[172:175], v[196:199], v[96:111]
  s_branch Lx2_33
Lst_35:
  s_waitcnt lgkmcnt(0)
  s_nop 0
  v_mfma_f32_32x32x16_bf16 v[96:111], v[176:179], v[200:203], v[96:111]
  v_mfma_f32_32x32x16_bf16 v[96:111], v[180:183], v[204:207], v[96:111]
  s_branch Lx2_33
Lst_36:
  s_waitcnt lgkmcnt(0)
  s_nop 0
  v_mfma_f32_32x32x16_bf16 v[96:111], v[168:171], v[192:195], v[96:111]
  v_mfma_f32_32x32x16_bf16 v[96:111], v[172:175], v[196:199], v[96:111]
  s_branch Lx2_33
Lst_37:
  s_waitcnt lgkmcnt(0)
  s_nop 0
  v_mfma_f32_32x32x16_bf16 v[96:111], v[176:179], v[200:203], v[96:111]
  v_mfma_f32_32x32x16_bf16 v[96:111], v[180:183], v[204:207], v[96:111]
  s_branch Lx2_33
Lst_38:
  s_waitcnt lgkmcnt(0)
  s_nop 0
  v_mfma_f32_32x32x16_bf16 v[96:111], v[168:171], v[192:195], v[96:111]
  v_mfma_f32_32x32x16_bf16 v[96:111], v[172:175], v[196:199], v[96:111]
  s_branch Lx2_33
Lst_39:
  s_waitcnt lgkmcnt(0)
  s_nop 0
  v_mfma_f32_32x32x16_bf16 v[96:111], v[176:179], v[200:203], v[96:111]
  v_mfma_f32_32x32x16_bf16 v[96:111], v[180:183], v[204:207], v[96:111]
  s_branch Lx2_33
Lst_40:
  s_waitcnt lgkmcnt(0)
  s_nop 0
  v_mfma_f32_32x32x16_bf16 v[96:111], v[168:171], v[192:195], v[96:111]
  v_mfma_f32_32x32x16_bf16 v[96:111], v[172:175], v[196:199], v[96:111]
  s_branch Lx2_33
Lx2_33:
  s_waitcnt lgkmcnt(0)
Lafin_31:
  s_nop 13
  v_mov_b32 v4, v104
  v_mov_b32 v5, v104
  s_nop 1
  v_permlane32_swap_b32 v4, v5
  s_nop 1
  v_rcp_f32 v5, v5
  s_nop 0

  v_mul_f32 v96, v96, v5
  v_mul_f32 v97, v97, v5
  v_mul_f32 v98, v98, v5
  v_mul_f32 v99, v99, v5
  v_mul_f32 v100, v100, v5
  v_mul_f32 v101, v101, v5
  v_mul_f32 v102, v102, v5
  v_mul_f32 v103, v103, v5
  v_mul_f32 v104, v104, v5
  v_mul_f32 v105, v105, v5
  v_mul_f32 v106, v106, v5
  v_mul_f32 v107, v107, v5
  v_cvt_pk_bf16_f32 v192, v96, v97
  v_cvt_pk_bf16_f32 v193, v98, v99
  v_cvt_pk_bf16_f32 v194, v100, v101
  v_cvt_pk_bf16_f32 v195, v102, v103
  v_cvt_pk_bf16_f32 v196, v104, v105
  v_cvt_pk_bf16_f32 v197, v106, v107
  s_and_b32 s35, s49, 1
  s_lshl_b32 s37, s48, 2
  s_lshr_b32 s38, s50, 1
  s_add_u32 s37, s37, s38
  s_mul_i32 s37, s37, 81920
  s_add_u32 s37, s37, s32
  s_add_u32 s37, s37, 7864320
  s_and_b32 s38, s50, 1
  s_lshl_b32 s38, s38, 11
  s_add_u32 s37, s37, s38
  v_permlane32_swap_b32 v192, v194
  v_permlane32_swap_b32 v193, v195
  s_lshr_b32 s38, s49, 1
  s_mul_i32 s38, s38, 5
  s_lshl_b32 s39, s35, 1
  s_add_u32 s39, s39, s38
  v_and_b32 v4, 1, v3
  v_lshlrev_b32 v4, 10, v4
  v_lshl_add_u32 v4, v2, 4, v4
  v_lshrrev_b32 v5, 1, v3
  v_add_u32 v5, s39, v5
  v_lshrrev_b32 v6, 2, v5
  v_lshlrev_b32 v6, 12, v6
  v_and_b32 v5, 3, v5
  v_lshl_add_u32 v6, v5, 8, v6
  v_add_u32 v6, v6, v4
  buffer_store_dwordx4 v[192:195], v6, s[16:19], s37 offen sc0 sc1
  s_add_u32 s38, s38, 4
  s_lshr_b32 s39, s38, 2
  s_lshl_b32 s39, s39, 12
  s_and_b32 s38, s38, 3
  s_lshl_b32 s38, s38, 8
  s_add_u32 s39, s39, s38
  s_lshl_b32 s38, s35, 3
  s_add_u32 s39, s39, s38
  v_add_u32 v7, s39, v4
  s_mov_b32 exec_hi, 0
  buffer_store_dwordx2 v[196:197], v7, s[16:19], s37 offen sc0 sc1
  s_mov_b32 exec_hi, -1

  s_waitcnt vmcnt(0)
  s_barrier
  s_barrier
  s_lshl_b32 s35, s33, 10
  s_add_u32 s35, s35, 86016
  v_add_u32 v8, s35, v1
  v_mov_b32 v10, v1
  v_add_u32 v11, 0x10000, v1

  v_mov_b32 v24, 0
  v_mov_b32 v25, 0
  v_mov_b32 v26, 0
  v_mov_b32 v27, 0
  v_mov_b32 v28, 0
  v_mov_b32 v29, 0
  v_mov_b32 v30, 0
  v_mov_b32 v31, 0
  v_mov_b32 v32, 0
  v_mov_b32 v33, 0
  v_mov_b32 v34, 0
  v_mov_b32 v35, 0
  v_mov_b32 v36, 0
  v_mov_b32 v37, 0
  v_mov_b32 v38, 0
  v_mov_b32 v39, 0
  v_mov_b32 v40, 0
  v_mov_b32 v41, 0
  v_mov_b32 v42, 0
  v_mov_b32 v43, 0
  s_barrier
  ds_read_b128 v[44:47], v8 offset:0
  ds_read_b128 v[48:51], v10 offset:4096
  ds_read_b128 v[68:71], v8 offset:4096
  ds_read_b128 v[52:55], v10 offset:5120
  ds_read_b128 v[56:59], v10 offset:6144
  ds_read_b128 v[60:63], v10 offset:7168
  ds_read_b128 v[64:67], v10 offset:8192
  ds_read_b128 v[72:75], v10 offset:9216
  ds_read_b128 v[76:79], v10 offset:10240
  ds_read_b128 v[80:83], v10 offset:11264
  ds_read_b128 v[84:87], v10 offset:12288
  ds_read_b128 v[88:91], v10 offset:13312
  s_waitcnt lgkmcnt(0)
  v_mfma_f32_16x16x32_bf16 v[24:27], v[48:51], v[44:47], v[24:27]
  ds_read_b128 v[92:95], v8 offset:8192
  ds_read_b128 v[96:99], v10 offset:14336
  v_mfma_f32_16x16x32_bf16 v[28:31], v[52:55], v[44:47], v[28:31]
  ds_read_b128 v[116:119], v8 offset:12288
  ds_read_b128 v[100:103], v10 offset:15360
  v_mfma_f32_16x16x32_bf16 v[32:35], v[56:59], v[44:47], v[32:35]
  ds_read_b128 v[104:107], v10 offset:16384
  ds_read_b128 v[108:111], v10 offset:17408
  v_mfma_f32_16x16x32_bf16 v[36:39], v[60:63], v[44:47], v[36:39]
  ds_read_b128 v[112:115], v10 offset:18432
  ds_read_b128 v[120:123], v10 offset:19456
  v_mfma_f32_16x16x32_bf16 v[40:43], v[64:67], v[44:47], v[40:43]
  ds_read_b128 v[124:127], v10 offset:20480
  ds_read_b128 v[128:131], v10 offset:21504
  v_mfma_f32_16x16x32_bf16 v[24:27], v[72:75], v[68:71], v[24:27]
  ds_read_b128 v[132:135], v10 offset:22528
  ds_read_b128 v[136:139], v10 offset:23552
  v_mfma_f32_16x16x32_bf16 v[28:31], v[76:79], v[68:71], v[28:31]
  v_mfma_f32_16x16x32_bf16 v[32:35], v[80:83], v[68:71], v[32:35]
  v_mfma_f32_16x16x32_bf16 v[36:39], v[84:87], v[68:71], v[36:39]
  v_mfma_f32_16x16x32_bf16 v[40:43], v[88:91], v[68:71], v[40:43]
  s_waitcnt lgkmcnt(0)
  v_mfma_f32_16x16x32_bf16 v[24:27], v[96:99], v[92:95], v[24:27]
  v_mfma_f32_16x16x32_bf16 v[28:31], v[100:103], v[92:95], v[28:31]
  s_barrier
  v_mfma_f32_16x16x32_bf16 v[32:35], v[104:107], v[92:95], v[32:35]
  ds_read_b128 v[44:47], v8 offset:16384
  ds_read_b128 v[48:51], v10 offset:24576
  ds_read_b128 v[68:71], v8 offset:20480
  v_mfma_f32_16x16x32_bf16 v[36:39], v[108:111], v[92:95], v[36:39]
  ds_read_b128 v[52:55], v10 offset:25600
  ds_read_b128 v[56:59], v10 offset:26624
  ds_read_b128 v[60:63], v10 offset:27648
  v_mfma_f32_16x16x32_bf16 v[40:43], v[112:115], v[92:95], v[40:43]
  ds_read_b128 v[64:67], v10 offset:28672
  ds_read_b128 v[72:75], v10 offset:29696
  ds_read_b128 v[76:79], v10 offset:30720
  v_mfma_f32_16x16x32_bf16 v[24:27], v[120:123], v[116:119], v[24:27]
  ds_read_b128 v[80:83], v10 offset:31744
  ds_read_b128 v[84:87], v10 offset:32768
  ds_read_b128 v[88:91], v10 offset:33792
  v_mfma_f32_16x16x32_bf16 v[28:31], v[124:127], v[116:119], v[28:31]
  v_mfma_f32_16x16x32_bf16 v[32:35], v[128:131], v[116:119], v[32:35]
  v_mfma_f32_16x16x32_bf16 v[36:39], v[132:135], v[116:119], v[36:39]
  v_mfma_f32_16x16x32_bf16 v[40:43], v[136:139], v[116:119], v[40:43]
  s_waitcnt lgkmcnt(0)
  v_mfma_f32_16x16x32_bf16 v[24:27], v[48:51], v[44:47], v[24:27]
  ds_read_b128 v[92:95], v8 offset:24576
  ds_read_b128 v[96:99], v10 offset:34816
  v_mfma_f32_16x16x32_bf16 v[28:31], v[52:55], v[44:47], v[28:31]
  ds_read_b128 v[116:119], v8 offset:28672
  ds_read_b128 v[100:103], v10 offset:35840
  v_mfma_f32_16x16x32_bf16 v[32:35], v[56:59], v[44:47], v[32:35]
  ds_read_b128 v[104:107], v10 offset:36864
  ds_read_b128 v[108:111], v10 offset:37888
  v_mfma_f32_16x16x32_bf16 v[36:39], v[60:63], v[44:47], v[36:39]
  ds_read_b128 v[112:115], v10 offset:38912
  ds_read_b128 v[120:123], v10 offset:39936
  v_mfma_f32_16x16x32_bf16 v[40:43], v[64:67], v[44:47], v[40:43]
  ds_read_b128 v[124:127], v10 offset:40960
  ds_read_b128 v[128:131], v10 offset:41984
  v_mfma_f32_16x16x32_bf16 v[24:27], v[72:75], v[68:71], v[24:27]
  ds_read_b128 v[132:135], v10 offset:43008
  ds_read_b128 v[136:139], v10 offset:44032
  v_mfma_f32_16x16x32_bf16 v[28:31], v[76:79], v[68:71], v[28:31]
  v_mfma_f32_16x16x32_bf16 v[32:35], v[80:83], v[68:71], v[32:35]
  v_mfma_f32_16x16x32_bf16 v[36:39], v[84:87], v[68:71], v[36:39]
  v_mfma_f32_16x16x32_bf16 v[40:43], v[88:91], v[68:71], v[40:43]
  s_waitcnt lgkmcnt(0)
  v_mfma_f32_16x16x32_bf16 v[24:27], v[96:99], v[92:95], v[24:27]
  v_mfma_f32_16x16x32_bf16 v[28:31], v[100:103], v[92:95], v[28:31]
  s_barrier
  v_mfma_f32_16x16x32_bf16 v[32:35], v[104:107], v[92:95], v[32:35]
  ds_read_b128 v[44:47], v8 offset:32768
  ds_read_b128 v[48:51], v10 offset:45056
  ds_read_b128 v[68:71], v8 offset:36864
  v_mfma_f32_16x16x32_bf16 v[36:39], v[108:111], v[92:95], v[36:39]
  ds_read_b128 v[52:55], v10 offset:46080
  ds_read_b128 v[56:59], v10 offset:47104
  ds_read_b128 v[60:63], v10 offset:48128
  v_mfma_f32_16x16x32_bf16 v[40:43], v[112:115], v[92:95], v[40:43]
  ds_read_b128 v[64:67], v10 offset:49152
  ds_read_b128 v[72:75], v10 offset:50176
  ds_read_b128 v[76:79], v10 offset:51200
  v_mfma_f32_16x16x32_bf16 v[24:27], v[120:123], v[116:119], v[24:27]
  ds_read_b128 v[80:83], v10 offset:52224
  ds_read_b128 v[84:87], v10 offset:53248
  ds_read_b128 v[88:91], v10 offset:54272
  v_mfma_f32_16x16x32_bf16 v[28:31], v[124:127], v[116:119], v[28:31]
  v_mfma_f32_16x16x32_bf16 v[32:35], v[128:131], v[116:119], v[32:35]
  v_mfma_f32_16x16x32_bf16 v[36:39], v[132:135], v[116:119], v[36:39]
  v_mfma_f32_16x16x32_bf16 v[40:43], v[136:139], v[116:119], v[40:43]
  s_waitcnt lgkmcnt(0)
  v_mfma_f32_16x16x32_bf16 v[24:27], v[48:51], v[44:47], v[24:27]
  ds_read_b128 v[92:95], v8 offset:40960
  ds_read_b128 v[96:99], v10 offset:55296
  v_mfma_f32_16x16x32_bf16 v[28:31], v[52:55], v[44:47], v[28:31]
  ds_read_b128 v[116:119], v8 offset:45056
  ds_read_b128 v[100:103], v10 offset:56320
  v_mfma_f32_16x16x32_bf16 v[32:35], v[56:59], v[44:47], v[32:35]
  ds_read_b128 v[104:107], v10 offset:57344
  ds_read_b128 v[108:111], v10 offset:58368
  v_mfma_f32_16x16x32_bf16 v[36:39], v[60:63], v[44:47], v[36:39]
  ds_read_b128 v[112:115], v10 offset:59392
  ds_read_b128 v[120:123], v10 offset:60416
  v_mfma_f32_16x16x32_bf16 v[40:43], v[64:67], v[44:47], v[40:43]
  ds_read_b128 v[124:127], v10 offset:61440
  ds_read_b128 v[128:131], v10 offset:62464
  v_mfma_f32_16x16x32_bf16 v[24:27], v[72:75], v[68:71], v[24:27]
  ds_read_b128 v[132:135], v10 offset:63488
  ds_read_b128 v[136:139], v10 offset:64512
  v_mfma_f32_16x16x32_bf16 v[28:31], v[76:79], v[68:71], v[28:31]
  v_mfma_f32_16x16x32_bf16 v[32:35], v[80:83], v[68:71], v[32:35]
  v_mfma_f32_16x16x32_bf16 v[36:39], v[84:87], v[68:71], v[36:39]
  v_mfma_f32_16x16x32_bf16 v[40:43], v[88:91], v[68:71], v[40:43]
  s_waitcnt lgkmcnt(0)
  v_mfma_f32_16x16x32_bf16 v[24:27], v[96:99], v[92:95], v[24:27]
  v_mfma_f32_16x16x32_bf16 v[28:31], v[100:103], v[92:95], v[28:31]
  s_barrier
  v_mfma_f32_16x16x32_bf16 v[32:35], v[104:107], v[92:95], v[32:35]
  ds_read_b128 v[44:47], v8 offset:49152
  ds_read_b128 v[48:51], v11 offset:0
  ds_read_b128 v[68:71], v8 offset:53248
  v_mfma_f32_16x16x32_bf16 v[36:39], v[108:111], v[92:95], v[36:39]
  ds_read_b128 v[52:55], v11 offset:1024
  ds_read_b128 v[56:59], v11 offset:2048
  ds_read_b128 v[60:63], v11 offset:3072
  v_mfma_f32_16x16x32_bf16 v[40:43], v[112:115], v[92:95], v[40:43]
  ds_read_b128 v[64:67], v11 offset:4096
  ds_read_b128 v[72:75], v11 offset:5120
  ds_read_b128 v[76:79], v11 offset:6144
  v_mfma_f32_16x16x32_bf16 v[24:27], v[120:123], v[116:119], v[24:27]
  ds_read_b128 v[80:83], v11 offset:7168
  ds_read_b128 v[84:87], v11 offset:8192
  ds_read_b128 v[88:91], v11 offset:9216
  v_mfma_f32_16x16x32_bf16 v[28:31], v[124:127], v[116:119], v[28:31]
  v_mfma_f32_16x16x32_bf16 v[32:35], v[128:131], v[116:119], v[32:35]
  v_mfma_f32_16x16x32_bf16 v[36:39], v[132:135], v[116:119], v[36:39]
  v_mfma_f32_16x16x32_bf16 v[40:43], v[136:139], v[116:119], v[40:43]
  s_waitcnt lgkmcnt(0)
  v_mfma_f32_16x16x32_bf16 v[24:27], v[48:51], v[44:47], v[24:27]
  ds_read_b128 v[92:95], v8 offset:57344
  ds_read_b128 v[96:99], v11 offset:10240
  v_mfma_f32_16x16x32_bf16 v[28:31], v[52:55], v[44:47], v[28:31]
  ds_read_b128 v[116:119], v8 offset:61440
  ds_read_b128 v[100:103], v11 offset:11264
  v_mfma_f32_16x16x32_bf16 v[32:35], v[56:59], v[44:47], v[32:35]
  ds_read_b128 v[104:107], v11 offset:12288
  ds_read_b128 v[108:111], v11 offset:13312
  v_mfma_f32_16x16x32_bf16 v[36:39], v[60:63], v[44:47], v[36:39]
  ds_read_b128 v[112:115], v11 offset:14336
  ds_read_b128 v[120:123], v11 offset:15360
  v_mfma_f32_16x16x32_bf16 v[40:43], v[64:67], v[44:47], v[40:43]
  ds_read_b128 v[124:127], v11 offset:16384
  ds_read_b128 v[128:131], v11 offset:17408
  v_mfma_f32_16x16x32_bf16 v[24:27], v[72:75], v[68:71], v[24:27]
  ds_read_b128 v[132:135], v11 offset:18432
  ds_read_b128 v[136:139], v11 offset:19456
  v_mfma_f32_16x16x32_bf16 v[28:31], v[76:79], v[68:71], v[28:31]
  v_mfma_f32_16x16x32_bf16 v[32:35], v[80:83], v[68:71], v[32:35]
  v_mfma_f32_16x16x32_bf16 v[36:39], v[84:87], v[68:71], v[36:39]
  v_mfma_f32_16x16x32_bf16 v[40:43], v[88:91], v[68:71], v[40:43]
  s_waitcnt lgkmcnt(0)
  v_mfma_f32_16x16x32_bf16 v[24:27], v[96:99], v[92:95], v[24:27]
  v_mfma_f32_16x16x32_bf16 v[28:31], v[100:103], v[92:95], v[28:31]
  s_barrier
  v_mfma_f32_16x16x32_bf16 v[32:35], v[104:107], v[92:95], v[32:35]
  ds_read_b128 v[44:47], v8 offset:0
  ds_read_b128 v[48:51], v10 offset:4096
  ds_read_b128 v[68:71], v8 offset:4096
  v_mfma_f32_16x16x32_bf16 v[36:39], v[108:111], v[92:95], v[36:39]
  ds_read_b128 v[52:55], v10 offset:5120
  ds_read_b128 v[56:59], v10 offset:6144
  ds_read_b128 v[60:63], v10 offset:7168
  v_mfma_f32_16x16x32_bf16 v[40:43], v[112:115], v[92:95], v[40:43]
  ds_read_b128 v[64:67], v10 offset:8192
  ds_read_b128 v[72:75], v10 offset:9216
  ds_read_b128 v[76:79], v10 offset:10240
  v_mfma_f32_16x16x32_bf16 v[24:27], v[120:123], v[116:119], v[24:27]
  ds_read_b128 v[80:83], v10 offset:11264
  ds_read_b128 v[84:87], v10 offset:12288
  ds_read_b128 v[88:91], v10 offset:13312
  v_mfma_f32_16x16x32_bf16 v[28:31], v[124:127], v[116:119], v[28:31]
  v_mfma_f32_16x16x32_bf16 v[32:35], v[128:131], v[116:119], v[32:35]
  v_mfma_f32_16x16x32_bf16 v[36:39], v[132:135], v[116:119], v[36:39]
  v_mfma_f32_16x16x32_bf16 v[40:43], v[136:139], v[116:119], v[40:43]
  s_waitcnt lgkmcnt(0)
  v_mfma_f32_16x16x32_bf16 v[24:27], v[48:51], v[44:47], v[24:27]
  ds_read_b128 v[92:95], v8 offset:8192
  ds_read_b128 v[96:99], v10 offset:14336
  v_mfma_f32_16x16x32_bf16 v[28:31], v[52:55], v[44:47], v[28:31]
  ds_read_b128 v[116:119], v8 offset:12288
  ds_read_b128 v[100:103], v10 offset:15360
  v_mfma_f32_16x16x32_bf16 v[32:35], v[56:59], v[44:47], v[32:35]
  ds_read_b128 v[104:107], v10 offset:16384
  ds_read_b128 v[108:111], v10 offset:17408
  v_mfma_f32_16x16x32_bf16 v[36:39], v[60:63], v[44:47], v[36:39]
  ds_read_b128 v[112:115], v10 offset:18432
  ds_read_b128 v[120:123], v10 offset:19456
  v_mfma_f32_16x16x32_bf16 v[40:43], v[64:67], v[44:47], v[40:43]
  ds_read_b128 v[124:127], v10 offset:20480
  ds_read_b128 v[128:131], v10 offset:21504
  v_mfma_f32_16x16x32_bf16 v[24:27], v[72:75], v[68:71], v[24:27]
  ds_read_b128 v[132:135], v10 offset:22528
  ds_read_b128 v[136:139], v10 offset:23552
  v_mfma_f32_16x16x32_bf16 v[28:31], v[76:79], v[68:71], v[28:31]
  v_mfma_f32_16x16x32_bf16 v[32:35], v[80:83], v[68:71], v[32:35]
  v_mfma_f32_16x16x32_bf16 v[36:39], v[84:87], v[68:71], v[36:39]
  v_mfma_f32_16x16x32_bf16 v[40:43], v[88:91], v[68:71], v[40:43]
  s_waitcnt lgkmcnt(0)
  v_mfma_f32_16x16x32_bf16 v[24:27], v[96:99], v[92:95], v[24:27]
  v_mfma_f32_16x16x32_bf16 v[28:31], v[100:103], v[92:95], v[28:31]
  v_mfma_f32_16x16x32_bf16 v[32:35], v[104:107], v[92:95], v[32:35]
  v_mfma_f32_16x16x32_bf16 v[36:39], v[108:111], v[92:95], v[36:39]
  v_mfma_f32_16x16x32_bf16 v[40:43], v[112:115], v[92:95], v[40:43]
  v_mfma_f32_16x16x32_bf16 v[24:27], v[120:123], v[116:119], v[24:27]
  v_mfma_f32_16x16x32_bf16 v[28:31], v[124:127], v[116:119], v[28:31]
  v_mfma_f32_16x16x32_bf16 v[32:35], v[128:131], v[116:119], v[32:35]
  v_mfma_f32_16x16x32_bf16 v[36:39], v[132:135], v[116:119], v[36:39]
  v_mfma_f32_16x16x32_bf16 v[40:43], v[136:139], v[116:119], v[40:43]
  s_barrier
  s_nop 7
  s_waitcnt vmcnt(0)
  v_lshlrev_b32 v4, 16, v246
  v_and_b32 v5, 0xffff0000, v246
  v_lshlrev_b32 v6, 16, v247
  v_and_b32 v7, 0xffff0000, v247
  v_pk_add_f32 v[24:25], v[24:25], v[4:5]
  v_pk_add_f32 v[26:27], v[26:27], v[6:7]
  v_cvt_pk_bf16_f32 v246, v24, v25
  v_cvt_pk_bf16_f32 v247, v26, v27

  v_lshlrev_b32 v4, 16, v248
  v_and_b32 v5, 0xffff0000, v248
  v_lshlrev_b32 v6, 16, v249
  v_and_b32 v7, 0xffff0000, v249
  v_pk_add_f32 v[28:29], v[28:29], v[4:5]
  v_pk_add_f32 v[30:31], v[30:31], v[6:7]
  v_cvt_pk_bf16_f32 v248, v28, v29
  v_cvt_pk_bf16_f32 v249, v30, v31

  v_lshlrev_b32 v4, 16, v250
  v_and_b32 v5, 0xffff0000, v250
  v_lshlrev_b32 v6, 16, v251
  v_and_b32 v7, 0xffff0000, v251
  v_pk_add_f32 v[32:33], v[32:33], v[4:5]
  v_pk_add_f32 v[34:35], v[34:35], v[6:7]
  v_cvt_pk_bf16_f32 v250, v32, v33
  v_cvt_pk_bf16_f32 v251, v34, v35

  v_lshlrev_b32 v4, 16, v252
  v_and_b32 v5, 0xffff0000, v252
  v_lshlrev_b32 v6, 16, v253
  v_and_b32 v7, 0xffff0000, v253
  v_pk_add_f32 v[36:37], v[36:37], v[4:5]
  v_pk_add_f32 v[38:39], v[38:39], v[6:7]
  v_cvt_pk_bf16_f32 v252, v36, v37
  v_cvt_pk_bf16_f32 v253, v38, v39

  v_lshlrev_b32 v4, 16, v254
  v_and_b32 v5, 0xffff0000, v254
  v_lshlrev_b32 v6, 16, v255
  v_and_b32 v7, 0xffff0000, v255
  v_pk_add_f32 v[40:41], v[40:41], v[4:5]
  v_pk_add_f32 v[42:43], v[42:43], v[6:7]
  v_cvt_pk_bf16_f32 v254, v40, v41
  v_cvt_pk_bf16_f32 v255, v42, v43

  v_mov_b32 v44, v246
  v_mov_b32 v45, v247
  v_mov_b32 v46, v248
  v_mov_b32 v47, v249
  v_mov_b32 v48, v250
  v_mov_b32 v49, v251
  v_mov_b32 v50, v252
  v_mov_b32 v51, v253
  s_mul_i32 s37, s28, 163840
  s_add_u32 s37, s37, s32
  s_add_u32 s37, s37, 10485760
  s_and_b32 s38, s52, 1
  s_lshl_b32 s38, s38, 2
  s_add_u32 s38, s38, s33
  s_lshl_b32 s38, s38, 11
  s_add_u32 s37, s37, s38
  s_mul_i32 s38, s53, 10
  v_and_b32 v4, 1, v3
  v_lshrrev_b32 v5, 1, v3
  v_lshl_add_u32 v6, v4, 1, v5
  v_add_u32 v6, s38, v6
  v_add_u32 v7, s38, v5
  v_permlane16_swap_b32 v44, v46
  v_permlane16_swap_b32 v45, v47
  v_permlane16_swap_b32 v48, v50
  v_permlane16_swap_b32 v49, v51

  v_add_u32 v8, 0, v6
  v_lshrrev_b32 v9, 3, v8
  v_lshlrev_b32 v9, 14, v9
  v_and_b32 v8, 7, v8
  v_lshl_add_u32 v9, v8, 8, v9
  v_lshl_add_u32 v52, v2, 4, v9
  buffer_store_dwordx4 v[44:47], v52, s[16:19], s37 offen sc0 sc1

  v_add_u32 v8, 4, v6
  v_lshrrev_b32 v9, 3, v8
  v_lshlrev_b32 v9, 14, v9
  v_and_b32 v8, 7, v8
  v_lshl_add_u32 v9, v8, 8, v9
  v_lshl_add_u32 v53, v2, 4, v9
  buffer_store_dwordx4 v[48:51], v53, s[16:19], s37 offen sc0 sc1

  v_add_u32 v8, 8, v7
  v_lshrrev_b32 v9, 3, v8
  v_lshlrev_b32 v9, 14, v9
  v_and_b32 v8, 7, v8
  v_lshl_add_u32 v9, v8, 8, v9
  v_lshl_add_u32 v9, v2, 4, v9
  v_lshl_add_u32 v54, v4, 3, v9
  buffer_store_dwordx2 v[254:255], v54, s[16:19], s37 offen sc0 sc1
  s_mov_b32 s60, 0x3f803f80
  v_mov_b32 v12, 0
  v_mov_b32 v13, 0

  v_dot2_f32_bf16 v12, v246, s60, v12
  v_dot2_f32_bf16 v13, v246, v246, v13
  v_dot2_f32_bf16 v12, v247, s60, v12
  v_dot2_f32_bf16 v13, v247, v247, v13
  v_dot2_f32_bf16 v12, v248, s60, v12
  v_dot2_f32_bf16 v13, v248, v248, v13
  v_dot2_f32_bf16 v12, v249, s60, v12
  v_dot2_f32_bf16 v13, v249, v249, v13
  v_dot2_f32_bf16 v12, v250, s60, v12
  v_dot2_f32_bf16 v13, v250, v250, v13
  v_dot2_f32_bf16 v12, v251, s60, v12
  v_dot2_f32_bf16 v13, v251, v251, v13
  v_dot2_f32_bf16 v12, v252, s60, v12
  v_dot2_f32_bf16 v13, v252, v252, v13
  v_dot2_f32_bf16 v12, v253, s60, v12
  v_dot2_f32_bf16 v13, v253, v253, v13
  v_dot2_f32_bf16 v12, v254, s60, v12
  v_dot2_f32_bf16 v13, v254, v254, v13
  v_dot2_f32_bf16 v12, v255, s60, v12
  v_dot2_f32_bf16 v13, v255, v255, v13
  s_nop 2
  v_mov_b32 v14, v12
  v_mov_b32 v15, v13
  s_nop 1
  v_permlane16_swap_b32 v12, v14
  v_permlane16_swap_b32 v13, v15
  s_nop 1
  v_add_f32 v12, v12, v14
  v_add_f32 v13, v13, v15
  v_mov_b32 v14, v12
  v_mov_b32 v15, v13
  s_nop 1
  v_permlane32_swap_b32 v12, v14
  v_permlane32_swap_b32 v13, v15
  s_nop 1
  v_add_f32 v12, v12, v14
  v_add_f32 v13, v13, v15
  s_lshl_b32 s37, s52, 2
  s_add_u32 s37, s37, s33
  s_lshl_b32 s37, s37, 3
  s_add_u32 s37, s37, s53
  s_lshl_b32 s37, s37, 7
  s_add_u32 s37, s37, s32
  s_add_u32 s37, s37, 22020096
  v_lshlrev_b32 v4, 3, v2
  s_mov_b64 exec, 0xffff
  buffer_store_dwordx2 v[12:13], v4, s[16:19], s37 offen sc0 sc1
  s_mov_b64 exec, -1

  s_waitcnt vmcnt(0)
  s_barrier
  s_barrier
  v_mov_b32 v8, v1
  v_add_u32 v9, 1024, v1
  s_and_b32 s35, s33, 1
  s_lshl_b32 s35, s35, 13
  s_add_u32 s35, s35, 86016
  v_add_u32 v8, s35, v8
  v_add_u32 v9, s35, v9
  v_add_u32 v22, 0x10000, v8
  v_add_u32 v23, 0x10000, v9
  s_lshr_b32 s36, s33, 1

  s_mul_i32 s35, s36, 3072
  v_add_u32 v10, s35, v1
  v_add_u32 v11, 0x10000, v10

  v_mov_b32 v24, 0
  v_mov_b32 v25, 0
  v_mov_b32 v26, 0
  v_mov_b32 v27, 0
  v_mov_b32 v28, 0
  v_mov_b32 v29, 0
  v_mov_b32 v30, 0
  v_mov_b32 v31, 0
  v_mov_b32 v32, 0
  v_mov_b32 v33, 0
  v_mov_b32 v34, 0
  v_mov_b32 v35, 0
  v_mov_b32 v36, 0
  v_mov_b32 v37, 0
  v_mov_b32 v38, 0
  v_mov_b32 v39, 0
  v_mov_b32 v40, 0
  v_mov_b32 v41, 0
  v_mov_b32 v42, 0
  v_mov_b32 v43, 0
  v_mov_b32 v44, 0
  v_mov_b32 v45, 0
  v_mov_b32 v46, 0
  v_mov_b32 v47, 0
  v_mov_b32 v48, 0
  v_mov_b32 v49, 0
  v_mov_b32 v50, 0
  v_mov_b32 v51, 0
  v_mov_b32 v52, 0
  v_mov_b32 v53, 0
  v_mov_b32 v54, 0
  v_mov_b32 v55, 0
  v_mov_b32 v56, 0
  v_mov_b32 v57, 0
  v_mov_b32 v58, 0
  v_mov_b32 v59, 0
  v_mov_b32 v60, 0
  v_mov_b32 v61, 0
  v_mov_b32 v62, 0
  v_mov_b32 v63, 0
  v_mov_b32 v64, 0
  v_mov_b32 v65, 0
  v_mov_b32 v66, 0
  v_mov_b32 v67, 0
  v_mov_b32 v68, 0
  v_mov_b32 v69, 0
  v_mov_b32 v70, 0
  v_mov_b32 v71, 0
  v_mov_b32 v72, 0
  v_mov_b32 v73, 0
  v_mov_b32 v74, 0
  v_mov_b32 v75, 0
  v_mov_b32 v76, 0
  v_mov_b32 v77, 0
  v_mov_b32 v78, 0
  v_mov_b32 v79, 0
  v_mov_b32 v80, 0
  v_mov_b32 v81, 0
  v_mov_b32 v82, 0
  v_mov_b32 v83, 0
  v_mov_b32 v84, 0
  v_mov_b32 v85, 0
  v_mov_b32 v86, 0
  v_mov_b32 v87, 0
  v_mov_b32 v88, 0
  v_mov_b32 v89, 0
  v_mov_b32 v90, 0
  v_mov_b32 v91, 0
  v_mov_b32 v92, 0
  v_mov_b32 v93, 0
  v_mov_b32 v94, 0
  v_mov_b32 v95, 0
  v_mov_b32 v96, 0
  v_mov_b32 v97, 0
  v_mov_b32 v98, 0
  v_mov_b32 v99, 0
  v_mov_b32 v100, 0
  v_mov_b32 v101, 0
  v_mov_b32 v102, 0
  v_mov_b32 v103, 0
  v_mov_b32 v104, 0
  v_mov_b32 v105, 0
  v_mov_b32 v106, 0
  v_mov_b32 v107, 0
  v_mov_b32 v108, 0
  v_mov_b32 v109, 0
  v_mov_b32 v110, 0
  v_mov_b32 v111, 0
  v_mov_b32 v112, 0
  v_mov_b32 v113, 0
  v_mov_b32 v114, 0
  v_mov_b32 v115, 0
  v_mov_b32 v116, 0
  v_mov_b32 v117, 0
  v_mov_b32 v118, 0
  v_mov_b32 v119, 0
  s_barrier
  ds_read_b128 v[120:123], v8 offset:0
  ds_read_b128 v[136:139], v10 offset:4096
  ds_read_b128 v[124:127], v8 offset:2048
  ds_read_b128 v[140:143], v10 offset:5120
  ds_read_b128 v[128:131], v8 offset:4096
  ds_read_b128 v[144:147], v10 offset:6144
  ds_read_b128 v[132:135], v8 offset:6144
  ds_read_b128 v[148:151], v10 offset:10240
  ds_read_b128 v[152:155], v10 offset:11264
  ds_read_b128 v[156:159], v10 offset:12288
  s_waitcnt lgkmcnt(0)
  v_mfma_f32_16x16x32_bf16 v[24:27], v[136:139], v[120:123], v[24:27]
  ds_read_b128 v[160:163], v9 offset:0
  v_mfma_f32_16x16x32_bf16 v[28:31], v[140:143], v[120:123], v[28:31]
  ds_read_b128 v[176:179], v10 offset:16384
  v_mfma_f32_16x16x32_bf16 v[32:35], v[144:147], v[120:123], v[32:35]
  ds_read_b128 v[164:167], v9 offset:2048
  v_mfma_f32_16x16x32_bf16 v[36:39], v[148:151], v[120:123], v[36:39]
  ds_read_b128 v[180:183], v10 offset:17408
  v_mfma_f32_16x16x32_bf16 v[40:43], v[152:155], v[120:123], v[40:43]
  ds_read_b128 v[168:171], v9 offset:4096
  v_mfma_f32_16x16x32_bf16 v[44:47], v[156:159], v[120:123], v[44:47]
  ds_read_b128 v[184:187], v10 offset:18432
  v_mfma_f32_16x16x32_bf16 v[48:51], v[136:139], v[124:127], v[48:51]
  ds_read_b128 v[172:175], v9 offset:6144
  v_mfma_f32_16x16x32_bf16 v[52:55], v[140:143], v[124:127], v[52:55]
  ds_read_b128 v[188:191], v10 offset:22528
  v_mfma_f32_16x16x32_bf16 v[56:59], v[144:147], v[124:127], v[56:59]
  ds_read_b128 v[192:195], v10 offset:23552
  v_mfma_f32_16x16x32_bf16 v[60:63], v[148:151], v[124:127], v[60:63]
  ds_read_b128 v[196:199], v10 offset:24576
  v_mfma_f32_16x16x32_bf16 v[64:67], v[152:155], v[124:127], v[64:67]
  v_mfma_f32_16x16x32_bf16 v[68:71], v[156:159], v[124:127], v[68:71]
  v_mfma_f32_16x16x32_bf16 v[72:75], v[136:139], v[128:131], v[72:75]
  v_mfma_f32_16x16x32_bf16 v[76:79], v[140:143], v[128:131], v[76:79]
  v_mfma_f32_16x16x32_bf16 v[80:83], v[144:147], v[128:131], v[80:83]
  v_mfma_f32_16x16x32_bf16 v[84:87], v[148:151], v[128:131], v[84:87]
  v_mfma_f32_16x16x32_bf16 v[88:91], v[152:155], v[128:131], v[88:91]
  v_mfma_f32_16x16x32_bf16 v[92:95], v[156:159], v[128:131], v[92:95]
  v_mfma_f32_16x16x32_bf16 v[96:99], v[136:139], v[132:135], v[96:99]
  v_mfma_f32_16x16x32_bf16 v[100:103], v[140:143], v[132:135], v[100:103]
  v_mfma_f32_16x16x32_bf16 v[104:107], v[144:147], v[132:135], v[104:107]
  v_mfma_f32_16x16x32_bf16 v[108:111], v[148:151], v[132:135], v[108:111]
  v_mfma_f32_16x16x32_bf16 v[112:115], v[152:155], v[132:135], v[112:115]
  v_mfma_f32_16x16x32_bf16 v[116:119], v[156:159], v[132:135], v[116:119]
  s_waitcnt lgkmcnt(0)
  v_mfma_f32_16x16x32_bf16 v[24:27], v[176:179], v[160:163], v[24:27]
  v_mfma_f32_16x16x32_bf16 v[28:31], v[180:183], v[160:163], v[28:31]
  s_barrier
  v_mfma_f32_16x16x32_bf16 v[32:35], v[184:187], v[160:163], v[32:35]
  ds_read_b128 v[120:123], v8 offset:16384
  v_mfma_f32_16x16x32_bf16 v[36:39], v[188:191], v[160:163], v[36:39]
  ds_read_b128 v[136:139], v10 offset:28672
  v_mfma_f32_16x16x32_bf16 v[40:43], v[192:195], v[160:163], v[40:43]
  ds_read_b128 v[124:127], v8 offset:18432
  v_mfma_f32_16x16x32_bf16 v[44:47], v[196:199], v[160:163], v[44:47]
  ds_read_b128 v[140:143], v10 offset:29696
  v_mfma_f32_16x16x32_bf16 v[48:51], v[176:179], v[164:167], v[48:51]
  ds_read_b128 v[128:131], v8 offset:20480
  v_mfma_f32_16x16x32_bf16 v[52:55], v[180:183], v[164:167], v[52:55]
  ds_read_b128 v[144:147], v10 offset:30720
  v_mfma_f32_16x16x32_bf16 v[56:59], v[184:187], v[164:167], v[56:59]
  ds_read_b128 v[132:135], v8 offset:22528
  v_mfma_f32_16x16x32_bf16 v[60:63], v[188:191], v[164:167], v[60:63]
  ds_read_b128 v[148:151], v10 offset:34816
  v_mfma_f32_16x16x32_bf16 v[64:67], v[192:195], v[164:167], v[64:67]
  ds_read_b128 v[152:155], v10 offset:35840
  v_mfma_f32_16x16x32_bf16 v[68:71], v[196:199], v[164:167], v[68:71]
  ds_read_b128 v[156:159], v10 offset:36864
  v_mfma_f32_16x16x32_bf16 v[72:75], v[176:179], v[168:171], v[72:75]
  v_mfma_f32_16x16x32_bf16 v[76:79], v[180:183], v[168:171], v[76:79]
  v_mfma_f32_16x16x32_bf16 v[80:83], v[184:187], v[168:171], v[80:83]
  v_mfma_f32_16x16x32_bf16 v[84:87], v[188:191], v[168:171], v[84:87]
  v_mfma_f32_16x16x32_bf16 v[88:91], v[192:195], v[168:171], v[88:91]
  v_mfma_f32_16x16x32_bf16 v[92:95], v[196:199], v[168:171], v[92:95]
  v_mfma_f32_16x16x32_bf16 v[96:99], v[176:179], v[172:175], v[96:99]
  v_mfma_f32_16x16x32_bf16 v[100:103], v[180:183], v[172:175], v[100:103]
  v_mfma_f32_16x16x32_bf16 v[104:107], v[184:187], v[172:175], v[104:107]
  v_mfma_f32_16x16x32_bf16 v[108:111], v[188:191], v[172:175], v[108:111]
  v_mfma_f32_16x16x32_bf16 v[112:115], v[192:195], v[172:175], v[112:115]
  v_mfma_f32_16x16x32_bf16 v[116:119], v[196:199], v[172:175], v[116:119]
  s_waitcnt lgkmcnt(0)
  v_mfma_f32_16x16x32_bf16 v[24:27], v[136:139], v[120:123], v[24:27]
  ds_read_b128 v[160:163], v9 offset:16384
  v_mfma_f32_16x16x32_bf16 v[28:31], v[140:143], v[120:123], v[28:31]
  ds_read_b128 v[176:179], v10 offset:40960
  v_mfma_f32_16x16x32_bf16 v[32:35], v[144:147], v[120:123], v[32:35]
  ds_read_b128 v[164:167], v9 offset:18432
  v_mfma_f32_16x16x32_bf16 v[36:39], v[148:151], v[120:123], v[36:39]
  ds_read_b128 v[180:183], v10 offset:41984
  v_mfma_f32_16x16x32_bf16 v[40:43], v[152:155], v[120:123], v[40:43]
  ds_read_b128 v[168:171], v9 offset:20480
  v_mfma_f32_16x16x32_bf16 v[44:47], v[156:159], v[120:123], v[44:47]
  ds_read_b128 v[184:187], v10 offset:43008
  v_mfma_f32_16x16x32_bf16 v[48:51], v[136:139], v[124:127], v[48:51]
  ds_read_b128 v[172:175], v9 offset:22528
  v_mfma_f32_16x16x32_bf16 v[52:55], v[140:143], v[124:127], v[52:55]
  ds_read_b128 v[188:191], v10 offset:47104
  v_mfma_f32_16x16x32_bf16 v[56:59], v[144:147], v[124:127], v[56:59]
  ds_read_b128 v[192:195], v10 offset:48128
  v_mfma_f32_16x16x32_bf16 v[60:63], v[148:151], v[124:127], v[60:63]
  ds_read_b128 v[196:199], v10 offset:49152
  v_mfma_f32_16x16x32_bf16 v[64:67], v[152:155], v[124:127], v[64:67]
  v_mfma_f32_16x16x32_bf16 v[68:71], v[156:159], v[124:127], v[68:71]
  v_mfma_f32_16x16x32_bf16 v[72:75], v[136:139], v[128:131], v[72:75]
  v_mfma_f32_16x16x32_bf16 v[76:79], v[140:143], v[128:131], v[76:79]
  v_mfma_f32_16x16x32_bf16 v[80:83], v[144:147], v[128:131], v[80:83]
  v_mfma_f32_16x16x32_bf16 v[84:87], v[148:151], v[128:131], v[84:87]
  v_mfma_f32_16x16x32_bf16 v[88:91], v[152:155], v[128:131], v[88:91]
  v_mfma_f32_16x16x32_bf16 v[92:95], v[156:159], v[128:131], v[92:95]
  v_mfma_f32_16x16x32_bf16 v[96:99], v[136:139], v[132:135], v[96:99]
  v_mfma_f32_16x16x32_bf16 v[100:103], v[140:143], v[132:135], v[100:103]
  v_mfma_f32_16x16x32_bf16 v[104:107], v[144:147], v[132:135], v[104:107]
  v_mfma_f32_16x16x32_bf16 v[108:111], v[148:151], v[132:135], v[108:111]
  v_mfma_f32_16x16x32_bf16 v[112:115], v[152:155], v[132:135], v[112:115]
  v_mfma_f32_16x16x32_bf16 v[116:119], v[156:159], v[132:135], v[116:119]
  s_waitcnt lgkmcnt(0)
  v_mfma_f32_16x16x32_bf16 v[24:27], v[176:179], v[160:163], v[24:27]
  v_mfma_f32_16x16x32_bf16 v[28:31], v[180:183], v[160:163], v[28:31]
  s_barrier
  v_mfma_f32_16x16x32_bf16 v[32:35], v[184:187], v[160:163], v[32:35]
  ds_read_b128 v[120:123], v8 offset:32768
  v_mfma_f32_16x16x32_bf16 v[36:39], v[188:191], v[160:163], v[36:39]
  ds_read_b128 v[136:139], v10 offset:53248
  v_mfma_f32_16x16x32_bf16 v[40:43], v[192:195], v[160:163], v[40:43]
  ds_read_b128 v[124:127], v8 offset:34816
  v_mfma_f32_16x16x32_bf16 v[44:47], v[196:199], v[160:163], v[44:47]
  ds_read_b128 v[140:143], v10 offset:54272
  v_mfma_f32_16x16x32_bf16 v[48:51], v[176:179], v[164:167], v[48:51]
  ds_read_b128 v[128:131], v8 offset:36864
  v_mfma_f32_16x16x32_bf16 v[52:55], v[180:183], v[164:167], v[52:55]
  ds_read_b128 v[144:147], v10 offset:55296
  v_mfma_f32_16x16x32_bf16 v[56:59], v[184:187], v[164:167], v[56:59]
  ds_read_b128 v[132:135], v8 offset:38912
  v_mfma_f32_16x16x32_bf16 v[60:63], v[188:191], v[164:167], v[60:63]
  ds_read_b128 v[148:151], v10 offset:59392
  v_mfma_f32_16x16x32_bf16 v[64:67], v[192:195], v[164:167], v[64:67]
  ds_read_b128 v[152:155], v10 offset:60416
  v_mfma_f32_16x16x32_bf16 v[68:71], v[196:199], v[164:167], v[68:71]
  ds_read_b128 v[156:159], v10 offset:61440
  v_mfma_f32_16x16x32_bf16 v[72:75], v[176:179], v[168:171], v[72:75]
  v_mfma_f32_16x16x32_bf16 v[76:79], v[180:183], v[168:171], v[76:79]
  v_mfma_f32_16x16x32_bf16 v[80:83], v[184:187], v[168:171], v[80:83]
  v_mfma_f32_16x16x32_bf16 v[84:87], v[188:191], v[168:171], v[84:87]
  v_mfma_f32_16x16x32_bf16 v[88:91], v[192:195], v[168:171], v[88:91]
  v_mfma_f32_16x16x32_bf16 v[92:95], v[196:199], v[168:171], v[92:95]
  v_mfma_f32_16x16x32_bf16 v[96:99], v[176:179], v[172:175], v[96:99]
  v_mfma_f32_16x16x32_bf16 v[100:103], v[180:183], v[172:175], v[100:103]
  v_mfma_f32_16x16x32_bf16 v[104:107], v[184:187], v[172:175], v[104:107]
  v_mfma_f32_16x16x32_bf16 v[108:111], v[188:191], v[172:175], v[108:111]
  v_mfma_f32_16x16x32_bf16 v[112:115], v[192:195], v[172:175], v[112:115]
  v_mfma_f32_16x16x32_bf16 v[116:119], v[196:199], v[172:175], v[116:119]
  s_waitcnt lgkmcnt(0)
  v_mfma_f32_16x16x32_bf16 v[24:27], v[136:139], v[120:123], v[24:27]
  ds_read_b128 v[160:163], v9 offset:32768
  v_mfma_f32_16x16x32_bf16 v[28:31], v[140:143], v[120:123], v[28:31]
  ds_read_b128 v[176:179], v11 offset:0
  v_mfma_f32_16x16x32_bf16 v[32:35], v[144:147], v[120:123], v[32:35]
  ds_read_b128 v[164:167], v9 offset:34816
  v_mfma_f32_16x16x32_bf16 v[36:39], v[148:151], v[120:123], v[36:39]
  ds_read_b128 v[180:183], v11 offset:1024
  v_mfma_f32_16x16x32_bf16 v[40:43], v[152:155], v[120:123], v[40:43]
  ds_read_b128 v[168:171], v9 offset:36864
  v_mfma_f32_16x16x32_bf16 v[44:47], v[156:159], v[120:123], v[44:47]
  ds_read_b128 v[184:187], v11 offset:2048
  v_mfma_f32_16x16x32_bf16 v[48:51], v[136:139], v[124:127], v[48:51]
  ds_read_b128 v[172:175], v9 offset:38912
  v_mfma_f32_16x16x32_bf16 v[52:55], v[140:143], v[124:127], v[52:55]
  ds_read_b128 v[188:191], v11 offset:6144
  v_mfma_f32_16x16x32_bf16 v[56:59], v[144:147], v[124:127], v[56:59]
  ds_read_b128 v[192:195], v11 offset:7168
  v_mfma_f32_16x16x32_bf16 v[60:63], v[148:151], v[124:127], v[60:63]
  ds_read_b128 v[196:199], v11 offset:8192
  v_mfma_f32_16x16x32_bf16 v[64:67], v[152:155], v[124:127], v[64:67]
  v_mfma_f32_16x16x32_bf16 v[68:71], v[156:159], v[124:127], v[68:71]
  v_mfma_f32_16x16x32_bf16 v[72:75], v[136:139], v[128:131], v[72:75]
  v_mfma_f32_16x16x32_bf16 v[76:79], v[140:143], v[128:131], v[76:79]
  v_mfma_f32_16x16x32_bf16 v[80:83], v[144:147], v[128:131], v[80:83]
  v_mfma_f32_16x16x32_bf16 v[84:87], v[148:151], v[128:131], v[84:87]
  v_mfma_f32_16x16x32_bf16 v[88:91], v[152:155], v[128:131], v[88:91]
  v_mfma_f32_16x16x32_bf16 v[92:95], v[156:159], v[128:131], v[92:95]
  v_mfma_f32_16x16x32_bf16 v[96:99], v[136:139], v[132:135], v[96:99]
  v_mfma_f32_16x16x32_bf16 v[100:103], v[140:143], v[132:135], v[100:103]
  v_mfma_f32_16x16x32_bf16 v[104:107], v[144:147], v[132:135], v[104:107]
  v_mfma_f32_16x16x32_bf16 v[108:111], v[148:151], v[132:135], v[108:111]
  v_mfma_f32_16x16x32_bf16 v[112:115], v[152:155], v[132:135], v[112:115]
  v_mfma_f32_16x16x32_bf16 v[116:119], v[156:159], v[132:135], v[116:119]
  s_waitcnt lgkmcnt(0)
  v_mfma_f32_16x16x32_bf16 v[24:27], v[176:179], v[160:163], v[24:27]
  v_mfma_f32_16x16x32_bf16 v[28:31], v[180:183], v[160:163], v[28:31]
  s_barrier
  v_mfma_f32_16x16x32_bf16 v[32:35], v[184:187], v[160:163], v[32:35]
  ds_read_b128 v[120:123], v8 offset:49152
  v_mfma_f32_16x16x32_bf16 v[36:39], v[188:191], v[160:163], v[36:39]
  ds_read_b128 v[136:139], v10 offset:4096
  v_mfma_f32_16x16x32_bf16 v[40:43], v[192:195], v[160:163], v[40:43]
  ds_read_b128 v[124:127], v8 offset:51200
  v_mfma_f32_16x16x32_bf16 v[44:47], v[196:199], v[160:163], v[44:47]
  ds_read_b128 v[140:143], v10 offset:5120
  v_mfma_f32_16x16x32_bf16 v[48:51], v[176:179], v[164:167], v[48:51]
  ds_read_b128 v[128:131], v8 offset:53248
  v_mfma_f32_16x16x32_bf16 v[52:55], v[180:183], v[164:167], v[52:55]
  ds_read_b128 v[144:147], v10 offset:6144
  v_mfma_f32_16x16x32_bf16 v[56:59], v[184:187], v[164:167], v[56:59]
  ds_read_b128 v[132:135], v8 offset:55296
  v_mfma_f32_16x16x32_bf16 v[60:63], v[188:191], v[164:167], v[60:63]
  ds_read_b128 v[148:151], v10 offset:10240
  v_mfma_f32_16x16x32_bf16 v[64:67], v[192:195], v[164:167], v[64:67]
  ds_read_b128 v[152:155], v10 offset:11264
  v_mfma_f32_16x16x32_bf16 v[68:71], v[196:199], v[164:167], v[68:71]
  ds_read_b128 v[156:159], v10 offset:12288
  v_mfma_f32_16x16x32_bf16 v[72:75], v[176:179], v[168:171], v[72:75]
  v_mfma_f32_16x16x32_bf16 v[76:79], v[180:183], v[168:171], v[76:79]
  v_mfma_f32_16x16x32_bf16 v[80:83], v[184:187], v[168:171], v[80:83]
  v_mfma_f32_16x16x32_bf16 v[84:87], v[188:191], v[168:171], v[84:87]
  v_mfma_f32_16x16x32_bf16 v[88:91], v[192:195], v[168:171], v[88:91]
  v_mfma_f32_16x16x32_bf16 v[92:95], v[196:199], v[168:171], v[92:95]
  v_mfma_f32_16x16x32_bf16 v[96:99], v[176:179], v[172:175], v[96:99]
  v_mfma_f32_16x16x32_bf16 v[100:103], v[180:183], v[172:175], v[100:103]
  v_mfma_f32_16x16x32_bf16 v[104:107], v[184:187], v[172:175], v[104:107]
  v_mfma_f32_16x16x32_bf16 v[108:111], v[188:191], v[172:175], v[108:111]
  v_mfma_f32_16x16x32_bf16 v[112:115], v[192:195], v[172:175], v[112:115]
  v_mfma_f32_16x16x32_bf16 v[116:119], v[196:199], v[172:175], v[116:119]
  s_waitcnt lgkmcnt(0)
  v_mfma_f32_16x16x32_bf16 v[24:27], v[136:139], v[120:123], v[24:27]
  ds_read_b128 v[160:163], v9 offset:49152
  v_mfma_f32_16x16x32_bf16 v[28:31], v[140:143], v[120:123], v[28:31]
  ds_read_b128 v[176:179], v10 offset:16384
  v_mfma_f32_16x16x32_bf16 v[32:35], v[144:147], v[120:123], v[32:35]
  ds_read_b128 v[164:167], v9 offset:51200
  v_mfma_f32_16x16x32_bf16 v[36:39], v[148:151], v[120:123], v[36:39]
  ds_read_b128 v[180:183], v10 offset:17408
  v_mfma_f32_16x16x32_bf16 v[40:43], v[152:155], v[120:123], v[40:43]
  ds_read_b128 v[168:171], v9 offset:53248
  v_mfma_f32_16x16x32_bf16 v[44:47], v[156:159], v[120:123], v[44:47]
  ds_read_b128 v[184:187], v10 offset:18432
  v_mfma_f32_16x16x32_bf16 v[48:51], v[136:139], v[124:127], v[48:51]
  ds_read_b128 v[172:175], v9 offset:55296
  v_mfma_f32_16x16x32_bf16 v[52:55], v[140:143], v[124:127], v[52:55]
  ds_read_b128 v[188:191], v10 offset:22528
  v_mfma_f32_16x16x32_bf16 v[56:59], v[144:147], v[124:127], v[56:59]
  ds_read_b128 v[192:195], v10 offset:23552
  v_mfma_f32_16x16x32_bf16 v[60:63], v[148:151], v[124:127], v[60:63]
  ds_read_b128 v[196:199], v10 offset:24576
  v_mfma_f32_16x16x32_bf16 v[64:67], v[152:155], v[124:127], v[64:67]
  v_mfma_f32_16x16x32_bf16 v[68:71], v[156:159], v[124:127], v[68:71]
  v_mfma_f32_16x16x32_bf16 v[72:75], v[136:139], v[128:131], v[72:75]
  v_mfma_f32_16x16x32_bf16 v[76:79], v[140:143], v[128:131], v[76:79]
  v_mfma_f32_16x16x32_bf16 v[80:83], v[144:147], v[128:131], v[80:83]
  v_mfma_f32_16x16x32_bf16 v[84:87], v[148:151], v[128:131], v[84:87]
  v_mfma_f32_16x16x32_bf16 v[88:91], v[152:155], v[128:131], v[88:91]
  v_mfma_f32_16x16x32_bf16 v[92:95], v[156:159], v[128:131], v[92:95]
  v_mfma_f32_16x16x32_bf16 v[96:99], v[136:139], v[132:135], v[96:99]
  v_mfma_f32_16x16x32_bf16 v[100:103], v[140:143], v[132:135], v[100:103]
  v_mfma_f32_16x16x32_bf16 v[104:107], v[144:147], v[132:135], v[104:107]
  v_mfma_f32_16x16x32_bf16 v[108:111], v[148:151], v[132:135], v[108:111]
  v_mfma_f32_16x16x32_bf16 v[112:115], v[152:155], v[132:135], v[112:115]
  v_mfma_f32_16x16x32_bf16 v[116:119], v[156:159], v[132:135], v[116:119]
  s_waitcnt lgkmcnt(0)
  v_mfma_f32_16x16x32_bf16 v[24:27], v[176:179], v[160:163], v[24:27]
  v_mfma_f32_16x16x32_bf16 v[28:31], v[180:183], v[160:163], v[28:31]
  s_barrier
  v_mfma_f32_16x16x32_bf16 v[32:35], v[184:187], v[160:163], v[32:35]
  ds_read_b128 v[120:123], v8 offset:0
  v_mfma_f32_16x16x32_bf16 v[36:39], v[188:191], v[160:163], v[36:39]
  ds_read_b128 v[136:139], v10 offset:28672
  v_mfma_f32_16x16x32_bf16 v[40:43], v[192:195], v[160:163], v[40:43]
  ds_read_b128 v[124:127], v8 offset:2048
  v_mfma_f32_16x16x32_bf16 v[44:47], v[196:199], v[160:163], v[44:47]
  ds_read_b128 v[140:143], v10 offset:29696
  v_mfma_f32_16x16x32_bf16 v[48:51], v[176:179], v[164:167], v[48:51]
  ds_read_b128 v[128:131], v8 offset:4096
  v_mfma_f32_16x16x32_bf16 v[52:55], v[180:183], v[164:167], v[52:55]
  ds_read_b128 v[144:147], v10 offset:30720
  v_mfma_f32_16x16x32_bf16 v[56:59], v[184:187], v[164:167], v[56:59]
  ds_read_b128 v[132:135], v8 offset:6144
  v_mfma_f32_16x16x32_bf16 v[60:63], v[188:191], v[164:167], v[60:63]
  ds_read_b128 v[148:151], v10 offset:34816
  v_mfma_f32_16x16x32_bf16 v[64:67], v[192:195], v[164:167], v[64:67]
  ds_read_b128 v[152:155], v10 offset:35840
  v_mfma_f32_16x16x32_bf16 v[68:71], v[196:199], v[164:167], v[68:71]
  ds_read_b128 v[156:159], v10 offset:36864
  v_mfma_f32_16x16x32_bf16 v[72:75], v[176:179], v[168:171], v[72:75]
  v_mfma_f32_16x16x32_bf16 v[76:79], v[180:183], v[168:171], v[76:79]
  v_mfma_f32_16x16x32_bf16 v[80:83], v[184:187], v[168:171], v[80:83]
  v_mfma_f32_16x16x32_bf16 v[84:87], v[188:191], v[168:171], v[84:87]
  v_mfma_f32_16x16x32_bf16 v[88:91], v[192:195], v[168:171], v[88:91]
  v_mfma_f32_16x16x32_bf16 v[92:95], v[196:199], v[168:171], v[92:95]
  v_mfma_f32_16x16x32_bf16 v[96:99], v[176:179], v[172:175], v[96:99]
  v_mfma_f32_16x16x32_bf16 v[100:103], v[180:183], v[172:175], v[100:103]
  v_mfma_f32_16x16x32_bf16 v[104:107], v[184:187], v[172:175], v[104:107]
  v_mfma_f32_16x16x32_bf16 v[108:111], v[188:191], v[172:175], v[108:111]
  v_mfma_f32_16x16x32_bf16 v[112:115], v[192:195], v[172:175], v[112:115]
  v_mfma_f32_16x16x32_bf16 v[116:119], v[196:199], v[172:175], v[116:119]
  s_waitcnt lgkmcnt(0)
  v_mfma_f32_16x16x32_bf16 v[24:27], v[136:139], v[120:123], v[24:27]
  ds_read_b128 v[160:163], v9 offset:0
  v_mfma_f32_16x16x32_bf16 v[28:31], v[140:143], v[120:123], v[28:31]
  ds_read_b128 v[176:179], v10 offset:40960
  v_mfma_f32_16x16x32_bf16 v[32:35], v[144:147], v[120:123], v[32:35]
  ds_read_b128 v[164:167], v9 offset:2048
  v_mfma_f32_16x16x32_bf16 v[36:39], v[148:151], v[120:123], v[36:39]
  ds_read_b128 v[180:183], v10 offset:41984
  v_mfma_f32_16x16x32_bf16 v[40:43], v[152:155], v[120:123], v[40:43]
  ds_read_b128 v[168:171], v9 offset:4096
  v_mfma_f32_16x16x32_bf16 v[44:47], v[156:159], v[120:123], v[44:47]
  ds_read_b128 v[184:187], v10 offset:43008
  v_mfma_f32_16x16x32_bf16 v[48:51], v[136:139], v[124:127], v[48:51]
  ds_read_b128 v[172:175], v9 offset:6144
  v_mfma_f32_16x16x32_bf16 v[52:55], v[140:143], v[124:127], v[52:55]
  ds_read_b128 v[188:191], v10 offset:47104
  v_mfma_f32_16x16x32_bf16 v[56:59], v[144:147], v[124:127], v[56:59]
  ds_read_b128 v[192:195], v10 offset:48128
  v_mfma_f32_16x16x32_bf16 v[60:63], v[148:151], v[124:127], v[60:63]
  ds_read_b128 v[196:199], v10 offset:49152
  v_mfma_f32_16x16x32_bf16 v[64:67], v[152:155], v[124:127], v[64:67]
  v_mfma_f32_16x16x32_bf16 v[68:71], v[156:159], v[124:127], v[68:71]
  v_mfma_f32_16x16x32_bf16 v[72:75], v[136:139], v[128:131], v[72:75]
  v_mfma_f32_16x16x32_bf16 v[76:79], v[140:143], v[128:131], v[76:79]
  v_mfma_f32_16x16x32_bf16 v[80:83], v[144:147], v[128:131], v[80:83]
  v_mfma_f32_16x16x32_bf16 v[84:87], v[148:151], v[128:131], v[84:87]
  v_mfma_f32_16x16x32_bf16 v[88:91], v[152:155], v[128:131], v[88:91]
  v_mfma_f32_16x16x32_bf16 v[92:95], v[156:159], v[128:131], v[92:95]
  v_mfma_f32_16x16x32_bf16 v[96:99], v[136:139], v[132:135], v[96:99]
  v_mfma_f32_16x16x32_bf16 v[100:103], v[140:143], v[132:135], v[100:103]
  v_mfma_f32_16x16x32_bf16 v[104:107], v[144:147], v[132:135], v[104:107]
  v_mfma_f32_16x16x32_bf16 v[108:111], v[148:151], v[132:135], v[108:111]
  v_mfma_f32_16x16x32_bf16 v[112:115], v[152:155], v[132:135], v[112:115]
  v_mfma_f32_16x16x32_bf16 v[116:119], v[156:159], v[132:135], v[116:119]
  s_waitcnt lgkmcnt(0)
  v_mfma_f32_16x16x32_bf16 v[24:27], v[176:179], v[160:163], v[24:27]
  v_mfma_f32_16x16x32_bf16 v[28:31], v[180:183], v[160:163], v[28:31]
  s_barrier
  v_mfma_f32_16x16x32_bf16 v[32:35], v[184:187], v[160:163], v[32:35]
  ds_read_b128 v[120:123], v8 offset:16384
  v_mfma_f32_16x16x32_bf16 v[36:39], v[188:191], v[160:163], v[36:39]
  ds_read_b128 v[136:139], v10 offset:53248
  v_mfma_f32_16x16x32_bf16 v[40:43], v[192:195], v[160:163], v[40:43]
  ds_read_b128 v[124:127], v8 offset:18432
  v_mfma_f32_16x16x32_bf16 v[44:47], v[196:199], v[160:163], v[44:47]
  ds_read_b128 v[140:143], v10 offset:54272
  v_mfma_f32_16x16x32_bf16 v[48:51], v[176:179], v[164:167], v[48:51]
  ds_read_b128 v[128:131], v8 offset:20480
  v_mfma_f32_16x16x32_bf16 v[52:55], v[180:183], v[164:167], v[52:55]
  ds_read_b128 v[144:147], v10 offset:55296
  v_mfma_f32_16x16x32_bf16 v[56:59], v[184:187], v[164:167], v[56:59]
  ds_read_b128 v[132:135], v8 offset:22528
  v_mfma_f32_16x16x32_bf16 v[60:63], v[188:191], v[164:167], v[60:63]
  ds_read_b128 v[148:151], v10 offset:59392
  v_mfma_f32_16x16x32_bf16 v[64:67], v[192:195], v[164:167], v[64:67]
  ds_read_b128 v[152:155], v10 offset:60416
  v_mfma_f32_16x16x32_bf16 v[68:71], v[196:199], v[164:167], v[68:71]
  ds_read_b128 v[156:159], v10 offset:61440
  v_mfma_f32_16x16x32_bf16 v[72:75], v[176:179], v[168:171], v[72:75]
  v_mfma_f32_16x16x32_bf16 v[76:79], v[180:183], v[168:171], v[76:79]
  v_mfma_f32_16x16x32_bf16 v[80:83], v[184:187], v[168:171], v[80:83]
  v_mfma_f32_16x16x32_bf16 v[84:87], v[188:191], v[168:171], v[84:87]
  v_mfma_f32_16x16x32_bf16 v[88:91], v[192:195], v[168:171], v[88:91]
  v_mfma_f32_16x16x32_bf16 v[92:95], v[196:199], v[168:171], v[92:95]
  v_mfma_f32_16x16x32_bf16 v[96:99], v[176:179], v[172:175], v[96:99]
  v_mfma_f32_16x16x32_bf16 v[100:103], v[180:183], v[172:175], v[100:103]
  v_mfma_f32_16x16x32_bf16 v[104:107], v[184:187], v[172:175], v[104:107]
  v_mfma_f32_16x16x32_bf16 v[108:111], v[188:191], v[172:175], v[108:111]
  v_mfma_f32_16x16x32_bf16 v[112:115], v[192:195], v[172:175], v[112:115]
  v_mfma_f32_16x16x32_bf16 v[116:119], v[196:199], v[172:175], v[116:119]
  s_waitcnt lgkmcnt(0)
  v_mfma_f32_16x16x32_bf16 v[24:27], v[136:139], v[120:123], v[24:27]
  ds_read_b128 v[160:163], v9 offset:16384
  v_mfma_f32_16x16x32_bf16 v[28:31], v[140:143], v[120:123], v[28:31]
  ds_read_b128 v[176:179], v11 offset:0
  v_mfma_f32_16x16x32_bf16 v[32:35], v[144:147], v[120:123], v[32:35]
  ds_read_b128 v[164:167], v9 offset:18432
  v_mfma_f32_16x16x32_bf16 v[36:39], v[148:151], v[120:123], v[36:39]
  ds_read_b128 v[180:183], v11 offset:1024
  v_mfma_f32_16x16x32_bf16 v[40:43], v[152:155], v[120:123], v[40:43]
  ds_read_b128 v[168:171], v9 offset:20480
  v_mfma_f32_16x16x32_bf16 v[44:47], v[156:159], v[120:123], v[44:47]
  ds_read_b128 v[184:187], v11 offset:2048
  v_mfma_f32_16x16x32_bf16 v[48:51], v[136:139], v[124:127], v[48:51]
  ds_read_b128 v[172:175], v9 offset:22528
  v_mfma_f32_16x16x32_bf16 v[52:55], v[140:143], v[124:127], v[52:55]
  ds_read_b128 v[188:191], v11 offset:6144
  v_mfma_f32_16x16x32_bf16 v[56:59], v[144:147], v[124:127], v[56:59]
  ds_read_b128 v[192:195], v11 offset:7168
  v_mfma_f32_16x16x32_bf16 v[60:63], v[148:151], v[124:127], v[60:63]
  ds_read_b128 v[196:199], v11 offset:8192
  v_mfma_f32_16x16x32_bf16 v[64:67], v[152:155], v[124:127], v[64:67]
  v_mfma_f32_16x16x32_bf16 v[68:71], v[156:159], v[124:127], v[68:71]
  v_mfma_f32_16x16x32_bf16 v[72:75], v[136:139], v[128:131], v[72:75]
  v_mfma_f32_16x16x32_bf16 v[76:79], v[140:143], v[128:131], v[76:79]
  v_mfma_f32_16x16x32_bf16 v[80:83], v[144:147], v[128:131], v[80:83]
  v_mfma_f32_16x16x32_bf16 v[84:87], v[148:151], v[128:131], v[84:87]
  v_mfma_f32_16x16x32_bf16 v[88:91], v[152:155], v[128:131], v[88:91]
  v_mfma_f32_16x16x32_bf16 v[92:95], v[156:159], v[128:131], v[92:95]
  v_mfma_f32_16x16x32_bf16 v[96:99], v[136:139], v[132:135], v[96:99]
  v_mfma_f32_16x16x32_bf16 v[100:103], v[140:143], v[132:135], v[100:103]
  v_mfma_f32_16x16x32_bf16 v[104:107], v[144:147], v[132:135], v[104:107]
  v_mfma_f32_16x16x32_bf16 v[108:111], v[148:151], v[132:135], v[108:111]
  v_mfma_f32_16x16x32_bf16 v[112:115], v[152:155], v[132:135], v[112:115]
  v_mfma_f32_16x16x32_bf16 v[116:119], v[156:159], v[132:135], v[116:119]
  s_waitcnt lgkmcnt(0)
  v_mfma_f32_16x16x32_bf16 v[24:27], v[176:179], v[160:163], v[24:27]
  v_mfma_f32_16x16x32_bf16 v[28:31], v[180:183], v[160:163], v[28:31]
  s_barrier
  v_mfma_f32_16x16x32_bf16 v[32:35], v[184:187], v[160:163], v[32:35]
  ds_read_b128 v[120:123], v8 offset:32768
  v_mfma_f32_16x16x32_bf16 v[36:39], v[188:191], v[160:163], v[36:39]
  ds_read_b128 v[136:139], v10 offset:4096
  v_mfma_f32_16x16x32_bf16 v[40:43], v[192:195], v[160:163], v[40:43]
  ds_read_b128 v[124:127], v8 offset:34816
  v_mfma_f32_16x16x32_bf16 v[44:47], v[196:199], v[160:163], v[44:47]
  ds_read_b128 v[140:143], v10 offset:5120
  v_mfma_f32_16x16x32_bf16 v[48:51], v[176:179], v[164:167], v[48:51]
  ds_read_b128 v[128:131], v8 offset:36864
  v_mfma_f32_16x16x32_bf16 v[52:55], v[180:183], v[164:167], v[52:55]
  ds_read_b128 v[144:147], v10 offset:6144
  v_mfma_f32_16x16x32_bf16 v[56:59], v[184:187], v[164:167], v[56:59]
  ds_read_b128 v[132:135], v8 offset:38912
  v_mfma_f32_16x16x32_bf16 v[60:63], v[188:191], v[164:167], v[60:63]
  ds_read_b128 v[148:151], v10 offset:10240
  v_mfma_f32_16x16x32_bf16 v[64:67], v[192:195], v[164:167], v[64:67]
  ds_read_b128 v[152:155], v10 offset:11264
  v_mfma_f32_16x16x32_bf16 v[68:71], v[196:199], v[164:167], v[68:71]
  ds_read_b128 v[156:159], v10 offset:12288
  v_mfma_f32_16x16x32_bf16 v[72:75], v[176:179], v[168:171], v[72:75]
  v_mfma_f32_16x16x32_bf16 v[76:79], v[180:183], v[168:171], v[76:79]
  v_mfma_f32_16x16x32_bf16 v[80:83], v[184:187], v[168:171], v[80:83]
  v_mfma_f32_16x16x32_bf16 v[84:87], v[188:191], v[168:171], v[84:87]
  v_mfma_f32_16x16x32_bf16 v[88:91], v[192:195], v[168:171], v[88:91]
  v_mfma_f32_16x16x32_bf16 v[92:95], v[196:199], v[168:171], v[92:95]
  v_mfma_f32_16x16x32_bf16 v[96:99], v[176:179], v[172:175], v[96:99]
  v_mfma_f32_16x16x32_bf16 v[100:103], v[180:183], v[172:175], v[100:103]
  v_mfma_f32_16x16x32_bf16 v[104:107], v[184:187], v[172:175], v[104:107]
  v_mfma_f32_16x16x32_bf16 v[108:111], v[188:191], v[172:175], v[108:111]
  v_mfma_f32_16x16x32_bf16 v[112:115], v[192:195], v[172:175], v[112:115]
  v_mfma_f32_16x16x32_bf16 v[116:119], v[196:199], v[172:175], v[116:119]
  s_waitcnt lgkmcnt(0)
  v_mfma_f32_16x16x32_bf16 v[24:27], v[136:139], v[120:123], v[24:27]
  ds_read_b128 v[160:163], v9 offset:32768
  v_mfma_f32_16x16x32_bf16 v[28:31], v[140:143], v[120:123], v[28:31]
  ds_read_b128 v[176:179], v10 offset:16384
  v_mfma_f32_16x16x32_bf16 v[32:35], v[144:147], v[120:123], v[32:35]
  ds_read_b128 v[164:167], v9 offset:34816
  v_mfma_f32_16x16x32_bf16 v[36:39], v[148:151], v[120:123], v[36:39]
  ds_read_b128 v[180:183], v10 offset:17408
  v_mfma_f32_16x16x32_bf16 v[40:43], v[152:155], v[120:123], v[40:43]
  ds_read_b128 v[168:171], v9 offset:36864
  v_mfma_f32_16x16x32_bf16 v[44:47], v[156:159], v[120:123], v[44:47]
  ds_read_b128 v[184:187], v10 offset:18432
  v_mfma_f32_16x16x32_bf16 v[48:51], v[136:139], v[124:127], v[48:51]
  ds_read_b128 v[172:175], v9 offset:38912
  v_mfma_f32_16x16x32_bf16 v[52:55], v[140:143], v[124:127], v[52:55]
  ds_read_b128 v[188:191], v10 offset:22528
  v_mfma_f32_16x16x32_bf16 v[56:59], v[144:147], v[124:127], v[56:59]
  ds_read_b128 v[192:195], v10 offset:23552
  v_mfma_f32_16x16x32_bf16 v[60:63], v[148:151], v[124:127], v[60:63]
  ds_read_b128 v[196:199], v10 offset:24576
  v_mfma_f32_16x16x32_bf16 v[64:67], v[152:155], v[124:127], v[64:67]
  v_mfma_f32_16x16x32_bf16 v[68:71], v[156:159], v[124:127], v[68:71]
  v_mfma_f32_16x16x32_bf16 v[72:75], v[136:139], v[128:131], v[72:75]
  v_mfma_f32_16x16x32_bf16 v[76:79], v[140:143], v[128:131], v[76:79]
  v_mfma_f32_16x16x32_bf16 v[80:83], v[144:147], v[128:131], v[80:83]
  v_mfma_f32_16x16x32_bf16 v[84:87], v[148:151], v[128:131], v[84:87]
  v_mfma_f32_16x16x32_bf16 v[88:91], v[152:155], v[128:131], v[88:91]
  v_mfma_f32_16x16x32_bf16 v[92:95], v[156:159], v[128:131], v[92:95]
  v_mfma_f32_16x16x32_bf16 v[96:99], v[136:139], v[132:135], v[96:99]
  v_mfma_f32_16x16x32_bf16 v[100:103], v[140:143], v[132:135], v[100:103]
  v_mfma_f32_16x16x32_bf16 v[104:107], v[144:147], v[132:135], v[104:107]
  v_mfma_f32_16x16x32_bf16 v[108:111], v[148:151], v[132:135], v[108:111]
  v_mfma_f32_16x16x32_bf16 v[112:115], v[152:155], v[132:135], v[112:115]
  v_mfma_f32_16x16x32_bf16 v[116:119], v[156:159], v[132:135], v[116:119]
  s_waitcnt lgkmcnt(0)
  v_mfma_f32_16x16x32_bf16 v[24:27], v[176:179], v[160:163], v[24:27]
  v_mfma_f32_16x16x32_bf16 v[28:31], v[180:183], v[160:163], v[28:31]
  s_barrier
  v_mfma_f32_16x16x32_bf16 v[32:35], v[184:187], v[160:163], v[32:35]
  ds_read_b128 v[120:123], v8 offset:49152
  v_mfma_f32_16x16x32_bf16 v[36:39], v[188:191], v[160:163], v[36:39]
  ds_read_b128 v[136:139], v10 offset:28672
  v_mfma_f32_16x16x32_bf16 v[40:43], v[192:195], v[160:163], v[40:43]
  ds_read_b128 v[124:127], v8 offset:51200
  v_mfma_f32_16x16x32_bf16 v[44:47], v[196:199], v[160:163], v[44:47]
  ds_read_b128 v[140:143], v10 offset:29696
  v_mfma_f32_16x16x32_bf16 v[48:51], v[176:179], v[164:167], v[48:51]
  ds_read_b128 v[128:131], v8 offset:53248
  v_mfma_f32_16x16x32_bf16 v[52:55], v[180:183], v[164:167], v[52:55]
  ds_read_b128 v[144:147], v10 offset:30720
  v_mfma_f32_16x16x32_bf16 v[56:59], v[184:187], v[164:167], v[56:59]
  ds_read_b128 v[132:135], v8 offset:55296
  v_mfma_f32_16x16x32_bf16 v[60:63], v[188:191], v[164:167], v[60:63]
  ds_read_b128 v[148:151], v10 offset:34816
  v_mfma_f32_16x16x32_bf16 v[64:67], v[192:195], v[164:167], v[64:67]
  ds_read_b128 v[152:155], v10 offset:35840
  v_mfma_f32_16x16x32_bf16 v[68:71], v[196:199], v[164:167], v[68:71]
  ds_read_b128 v[156:159], v10 offset:36864
  v_mfma_f32_16x16x32_bf16 v[72:75], v[176:179], v[168:171], v[72:75]
  v_mfma_f32_16x16x32_bf16 v[76:79], v[180:183], v[168:171], v[76:79]
  v_mfma_f32_16x16x32_bf16 v[80:83], v[184:187], v[168:171], v[80:83]
  v_mfma_f32_16x16x32_bf16 v[84:87], v[188:191], v[168:171], v[84:87]
  v_mfma_f32_16x16x32_bf16 v[88:91], v[192:195], v[168:171], v[88:91]
  v_mfma_f32_16x16x32_bf16 v[92:95], v[196:199], v[168:171], v[92:95]
  v_mfma_f32_16x16x32_bf16 v[96:99], v[176:179], v[172:175], v[96:99]
  v_mfma_f32_16x16x32_bf16 v[100:103], v[180:183], v[172:175], v[100:103]
  v_mfma_f32_16x16x32_bf16 v[104:107], v[184:187], v[172:175], v[104:107]
  v_mfma_f32_16x16x32_bf16 v[108:111], v[188:191], v[172:175], v[108:111]
  v_mfma_f32_16x16x32_bf16 v[112:115], v[192:195], v[172:175], v[112:115]
  v_mfma_f32_16x16x32_bf16 v[116:119], v[196:199], v[172:175], v[116:119]
  s_waitcnt lgkmcnt(0)
  v_mfma_f32_16x16x32_bf16 v[24:27], v[136:139], v[120:123], v[24:27]
  ds_read_b128 v[160:163], v9 offset:49152
  v_mfma_f32_16x16x32_bf16 v[28:31], v[140:143], v[120:123], v[28:31]
  ds_read_b128 v[176:179], v10 offset:40960
  v_mfma_f32_16x16x32_bf16 v[32:35], v[144:147], v[120:123], v[32:35]
  ds_read_b128 v[164:167], v9 offset:51200
  v_mfma_f32_16x16x32_bf16 v[36:39], v[148:151], v[120:123], v[36:39]
  ds_read_b128 v[180:183], v10 offset:41984
  v_mfma_f32_16x16x32_bf16 v[40:43], v[152:155], v[120:123], v[40:43]
  ds_read_b128 v[168:171], v9 offset:53248
  v_mfma_f32_16x16x32_bf16 v[44:47], v[156:159], v[120:123], v[44:47]
  ds_read_b128 v[184:187], v10 offset:43008
  v_mfma_f32_16x16x32_bf16 v[48:51], v[136:139], v[124:127], v[48:51]
  ds_read_b128 v[172:175], v9 offset:55296
  v_mfma_f32_16x16x32_bf16 v[52:55], v[140:143], v[124:127], v[52:55]
  ds_read_b128 v[188:191], v10 offset:47104
  v_mfma_f32_16x16x32_bf16 v[56:59], v[144:147], v[124:127], v[56:59]
  ds_read_b128 v[192:195], v10 offset:48128
  v_mfma_f32_16x16x32_bf16 v[60:63], v[148:151], v[124:127], v[60:63]
  ds_read_b128 v[196:199], v10 offset:49152
  v_mfma_f32_16x16x32_bf16 v[64:67], v[152:155], v[124:127], v[64:67]
  v_mfma_f32_16x16x32_bf16 v[68:71], v[156:159], v[124:127], v[68:71]
  v_mfma_f32_16x16x32_bf16 v[72:75], v[136:139], v[128:131], v[72:75]
  v_mfma_f32_16x16x32_bf16 v[76:79], v[140:143], v[128:131], v[76:79]
  v_mfma_f32_16x16x32_bf16 v[80:83], v[144:147], v[128:131], v[80:83]
  v_mfma_f32_16x16x32_bf16 v[84:87], v[148:151], v[128:131], v[84:87]
  v_mfma_f32_16x16x32_bf16 v[88:91], v[152:155], v[128:131], v[88:91]
  v_mfma_f32_16x16x32_bf16 v[92:95], v[156:159], v[128:131], v[92:95]
  v_mfma_f32_16x16x32_bf16 v[96:99], v[136:139], v[132:135], v[96:99]
  v_mfma_f32_16x16x32_bf16 v[100:103], v[140:143], v[132:135], v[100:103]
  v_mfma_f32_16x16x32_bf16 v[104:107], v[144:147], v[132:135], v[104:107]
  v_mfma_f32_16x16x32_bf16 v[108:111], v[148:151], v[132:135], v[108:111]
  v_mfma_f32_16x16x32_bf16 v[112:115], v[152:155], v[132:135], v[112:115]
  v_mfma_f32_16x16x32_bf16 v[116:119], v[156:159], v[132:135], v[116:119]
  s_waitcnt lgkmcnt(0)
  v_mfma_f32_16x16x32_bf16 v[24:27], v[176:179], v[160:163], v[24:27]
  v_mfma_f32_16x16x32_bf16 v[28:31], v[180:183], v[160:163], v[28:31]
  s_barrier
  v_mfma_f32_16x16x32_bf16 v[32:35], v[184:187], v[160:163], v[32:35]
  ds_read_b128 v[120:123], v8 offset:0
  v_mfma_f32_16x16x32_bf16 v[36:39], v[188:191], v[160:163], v[36:39]
  ds_read_b128 v[136:139], v10 offset:53248
  v_mfma_f32_16x16x32_bf16 v[40:43], v[192:195], v[160:163], v[40:43]
  ds_read_b128 v[124:127], v8 offset:2048
  v_mfma_f32_16x16x32_bf16 v[44:47], v[196:199], v[160:163], v[44:47]
  ds_read_b128 v[140:143], v10 offset:54272
  v_mfma_f32_16x16x32_bf16 v[48:51], v[176:179], v[164:167], v[48:51]
  ds_read_b128 v[128:131], v8 offset:4096
  v_mfma_f32_16x16x32_bf16 v[52:55], v[180:183], v[164:167], v[52:55]
  ds_read_b128 v[144:147], v10 offset:55296
  v_mfma_f32_16x16x32_bf16 v[56:59], v[184:187], v[164:167], v[56:59]
  ds_read_b128 v[132:135], v8 offset:6144
  v_mfma_f32_16x16x32_bf16 v[60:63], v[188:191], v[164:167], v[60:63]
  ds_read_b128 v[148:151], v10 offset:59392
  v_mfma_f32_16x16x32_bf16 v[64:67], v[192:195], v[164:167], v[64:67]
  ds_read_b128 v[152:155], v10 offset:60416
  v_mfma_f32_16x16x32_bf16 v[68:71], v[196:199], v[164:167], v[68:71]
  ds_read_b128 v[156:159], v10 offset:61440
  v_mfma_f32_16x16x32_bf16 v[72:75], v[176:179], v[168:171], v[72:75]
  v_mfma_f32_16x16x32_bf16 v[76:79], v[180:183], v[168:171], v[76:79]
  v_mfma_f32_16x16x32_bf16 v[80:83], v[184:187], v[168:171], v[80:83]
  v_mfma_f32_16x16x32_bf16 v[84:87], v[188:191], v[168:171], v[84:87]
  v_mfma_f32_16x16x32_bf16 v[88:91], v[192:195], v[168:171], v[88:91]
  v_mfma_f32_16x16x32_bf16 v[92:95], v[196:199], v[168:171], v[92:95]
  v_mfma_f32_16x16x32_bf16 v[96:99], v[176:179], v[172:175], v[96:99]
  v_mfma_f32_16x16x32_bf16 v[100:103], v[180:183], v[172:175], v[100:103]
  v_mfma_f32_16x16x32_bf16 v[104:107], v[184:187], v[172:175], v[104:107]
  v_mfma_f32_16x16x32_bf16 v[108:111], v[188:191], v[172:175], v[108:111]
  v_mfma_f32_16x16x32_bf16 v[112:115], v[192:195], v[172:175], v[112:115]
  v_mfma_f32_16x16x32_bf16 v[116:119], v[196:199], v[172:175], v[116:119]
  s_waitcnt lgkmcnt(0)
  v_mfma_f32_16x16x32_bf16 v[24:27], v[136:139], v[120:123], v[24:27]
  ds_read_b128 v[160:163], v9 offset:0
  v_mfma_f32_16x16x32_bf16 v[28:31], v[140:143], v[120:123], v[28:31]
  ds_read_b128 v[176:179], v11 offset:0
  v_mfma_f32_16x16x32_bf16 v[32:35], v[144:147], v[120:123], v[32:35]
  ds_read_b128 v[164:167], v9 offset:2048
  v_mfma_f32_16x16x32_bf16 v[36:39], v[148:151], v[120:123], v[36:39]
  ds_read_b128 v[180:183], v11 offset:1024
  v_mfma_f32_16x16x32_bf16 v[40:43], v[152:155], v[120:123], v[40:43]
  ds_read_b128 v[168:171], v9 offset:4096
  v_mfma_f32_16x16x32_bf16 v[44:47], v[156:159], v[120:123], v[44:47]
  ds_read_b128 v[184:187], v11 offset:2048
  v_mfma_f32_16x16x32_bf16 v[48:51], v[136:139], v[124:127], v[48:51]
  ds_read_b128 v[172:175], v9 offset:6144
  v_mfma_f32_16x16x32_bf16 v[52:55], v[140:143], v[124:127], v[52:55]
  ds_read_b128 v[188:191], v11 offset:6144
  v_mfma_f32_16x16x32_bf16 v[56:59], v[144:147], v[124:127], v[56:59]
  ds_read_b128 v[192:195], v11 offset:7168
  v_mfma_f32_16x16x32_bf16 v[60:63], v[148:151], v[124:127], v[60:63]
  ds_read_b128 v[196:199], v11 offset:8192
  v_mfma_f32_16x16x32_bf16 v[64:67], v[152:155], v[124:127], v[64:67]
  v_mfma_f32_16x16x32_bf16 v[68:71], v[156:159], v[124:127], v[68:71]
  v_mfma_f32_16x16x32_bf16 v[72:75], v[136:139], v[128:131], v[72:75]
  v_mfma_f32_16x16x32_bf16 v[76:79], v[140:143], v[128:131], v[76:79]
  v_mfma_f32_16x16x32_bf16 v[80:83], v[144:147], v[128:131], v[80:83]
  v_mfma_f32_16x16x32_bf16 v[84:87], v[148:151], v[128:131], v[84:87]
  v_mfma_f32_16x16x32_bf16 v[88:91], v[152:155], v[128:131], v[88:91]
  v_mfma_f32_16x16x32_bf16 v[92:95], v[156:159], v[128:131], v[92:95]
  v_mfma_f32_16x16x32_bf16 v[96:99], v[136:139], v[132:135], v[96:99]
  v_mfma_f32_16x16x32_bf16 v[100:103], v[140:143], v[132:135], v[100:103]
  v_mfma_f32_16x16x32_bf16 v[104:107], v[144:147], v[132:135], v[104:107]
  v_mfma_f32_16x16x32_bf16 v[108:111], v[148:151], v[132:135], v[108:111]
  v_mfma_f32_16x16x32_bf16 v[112:115], v[152:155], v[132:135], v[112:115]
  v_mfma_f32_16x16x32_bf16 v[116:119], v[156:159], v[132:135], v[116:119]
  s_waitcnt lgkmcnt(0)
  v_mfma_f32_16x16x32_bf16 v[24:27], v[176:179], v[160:163], v[24:27]
  v_mfma_f32_16x16x32_bf16 v[28:31], v[180:183], v[160:163], v[28:31]
  s_barrier
  v_mfma_f32_16x16x32_bf16 v[32:35], v[184:187], v[160:163], v[32:35]
  ds_read_b128 v[120:123], v8 offset:16384
  v_mfma_f32_16x16x32_bf16 v[36:39], v[188:191], v[160:163], v[36:39]
  ds_read_b128 v[136:139], v10 offset:4096
  v_mfma_f32_16x16x32_bf16 v[40:43], v[192:195], v[160:163], v[40:43]
  ds_read_b128 v[124:127], v8 offset:18432
  v_mfma_f32_16x16x32_bf16 v[44:47], v[196:199], v[160:163], v[44:47]
  ds_read_b128 v[140:143], v10 offset:5120
  v_mfma_f32_16x16x32_bf16 v[48:51], v[176:179], v[164:167], v[48:51]
  ds_read_b128 v[128:131], v8 offset:20480
  v_mfma_f32_16x16x32_bf16 v[52:55], v[180:183], v[164:167], v[52:55]
  ds_read_b128 v[144:147], v10 offset:6144
  v_mfma_f32_16x16x32_bf16 v[56:59], v[184:187], v[164:167], v[56:59]
  ds_read_b128 v[132:135], v8 offset:22528
  v_mfma_f32_16x16x32_bf16 v[60:63], v[188:191], v[164:167], v[60:63]
  ds_read_b128 v[148:151], v10 offset:10240
  v_mfma_f32_16x16x32_bf16 v[64:67], v[192:195], v[164:167], v[64:67]
  ds_read_b128 v[152:155], v10 offset:11264
  v_mfma_f32_16x16x32_bf16 v[68:71], v[196:199], v[164:167], v[68:71]
  ds_read_b128 v[156:159], v10 offset:12288
  v_mfma_f32_16x16x32_bf16 v[72:75], v[176:179], v[168:171], v[72:75]
  v_mfma_f32_16x16x32_bf16 v[76:79], v[180:183], v[168:171], v[76:79]
  v_mfma_f32_16x16x32_bf16 v[80:83], v[184:187], v[168:171], v[80:83]
  v_mfma_f32_16x16x32_bf16 v[84:87], v[188:191], v[168:171], v[84:87]
  v_mfma_f32_16x16x32_bf16 v[88:91], v[192:195], v[168:171], v[88:91]
  v_mfma_f32_16x16x32_bf16 v[92:95], v[196:199], v[168:171], v[92:95]
  v_mfma_f32_16x16x32_bf16 v[96:99], v[176:179], v[172:175], v[96:99]
  v_mfma_f32_16x16x32_bf16 v[100:103], v[180:183], v[172:175], v[100:103]
  v_mfma_f32_16x16x32_bf16 v[104:107], v[184:187], v[172:175], v[104:107]
  v_mfma_f32_16x16x32_bf16 v[108:111], v[188:191], v[172:175], v[108:111]
  v_mfma_f32_16x16x32_bf16 v[112:115], v[192:195], v[172:175], v[112:115]
  v_mfma_f32_16x16x32_bf16 v[116:119], v[196:199], v[172:175], v[116:119]
  s_waitcnt lgkmcnt(0)
  v_mfma_f32_16x16x32_bf16 v[24:27], v[136:139], v[120:123], v[24:27]
  ds_read_b128 v[160:163], v9 offset:16384
  v_mfma_f32_16x16x32_bf16 v[28:31], v[140:143], v[120:123], v[28:31]
  ds_read_b128 v[176:179], v10 offset:16384
  v_mfma_f32_16x16x32_bf16 v[32:35], v[144:147], v[120:123], v[32:35]
  ds_read_b128 v[164:167], v9 offset:18432
  v_mfma_f32_16x16x32_bf16 v[36:39], v[148:151], v[120:123], v[36:39]
  ds_read_b128 v[180:183], v10 offset:17408
  v_mfma_f32_16x16x32_bf16 v[40:43], v[152:155], v[120:123], v[40:43]
  ds_read_b128 v[168:171], v9 offset:20480
  v_mfma_f32_16x16x32_bf16 v[44:47], v[156:159], v[120:123], v[44:47]
  ds_read_b128 v[184:187], v10 offset:18432
  v_mfma_f32_16x16x32_bf16 v[48:51], v[136:139], v[124:127], v[48:51]
  ds_read_b128 v[172:175], v9 offset:22528
  v_mfma_f32_16x16x32_bf16 v[52:55], v[140:143], v[124:127], v[52:55]
  ds_read_b128 v[188:191], v10 offset:22528
  v_mfma_f32_16x16x32_bf16 v[56:59], v[144:147], v[124:127], v[56:59]
  ds_read_b128 v[192:195], v10 offset:23552
  v_mfma_f32_16x16x32_bf16 v[60:63], v[148:151], v[124:127], v[60:63]
  ds_read_b128 v[196:199], v10 offset:24576
  v_mfma_f32_16x16x32_bf16 v[64:67], v[152:155], v[124:127], v[64:67]
  v_mfma_f32_16x16x32_bf16 v[68:71], v[156:159], v[124:127], v[68:71]
  v_mfma_f32_16x16x32_bf16 v[72:75], v[136:139], v[128:131], v[72:75]
  v_mfma_f32_16x16x32_bf16 v[76:79], v[140:143], v[128:131], v[76:79]
  v_mfma_f32_16x16x32_bf16 v[80:83], v[144:147], v[128:131], v[80:83]
  v_mfma_f32_16x16x32_bf16 v[84:87], v[148:151], v[128:131], v[84:87]
  v_mfma_f32_16x16x32_bf16 v[88:91], v[152:155], v[128:131], v[88:91]
  v_mfma_f32_16x16x32_bf16 v[92:95], v[156:159], v[128:131], v[92:95]
  v_mfma_f32_16x16x32_bf16 v[96:99], v[136:139], v[132:135], v[96:99]
  v_mfma_f32_16x16x32_bf16 v[100:103], v[140:143], v[132:135], v[100:103]
  v_mfma_f32_16x16x32_bf16 v[104:107], v[144:147], v[132:135], v[104:107]
  v_mfma_f32_16x16x32_bf16 v[108:111], v[148:151], v[132:135], v[108:111]
  v_mfma_f32_16x16x32_bf16 v[112:115], v[152:155], v[132:135], v[112:115]
  v_mfma_f32_16x16x32_bf16 v[116:119], v[156:159], v[132:135], v[116:119]
  s_waitcnt lgkmcnt(0)
  v_mfma_f32_16x16x32_bf16 v[24:27], v[176:179], v[160:163], v[24:27]
  v_mfma_f32_16x16x32_bf16 v[28:31], v[180:183], v[160:163], v[28:31]
  v_mfma_f32_16x16x32_bf16 v[32:35], v[184:187], v[160:163], v[32:35]
  v_mfma_f32_16x16x32_bf16 v[36:39], v[188:191], v[160:163], v[36:39]
  v_mfma_f32_16x16x32_bf16 v[40:43], v[192:195], v[160:163], v[40:43]
  v_mfma_f32_16x16x32_bf16 v[44:47], v[196:199], v[160:163], v[44:47]
  v_mfma_f32_16x16x32_bf16 v[48:51], v[176:179], v[164:167], v[48:51]
  v_mfma_f32_16x16x32_bf16 v[52:55], v[180:183], v[164:167], v[52:55]
  v_mfma_f32_16x16x32_bf16 v[56:59], v[184:187], v[164:167], v[56:59]
  v_mfma_f32_16x16x32_bf16 v[60:63], v[188:191], v[164:167], v[60:63]
  v_mfma_f32_16x16x32_bf16 v[64:67], v[192:195], v[164:167], v[64:67]
  v_mfma_f32_16x16x32_bf16 v[68:71], v[196:199], v[164:167], v[68:71]
  v_mfma_f32_16x16x32_bf16 v[72:75], v[176:179], v[168:171], v[72:75]
  v_mfma_f32_16x16x32_bf16 v[76:79], v[180:183], v[168:171], v[76:79]
  v_mfma_f32_16x16x32_bf16 v[80:83], v[184:187], v[168:171], v[80:83]
  v_mfma_f32_16x16x32_bf16 v[84:87], v[188:191], v[168:171], v[84:87]
  v_mfma_f32_16x16x32_bf16 v[88:91], v[192:195], v[168:171], v[88:91]
  v_mfma_f32_16x16x32_bf16 v[92:95], v[196:199], v[168:171], v[92:95]
  v_mfma_f32_16x16x32_bf16 v[96:99], v[176:179], v[172:175], v[96:99]
  v_mfma_f32_16x16x32_bf16 v[100:103], v[180:183], v[172:175], v[100:103]
  v_mfma_f32_16x16x32_bf16 v[104:107], v[184:187], v[172:175], v[104:107]
  v_mfma_f32_16x16x32_bf16 v[108:111], v[188:191], v[172:175], v[108:111]
  v_mfma_f32_16x16x32_bf16 v[112:115], v[192:195], v[172:175], v[112:115]
  v_mfma_f32_16x16x32_bf16 v[116:119], v[196:199], v[172:175], v[116:119]
  s_barrier
  s_nop 7
  s_and_b32 s35, s33, 1
  s_lshr_b32 s36, s33, 1
  s_lshl_b32 s37, s35, 8
  v_lshl_add_u32 v4, v2, 2, s37

  ds_read_b32 v120, v4 offset:0
  ds_read_b32 v128, v4 offset:1024
  ds_read_b32 v122, v4 offset:64
  ds_read_b32 v130, v4 offset:1088
  ds_read_b32 v124, v4 offset:128
  ds_read_b32 v132, v4 offset:1152
  ds_read_b32 v126, v4 offset:192
  ds_read_b32 v134, v4 offset:1216
  s_mul_i32 s37, s36, 192
  v_lshl_add_u32 v5, v3, 4, s37

  ds_read_b128 v[200:203], v5 offset:2304
  ds_read_b128 v[212:215], v5 offset:2688
  ds_read_b128 v[204:207], v5 offset:2368
  ds_read_b128 v[216:219], v5 offset:2752
  ds_read_b128 v[208:211], v5 offset:2432
  ds_read_b128 v[220:223], v5 offset:2816
  s_lshl_b32 s37, s28, 1
  s_add_u32 s37, s37, s35
  s_mul_i32 s37, s37, 196608
  s_add_u32 s37, s37, s32
  s_add_u32 s37, s37, 13107200
  s_mul_i32 s38, s29, 12
  s_mul_i32 s39, s36, 6
  s_add_u32 s38, s38, s39
  v_lshrrev_b32 v4, 1, v3
  v_add_u32 v4, s38, v4
  v_and_b32 v5, 1, v3
  v_lshlrev_b32 v5, 10, v5
  v_lshl_add_u32 v5, v2, 4, v5

  v_add_u32 v6, 0, v4
  v_lshrrev_b32 v7, 2, v6
  v_lshlrev_b32 v7, 12, v7
  v_and_b32 v6, 3, v6
  v_lshl_add_u32 v7, v6, 8, v7
  v_add_u32 v8, v7, v5

  v_add_u32 v6, 2, v4
  v_lshrrev_b32 v7, 2, v6
  v_lshlrev_b32 v7, 12, v7
  v_and_b32 v6, 3, v6
  v_lshl_add_u32 v7, v6, 8, v7
  v_add_u32 v9, v7, v5

  v_add_u32 v6, 4, v4
  v_lshrrev_b32 v7, 2, v6
  v_lshlrev_b32 v7, 12, v7
  v_and_b32 v6, 3, v6
  v_lshl_add_u32 v7, v6, 8, v7
  v_add_u32 v10, v7, v5

  s_waitcnt vmcnt(0) lgkmcnt(0)
  v_mul_f32 v128, v128, v128
  v_mul_f32 v130, v130, v130
  v_mul_f32 v132, v132, v132
  v_mul_f32 v134, v134, v134
  v_pk_fma_f32 v[24:25], v[120:121], v[200:201], v[24:25] op_sel_hi:[0,1,1] neg_lo:[1,0,0] neg_hi:[1,0,0]
  v_pk_fma_f32 v[36:37], v[120:121], v[212:213], v[36:37] op_sel_hi:[0,1,1] neg_lo:[1,0,0] neg_hi:[1,0,0]
  v_pk_fma_f32 v[26:27], v[120:121], v[202:203], v[26:27] op_sel_hi:[0,1,1] neg_lo:[1,0,0] neg_hi:[1,0,0]
  v_pk_fma_f32 v[38:39], v[120:121], v[214:215], v[38:39] op_sel_hi:[0,1,1] neg_lo:[1,0,0] neg_hi:[1,0,0]
  v_pk_mul_f32 v[24:25], v[24:25], v[36:37]
  v_pk_mul_f32 v[26:27], v[26:27], v[38:39]
  v_pk_mul_f32 v[24:25], v[24:25], v[128:129] op_sel_hi:[1,0]
  v_pk_mul_f32 v[26:27], v[26:27], v[128:129] op_sel_hi:[1,0]
  v_cvt_pk_bf16_f32 v136, v24, v25
  v_cvt_pk_bf16_f32 v137, v26, v27
  v_pk_fma_f32 v[48:49], v[122:123], v[200:201], v[48:49] op_sel_hi:[0,1,1] neg_lo:[1,0,0] neg_hi:[1,0,0]
  v_pk_fma_f32 v[60:61], v[122:123], v[212:213], v[60:61] op_sel_hi:[0,1,1] neg_lo:[1,0,0] neg_hi:[1,0,0]
  v_pk_fma_f32 v[50:51], v[122:123], v[202:203], v[50:51] op_sel_hi:[0,1,1] neg_lo:[1,0,0] neg_hi:[1,0,0]
  v_pk_fma_f32 v[62:63], v[122:123], v[214:215], v[62:63] op_sel_hi:[0,1,1] neg_lo:[1,0,0] neg_hi:[1,0,0]
  v_pk_mul_f32 v[48:49], v[48:49], v[60:61]
  v_pk_mul_f32 v[50:51], v[50:51], v[62:63]
  v_pk_mul_f32 v[48:49], v[48:49], v[130:131] op_sel_hi:[1,0]
  v_pk_mul_f32 v[50:51], v[50:51], v[130:131] op_sel_hi:[1,0]
  v_cvt_pk_bf16_f32 v138, v48, v49
  v_cvt_pk_bf16_f32 v139, v50, v51
  s_nop 1
  v_permlane16_swap_b32 v136, v138
  v_permlane16_swap_b32 v137, v139
  s_nop 1
  buffer_store_dwordx4 v[136:139], v8, s[16:19], s37 offen sc0 sc1

  v_pk_fma_f32 v[28:29], v[120:121], v[204:205], v[28:29] op_sel_hi:[0,1,1] neg_lo:[1,0,0] neg_hi:[1,0,0]
  v_pk_fma_f32 v[40:41], v[120:121], v[216:217], v[40:41] op_sel_hi:[0,1,1] neg_lo:[1,0,0] neg_hi:[1,0,0]
  v_pk_fma_f32 v[30:31], v[120:121], v[206:207], v[30:31] op_sel_hi:[0,1,1] neg_lo:[1,0,0] neg_hi:[1,0,0]
  v_pk_fma_f32 v[42:43], v[120:121], v[218:219], v[42:43] op_sel_hi:[0,1,1] neg_lo:[1,0,0] neg_hi:[1,0,0]
  v_pk_mul_f32 v[28:29], v[28:29], v[40:41]
  v_pk_mul_f32 v[30:31], v[30:31], v[42:43]
  v_pk_mul_f32 v[28:29], v[28:29], v[128:129] op_sel_hi:[1,0]
  v_pk_mul_f32 v[30:31], v[30:31], v[128:129] op_sel_hi:[1,0]
  v_cvt_pk_bf16_f32 v140, v28, v29
  v_cvt_pk_bf16_f32 v141, v30, v31
  v_pk_fma_f32 v[52:53], v[122:123], v[204:205], v[52:53] op_sel_hi:[0,1,1] neg_lo:[1,0,0] neg_hi:[1,0,0]
  v_pk_fma_f32 v[64:65], v[122:123], v[216:217], v[64:65] op_sel_hi:[0,1,1] neg_lo:[1,0,0] neg_hi:[1,0,0]
  v_pk_fma_f32 v[54:55], v[122:123], v[206:207], v[54:55] op_sel_hi:[0,1,1] neg_lo:[1,0,0] neg_hi:[1,0,0]
  v_pk_fma_f32 v[66:67], v[122:123], v[218:219], v[66:67] op_sel_hi:[0,1,1] neg_lo:[1,0,0] neg_hi:[1,0,0]
  v_pk_mul_f32 v[52:53], v[52:53], v[64:65]
  v_pk_mul_f32 v[54:55], v[54:55], v[66:67]
  v_pk_mul_f32 v[52:53], v[52:53], v[130:131] op_sel_hi:[1,0]
  v_pk_mul_f32 v[54:55], v[54:55], v[130:131] op_sel_hi:[1,0]
  v_cvt_pk_bf16_f32 v142, v52, v53
  v_cvt_pk_bf16_f32 v143, v54, v55
  s_nop 1
  v_permlane16_swap_b32 v140, v142
  v_permlane16_swap_b32 v141, v143
  s_nop 1
  buffer_store_dwordx4 v[140:143], v9, s[16:19], s37 offen sc0 sc1

  v_pk_fma_f32 v[32:33], v[120:121], v[208:209], v[32:33] op_sel_hi:[0,1,1] neg_lo:[1,0,0] neg_hi:[1,0,0]
  v_pk_fma_f32 v[44:45], v[120:121], v[220:221], v[44:45] op_sel_hi:[0,1,1] neg_lo:[1,0,0] neg_hi:[1,0,0]
  v_pk_fma_f32 v[34:35], v[120:121], v[210:211], v[34:35] op_sel_hi:[0,1,1] neg_lo:[1,0,0] neg_hi:[1,0,0]
  v_pk_fma_f32 v[46:47], v[120:121], v[222:223], v[46:47] op_sel_hi:[0,1,1] neg_lo:[1,0,0] neg_hi:[1,0,0]
  v_pk_mul_f32 v[32:33], v[32:33], v[44:45]
  v_pk_mul_f32 v[34:35], v[34:35], v[46:47]
  v_pk_mul_f32 v[32:33], v[32:33], v[128:129] op_sel_hi:[1,0]
  v_pk_mul_f32 v[34:35], v[34:35], v[128:129] op_sel_hi:[1,0]
  v_cvt_pk_bf16_f32 v144, v32, v33
  v_cvt_pk_bf16_f32 v145, v34, v35
  v_pk_fma_f32 v[56:57], v[122:123], v[208:209], v[56:57] op_sel_hi:[0,1,1] neg_lo:[1,0,0] neg_hi:[1,0,0]
  v_pk_fma_f32 v[68:69], v[122:123], v[220:221], v[68:69] op_sel_hi:[0,1,1] neg_lo:[1,0,0] neg_hi:[1,0,0]
  v_pk_fma_f32 v[58:59], v[122:123], v[210:211], v[58:59] op_sel_hi:[0,1,1] neg_lo:[1,0,0] neg_hi:[1,0,0]
  v_pk_fma_f32 v[70:71], v[122:123], v[222:223], v[70:71] op_sel_hi:[0,1,1] neg_lo:[1,0,0] neg_hi:[1,0,0]
  v_pk_mul_f32 v[56:57], v[56:57], v[68:69]
  v_pk_mul_f32 v[58:59], v[58:59], v[70:71]
  v_pk_mul_f32 v[56:57], v[56:57], v[130:131] op_sel_hi:[1,0]
  v_pk_mul_f32 v[58:59], v[58:59], v[130:131] op_sel_hi:[1,0]
  v_cvt_pk_bf16_f32 v146, v56, v57
  v_cvt_pk_bf16_f32 v147, v58, v59
  s_nop 1
  v_permlane16_swap_b32 v144, v146
  v_permlane16_swap_b32 v145, v147
  s_nop 1
  buffer_store_dwordx4 v[144:147], v10, s[16:19], s37 offen sc0 sc1

  v_pk_fma_f32 v[72:73], v[124:125], v[200:201], v[72:73] op_sel_hi:[0,1,1] neg_lo:[1,0,0] neg_hi:[1,0,0]
  v_pk_fma_f32 v[84:85], v[124:125], v[212:213], v[84:85] op_sel_hi:[0,1,1] neg_lo:[1,0,0] neg_hi:[1,0,0]
  v_pk_fma_f32 v[74:75], v[124:125], v[202:203], v[74:75] op_sel_hi:[0,1,1] neg_lo:[1,0,0] neg_hi:[1,0,0]
  v_pk_fma_f32 v[86:87], v[124:125], v[214:215], v[86:87] op_sel_hi:[0,1,1] neg_lo:[1,0,0] neg_hi:[1,0,0]
  v_pk_mul_f32 v[72:73], v[72:73], v[84:85]
  v_pk_mul_f32 v[74:75], v[74:75], v[86:87]
  v_pk_mul_f32 v[72:73], v[72:73], v[132:133] op_sel_hi:[1,0]
  v_pk_mul_f32 v[74:75], v[74:75], v[132:133] op_sel_hi:[1,0]
  v_cvt_pk_bf16_f32 v148, v72, v73
  v_cvt_pk_bf16_f32 v149, v74, v75
  v_pk_fma_f32 v[96:97], v[126:127], v[200:201], v[96:97] op_sel_hi:[0,1,1] neg_lo:[1,0,0] neg_hi:[1,0,0]
  v_pk_fma_f32 v[108:109], v[126:127], v[212:213], v[108:109] op_sel_hi:[0,1,1] neg_lo:[1,0,0] neg_hi:[1,0,0]
  v_pk_fma_f32 v[98:99], v[126:127], v[202:203], v[98:99] op_sel_hi:[0,1,1] neg_lo:[1,0,0] neg_hi:[1,0,0]
  v_pk_fma_f32 v[110:111], v[126:127], v[214:215], v[110:111] op_sel_hi:[0,1,1] neg_lo:[1,0,0] neg_hi:[1,0,0]
  v_pk_mul_f32 v[96:97], v[96:97], v[108:109]
  v_pk_mul_f32 v[98:99], v[98:99], v[110:111]
  v_pk_mul_f32 v[96:97], v[96:97], v[134:135] op_sel_hi:[1,0]
  v_pk_mul_f32 v[98:99], v[98:99], v[134:135] op_sel_hi:[1,0]
  v_cvt_pk_bf16_f32 v150, v96, v97
  v_cvt_pk_bf16_f32 v151, v98, v99
  s_nop 1
  v_permlane16_swap_b32 v148, v150
  v_permlane16_swap_b32 v149, v151
  s_nop 1
  buffer_store_dwordx4 v[148:151], v8, s[16:19], s37 offen offset:2048 sc0 sc1

  v_pk_fma_f32 v[76:77], v[124:125], v[204:205], v[76:77] op_sel_hi:[0,1,1] neg_lo:[1,0,0] neg_hi:[1,0,0]
  v_pk_fma_f32 v[88:89], v[124:125], v[216:217], v[88:89] op_sel_hi:[0,1,1] neg_lo:[1,0,0] neg_hi:[1,0,0]
  v_pk_fma_f32 v[78:79], v[124:125], v[206:207], v[78:79] op_sel_hi:[0,1,1] neg_lo:[1,0,0] neg_hi:[1,0,0]
  v_pk_fma_f32 v[90:91], v[124:125], v[218:219], v[90:91] op_sel_hi:[0,1,1] neg_lo:[1,0,0] neg_hi:[1,0,0]
  v_pk_mul_f32 v[76:77], v[76:77], v[88:89]
  v_pk_mul_f32 v[78:79], v[78:79], v[90:91]
  v_pk_mul_f32 v[76:77], v[76:77], v[132:133] op_sel_hi:[1,0]
  v_pk_mul_f32 v[78:79], v[78:79], v[132:133] op_sel_hi:[1,0]
  v_cvt_pk_bf16_f32 v152, v76, v77
  v_cvt_pk_bf16_f32 v153, v78, v79
  v_pk_fma_f32 v[100:101], v[126:127], v[204:205], v[100:101] op_sel_hi:[0,1,1] neg_lo:[1,0,0] neg_hi:[1,0,0]
  v_pk_fma_f32 v[112:113], v[126:127], v[216:217], v[112:113] op_sel_hi:[0,1,1] neg_lo:[1,0,0] neg_hi:[1,0,0]
  v_pk_fma_f32 v[102:103], v[126:127], v[206:207], v[102:103] op_sel_hi:[0,1,1] neg_lo:[1,0,0] neg_hi:[1,0,0]
  v_pk_fma_f32 v[114:115], v[126:127], v[218:219], v[114:115] op_sel_hi:[0,1,1] neg_lo:[1,0,0] neg_hi:[1,0,0]
  v_pk_mul_f32 v[100:101], v[100:101], v[112:113]
  v_pk_mul_f32 v[102:103], v[102:103], v[114:115]
  v_pk_mul_f32 v[100:101], v[100:101], v[134:135] op_sel_hi:[1,0]
  v_pk_mul_f32 v[102:103], v[102:103], v[134:135] op_sel_hi:[1,0]
  v_cvt_pk_bf16_f32 v154, v100, v101
  v_cvt_pk_bf16_f32 v155, v102, v103
  s_nop 1
  v_permlane16_swap_b32 v152, v154
  v_permlane16_swap_b32 v153, v155
  s_nop 1
  buffer_store_dwordx4 v[152:155], v9, s[16:19], s37 offen offset:2048 sc0 sc1

  v_pk_fma_f32 v[80:81], v[124:125], v[208:209], v[80:81] op_sel_hi:[0,1,1] neg_lo:[1,0,0] neg_hi:[1,0,0]
  v_pk_fma_f32 v[92:93], v[124:125], v[220:221], v[92:93] op_sel_hi:[0,1,1] neg_lo:[1,0,0] neg_hi:[1,0,0]
  v_pk_fma_f32 v[82:83], v[124:125], v[210:211], v[82:83] op_sel_hi:[0,1,1] neg_lo:[1,0,0] neg_hi:[1,0,0]
  v_pk_fma_f32 v[94:95], v[124:125], v[222:223], v[94:95] op_sel_hi:[0,1,1] neg_lo:[1,0,0] neg_hi:[1,0,0]
  v_pk_mul_f32 v[80:81], v[80:81], v[92:93]
  v_pk_mul_f32 v[82:83], v[82:83], v[94:95]
  v_pk_mul_f32 v[80:81], v[80:81], v[132:133] op_sel_hi:[1,0]
  v_pk_mul_f32 v[82:83], v[82:83], v[132:133] op_sel_hi:[1,0]
  v_cvt_pk_bf16_f32 v156, v80, v81
  v_cvt_pk_bf16_f32 v157, v82, v83
  v_pk_fma_f32 v[104:105], v[126:127], v[208:209], v[104:105] op_sel_hi:[0,1,1] neg_lo:[1,0,0] neg_hi:[1,0,0]
  v_pk_fma_f32 v[116:117], v[126:127], v[220:221], v[116:117] op_sel_hi:[0,1,1] neg_lo:[1,0,0] neg_hi:[1,0,0]
  v_pk_fma_f32 v[106:107], v[126:127], v[210:211], v[106:107] op_sel_hi:[0,1,1] neg_lo:[1,0,0] neg_hi:[1,0,0]
  v_pk_fma_f32 v[118:119], v[126:127], v[222:223], v[118:119] op_sel_hi:[0,1,1] neg_lo:[1,0,0] neg_hi:[1,0,0]
  v_pk_mul_f32 v[104:105], v[104:105], v[116:117]
  v_pk_mul_f32 v[106:107], v[106:107], v[118:119]
  v_pk_mul_f32 v[104:105], v[104:105], v[134:135] op_sel_hi:[1,0]
  v_pk_mul_f32 v[106:107], v[106:107], v[134:135] op_sel_hi:[1,0]
  v_cvt_pk_bf16_f32 v158, v104, v105
  v_cvt_pk_bf16_f32 v159, v106, v107
  s_nop 1
  v_permlane16_swap_b32 v156, v158
  v_permlane16_swap_b32 v157, v159
  s_nop 1
  buffer_store_dwordx4 v[156:159], v10, s[16:19], s37 offen offset:2048 sc0 sc1

  s_waitcnt vmcnt(0)
  s_barrier
  s_barrier
  s_lshl_b32 s35, s33, 10
  s_add_u32 s35, s35, 86016
  v_add_u32 v8, s35, v1
  v_mov_b32 v10, v1
  v_add_u32 v11, 0x10000, v1

  v_mov_b32 v24, 0
  v_mov_b32 v25, 0
  v_mov_b32 v26, 0
  v_mov_b32 v27, 0
  v_mov_b32 v28, 0
  v_mov_b32 v29, 0
  v_mov_b32 v30, 0
  v_mov_b32 v31, 0
  v_mov_b32 v32, 0
  v_mov_b32 v33, 0
  v_mov_b32 v34, 0
  v_mov_b32 v35, 0
  v_mov_b32 v36, 0
  v_mov_b32 v37, 0
  v_mov_b32 v38, 0
  v_mov_b32 v39, 0
  v_mov_b32 v40, 0
  v_mov_b32 v41, 0
  v_mov_b32 v42, 0
  v_mov_b32 v43, 0
  s_barrier
  ds_read_b128 v[44:47], v8 offset:0
  ds_read_b128 v[48:51], v10 offset:4096
  ds_read_b128 v[68:71], v8 offset:4096
  ds_read_b128 v[52:55], v10 offset:5120
  ds_read_b128 v[56:59], v10 offset:6144
  ds_read_b128 v[60:63], v10 offset:7168
  ds_read_b128 v[64:67], v10 offset:8192
  ds_read_b128 v[72:75], v10 offset:9216
  ds_read_b128 v[76:79], v10 offset:10240
  ds_read_b128 v[80:83], v10 offset:11264
  ds_read_b128 v[84:87], v10 offset:12288
  ds_read_b128 v[88:91], v10 offset:13312
  s_waitcnt lgkmcnt(0)
  v_mfma_f32_16x16x32_bf16 v[24:27], v[48:51], v[44:47], v[24:27]
  ds_read_b128 v[92:95], v8 offset:8192
  ds_read_b128 v[96:99], v10 offset:14336
  v_mfma_f32_16x16x32_bf16 v[28:31], v[52:55], v[44:47], v[28:31]
  ds_read_b128 v[116:119], v8 offset:12288
  ds_read_b128 v[100:103], v10 offset:15360
  v_mfma_f32_16x16x32_bf16 v[32:35], v[56:59], v[44:47], v[32:35]
  ds_read_b128 v[104:107], v10 offset:16384
  ds_read_b128 v[108:111], v10 offset:17408
  v_mfma_f32_16x16x32_bf16 v[36:39], v[60:63], v[44:47], v[36:39]
  ds_read_b128 v[112:115], v10 offset:18432
  ds_read_b128 v[120:123], v10 offset:19456
  v_mfma_f32_16x16x32_bf16 v[40:43], v[64:67], v[44:47], v[40:43]
  ds_read_b128 v[124:127], v10 offset:20480
  ds_read_b128 v[128:131], v10 offset:21504
  v_mfma_f32_16x16x32_bf16 v[24:27], v[72:75], v[68:71], v[24:27]
  ds_read_b128 v[132:135], v10 offset:22528
  ds_read_b128 v[136:139], v10 offset:23552
  v_mfma_f32_16x16x32_bf16 v[28:31], v[76:79], v[68:71], v[28:31]
  v_mfma_f32_16x16x32_bf16 v[32:35], v[80:83], v[68:71], v[32:35]
  v_mfma_f32_16x16x32_bf16 v[36:39], v[84:87], v[68:71], v[36:39]
  v_mfma_f32_16x16x32_bf16 v[40:43], v[88:91], v[68:71], v[40:43]
  s_waitcnt lgkmcnt(0)
  v_mfma_f32_16x16x32_bf16 v[24:27], v[96:99], v[92:95], v[24:27]
  v_mfma_f32_16x16x32_bf16 v[28:31], v[100:103], v[92:95], v[28:31]
  s_barrier
  v_mfma_f32_16x16x32_bf16 v[32:35], v[104:107], v[92:95], v[32:35]
  ds_read_b128 v[44:47], v8 offset:16384
  ds_read_b128 v[48:51], v10 offset:24576
  ds_read_b128 v[68:71], v8 offset:20480
  v_mfma_f32_16x16x32_bf16 v[36:39], v[108:111], v[92:95], v[36:39]
  ds_read_b128 v[52:55], v10 offset:25600
  ds_read_b128 v[56:59], v10 offset:26624
  ds_read_b128 v[60:63], v10 offset:27648
  v_mfma_f32_16x16x32_bf16 v[40:43], v[112:115], v[92:95], v[40:43]
  ds_read_b128 v[64:67], v10 offset:28672
  ds_read_b128 v[72:75], v10 offset:29696
  ds_read_b128 v[76:79], v10 offset:30720
  v_mfma_f32_16x16x32_bf16 v[24:27], v[120:123], v[116:119], v[24:27]
  ds_read_b128 v[80:83], v10 offset:31744
  ds_read_b128 v[84:87], v10 offset:32768
  ds_read_b128 v[88:91], v10 offset:33792
  v_mfma_f32_16x16x32_bf16 v[28:31], v[124:127], v[116:119], v[28:31]
  v_mfma_f32_16x16x32_bf16 v[32:35], v[128:131], v[116:119], v[32:35]
  v_mfma_f32_16x16x32_bf16 v[36:39], v[132:135], v[116:119], v[36:39]
  v_mfma_f32_16x16x32_bf16 v[40:43], v[136:139], v[116:119], v[40:43]
  s_waitcnt lgkmcnt(0)
  v_mfma_f32_16x16x32_bf16 v[24:27], v[48:51], v[44:47], v[24:27]
  ds_read_b128 v[92:95], v8 offset:24576
  ds_read_b128 v[96:99], v10 offset:34816
  v_mfma_f32_16x16x32_bf16 v[28:31], v[52:55], v[44:47], v[28:31]
  ds_read_b128 v[116:119], v8 offset:28672
  ds_read_b128 v[100:103], v10 offset:35840
  v_mfma_f32_16x16x32_bf16 v[32:35], v[56:59], v[44:47], v[32:35]
  ds_read_b128 v[104:107], v10 offset:36864
  ds_read_b128 v[108:111], v10 offset:37888
  v_mfma_f32_16x16x32_bf16 v[36:39], v[60:63], v[44:47], v[36:39]
  ds_read_b128 v[112:115], v10 offset:38912
  ds_read_b128 v[120:123], v10 offset:39936
  v_mfma_f32_16x16x32_bf16 v[40:43], v[64:67], v[44:47], v[40:43]
  ds_read_b128 v[124:127], v10 offset:40960
  ds_read_b128 v[128:131], v10 offset:41984
  v_mfma_f32_16x16x32_bf16 v[24:27], v[72:75], v[68:71], v[24:27]
  ds_read_b128 v[132:135], v10 offset:43008
  ds_read_b128 v[136:139], v10 offset:44032
  v_mfma_f32_16x16x32_bf16 v[28:31], v[76:79], v[68:71], v[28:31]
  v_mfma_f32_16x16x32_bf16 v[32:35], v[80:83], v[68:71], v[32:35]
  v_mfma_f32_16x16x32_bf16 v[36:39], v[84:87], v[68:71], v[36:39]
  v_mfma_f32_16x16x32_bf16 v[40:43], v[88:91], v[68:71], v[40:43]
  s_waitcnt lgkmcnt(0)
  v_mfma_f32_16x16x32_bf16 v[24:27], v[96:99], v[92:95], v[24:27]
  v_mfma_f32_16x16x32_bf16 v[28:31], v[100:103], v[92:95], v[28:31]
  s_barrier
  v_mfma_f32_16x16x32_bf16 v[32:35], v[104:107], v[92:95], v[32:35]
  ds_read_b128 v[44:47], v8 offset:32768
  ds_read_b128 v[48:51], v10 offset:45056
  ds_read_b128 v[68:71], v8 offset:36864
  v_mfma_f32_16x16x32_bf16 v[36:39], v[108:111], v[92:95], v[36:39]
  ds_read_b128 v[52:55], v10 offset:46080
  ds_read_b128 v[56:59], v10 offset:47104
  ds_read_b128 v[60:63], v10 offset:48128
  v_mfma_f32_16x16x32_bf16 v[40:43], v[112:115], v[92:95], v[40:43]
  ds_read_b128 v[64:67], v10 offset:49152
  ds_read_b128 v[72:75], v10 offset:50176
  ds_read_b128 v[76:79], v10 offset:51200
  v_mfma_f32_16x16x32_bf16 v[24:27], v[120:123], v[116:119], v[24:27]
  ds_read_b128 v[80:83], v10 offset:52224
  ds_read_b128 v[84:87], v10 offset:53248
  ds_read_b128 v[88:91], v10 offset:54272
  v_mfma_f32_16x16x32_bf16 v[28:31], v[124:127], v[116:119], v[28:31]
  v_mfma_f32_16x16x32_bf16 v[32:35], v[128:131], v[116:119], v[32:35]
  v_mfma_f32_16x16x32_bf16 v[36:39], v[132:135], v[116:119], v[36:39]
  v_mfma_f32_16x16x32_bf16 v[40:43], v[136:139], v[116:119], v[40:43]
  s_waitcnt lgkmcnt(0)
  v_mfma_f32_16x16x32_bf16 v[24:27], v[48:51], v[44:47], v[24:27]
  ds_read_b128 v[92:95], v8 offset:40960
  ds_read_b128 v[96:99], v10 offset:55296
  v_mfma_f32_16x16x32_bf16 v[28:31], v[52:55], v[44:47], v[28:31]
  ds_read_b128 v[116:119], v8 offset:45056
  ds_read_b128 v[100:103], v10 offset:56320
  v_mfma_f32_16x16x32_bf16 v[32:35], v[56:59], v[44:47], v[32:35]
  ds_read_b128 v[104:107], v10 offset:57344
  ds_read_b128 v[108:111], v10 offset:58368
  v_mfma_f32_16x16x32_bf16 v[36:39], v[60:63], v[44:47], v[36:39]
  ds_read_b128 v[112:115], v10 offset:59392
  ds_read_b128 v[120:123], v10 offset:60416
  v_mfma_f32_16x16x32_bf16 v[40:43], v[64:67], v[44:47], v[40:43]
  ds_read_b128 v[124:127], v10 offset:61440
  ds_read_b128 v[128:131], v10 offset:62464
  v_mfma_f32_16x16x32_bf16 v[24:27], v[72:75], v[68:71], v[24:27]
  ds_read_b128 v[132:135], v10 offset:63488
  ds_read_b128 v[136:139], v10 offset:64512
  v_mfma_f32_16x16x32_bf16 v[28:31], v[76:79], v[68:71], v[28:31]
  v_mfma_f32_16x16x32_bf16 v[32:35], v[80:83], v[68:71], v[32:35]
  v_mfma_f32_16x16x32_bf16 v[36:39], v[84:87], v[68:71], v[36:39]
  v_mfma_f32_16x16x32_bf16 v[40:43], v[88:91], v[68:71], v[40:43]
  s_waitcnt lgkmcnt(0)
  v_mfma_f32_16x16x32_bf16 v[24:27], v[96:99], v[92:95], v[24:27]
  v_mfma_f32_16x16x32_bf16 v[28:31], v[100:103], v[92:95], v[28:31]
  s_barrier
  v_mfma_f32_16x16x32_bf16 v[32:35], v[104:107], v[92:95], v[32:35]
  ds_read_b128 v[44:47], v8 offset:49152
  ds_read_b128 v[48:51], v11 offset:0
  ds_read_b128 v[68:71], v8 offset:53248
  v_mfma_f32_16x16x32_bf16 v[36:39], v[108:111], v[92:95], v[36:39]
  ds_read_b128 v[52:55], v11 offset:1024
  ds_read_b128 v[56:59], v11 offset:2048
  ds_read_b128 v[60:63], v11 offset:3072
  v_mfma_f32_16x16x32_bf16 v[40:43], v[112:115], v[92:95], v[40:43]
  ds_read_b128 v[64:67], v11 offset:4096
  ds_read_b128 v[72:75], v11 offset:5120
  ds_read_b128 v[76:79], v11 offset:6144
  v_mfma_f32_16x16x32_bf16 v[24:27], v[120:123], v[116:119], v[24:27]
  ds_read_b128 v[80:83], v11 offset:7168
  ds_read_b128 v[84:87], v11 offset:8192
  ds_read_b128 v[88:91], v11 offset:9216
  v_mfma_f32_16x16x32_bf16 v[28:31], v[124:127], v[116:119], v[28:31]
  v_mfma_f32_16x16x32_bf16 v[32:35], v[128:131], v[116:119], v[32:35]
  v_mfma_f32_16x16x32_bf16 v[36:39], v[132:135], v[116:119], v[36:39]
  v_mfma_f32_16x16x32_bf16 v[40:43], v[136:139], v[116:119], v[40:43]
  s_waitcnt lgkmcnt(0)
  v_mfma_f32_16x16x32_bf16 v[24:27], v[48:51], v[44:47], v[24:27]
  ds_read_b128 v[92:95], v8 offset:57344
  ds_read_b128 v[96:99], v11 offset:10240
  v_mfma_f32_16x16x32_bf16 v[28:31], v[52:55], v[44:47], v[28:31]
  ds_read_b128 v[116:119], v8 offset:61440
  ds_read_b128 v[100:103], v11 offset:11264
  v_mfma_f32_16x16x32_bf16 v[32:35], v[56:59], v[44:47], v[32:35]
  ds_read_b128 v[104:107], v11 offset:12288
  ds_read_b128 v[108:111], v11 offset:13312
  v_mfma_f32_16x16x32_bf16 v[36:39], v[60:63], v[44:47], v[36:39]
  ds_read_b128 v[112:115], v11 offset:14336
  ds_read_b128 v[120:123], v11 offset:15360
  v_mfma_f32_16x16x32_bf16 v[40:43], v[64:67], v[44:47], v[40:43]
  ds_read_b128 v[124:127], v11 offset:16384
  ds_read_b128 v[128:131], v11 offset:17408
  v_mfma_f32_16x16x32_bf16 v[24:27], v[72:75], v[68:71], v[24:27]
  ds_read_b128 v[132:135], v11 offset:18432
  ds_read_b128 v[136:139], v11 offset:19456
  v_mfma_f32_16x16x32_bf16 v[28:31], v[76:79], v[68:71], v[28:31]
  v_mfma_f32_16x16x32_bf16 v[32:35], v[80:83], v[68:71], v[32:35]
  v_mfma_f32_16x16x32_bf16 v[36:39], v[84:87], v[68:71], v[36:39]
  v_mfma_f32_16x16x32_bf16 v[40:43], v[88:91], v[68:71], v[40:43]
  s_waitcnt lgkmcnt(0)
  v_mfma_f32_16x16x32_bf16 v[24:27], v[96:99], v[92:95], v[24:27]
  v_mfma_f32_16x16x32_bf16 v[28:31], v[100:103], v[92:95], v[28:31]
  s_barrier
  v_mfma_f32_16x16x32_bf16 v[32:35], v[104:107], v[92:95], v[32:35]
  ds_read_b128 v[44:47], v8 offset:0
  ds_read_b128 v[48:51], v10 offset:4096
  ds_read_b128 v[68:71], v8 offset:4096
  v_mfma_f32_16x16x32_bf16 v[36:39], v[108:111], v[92:95], v[36:39]
  ds_read_b128 v[52:55], v10 offset:5120
  ds_read_b128 v[56:59], v10 offset:6144
  ds_read_b128 v[60:63], v10 offset:7168
  v_mfma_f32_16x16x32_bf16 v[40:43], v[112:115], v[92:95], v[40:43]
  ds_read_b128 v[64:67], v10 offset:8192
  ds_read_b128 v[72:75], v10 offset:9216
  ds_read_b128 v[76:79], v10 offset:10240
  v_mfma_f32_16x16x32_bf16 v[24:27], v[120:123], v[116:119], v[24:27]
  ds_read_b128 v[80:83], v10 offset:11264
  ds_read_b128 v[84:87], v10 offset:12288
  ds_read_b128 v[88:91], v10 offset:13312
  v_mfma_f32_16x16x32_bf16 v[28:31], v[124:127], v[116:119], v[28:31]
  v_mfma_f32_16x16x32_bf16 v[32:35], v[128:131], v[116:119], v[32:35]
  v_mfma_f32_16x16x32_bf16 v[36:39], v[132:135], v[116:119], v[36:39]
  v_mfma_f32_16x16x32_bf16 v[40:43], v[136:139], v[116:119], v[40:43]
  s_waitcnt lgkmcnt(0)
  v_mfma_f32_16x16x32_bf16 v[24:27], v[48:51], v[44:47], v[24:27]
  ds_read_b128 v[92:95], v8 offset:8192
  ds_read_b128 v[96:99], v10 offset:14336
  v_mfma_f32_16x16x32_bf16 v[28:31], v[52:55], v[44:47], v[28:31]
  ds_read_b128 v[116:119], v8 offset:12288
  ds_read_b128 v[100:103], v10 offset:15360
  v_mfma_f32_16x16x32_bf16 v[32:35], v[56:59], v[44:47], v[32:35]
  ds_read_b128 v[104:107], v10 offset:16384
  ds_read_b128 v[108:111], v10 offset:17408
  v_mfma_f32_16x16x32_bf16 v[36:39], v[60:63], v[44:47], v[36:39]
  ds_read_b128 v[112:115], v10 offset:18432
  ds_read_b128 v[120:123], v10 offset:19456
  v_mfma_f32_16x16x32_bf16 v[40:43], v[64:67], v[44:47], v[40:43]
  ds_read_b128 v[124:127], v10 offset:20480
  ds_read_b128 v[128:131], v10 offset:21504
  v_mfma_f32_16x16x32_bf16 v[24:27], v[72:75], v[68:71], v[24:27]
  ds_read_b128 v[132:135], v10 offset:22528
  ds_read_b128 v[136:139], v10 offset:23552
  v_mfma_f32_16x16x32_bf16 v[28:31], v[76:79], v[68:71], v[28:31]
  v_mfma_f32_16x16x32_bf16 v[32:35], v[80:83], v[68:71], v[32:35]
  v_mfma_f32_16x16x32_bf16 v[36:39], v[84:87], v[68:71], v[36:39]
  v_mfma_f32_16x16x32_bf16 v[40:43], v[88:91], v[68:71], v[40:43]
  s_waitcnt lgkmcnt(0)
  v_mfma_f32_16x16x32_bf16 v[24:27], v[96:99], v[92:95], v[24:27]
  v_mfma_f32_16x16x32_bf16 v[28:31], v[100:103], v[92:95], v[28:31]
  s_barrier
  v_mfma_f32_16x16x32_bf16 v[32:35], v[104:107], v[92:95], v[32:35]
  ds_read_b128 v[44:47], v8 offset:16384
  ds_read_b128 v[48:51], v10 offset:24576
  ds_read_b128 v[68:71], v8 offset:20480
  v_mfma_f32_16x16x32_bf16 v[36:39], v[108:111], v[92:95], v[36:39]
  ds_read_b128 v[52:55], v10 offset:25600
  ds_read_b128 v[56:59], v10 offset:26624
  ds_read_b128 v[60:63], v10 offset:27648
  v_mfma_f32_16x16x32_bf16 v[40:43], v[112:115], v[92:95], v[40:43]
  ds_read_b128 v[64:67], v10 offset:28672
  ds_read_b128 v[72:75], v10 offset:29696
  ds_read_b128 v[76:79], v10 offset:30720
  v_mfma_f32_16x16x32_bf16 v[24:27], v[120:123], v[116:119], v[24:27]
  ds_read_b128 v[80:83], v10 offset:31744
  ds_read_b128 v[84:87], v10 offset:32768
  ds_read_b128 v[88:91], v10 offset:33792
  v_mfma_f32_16x16x32_bf16 v[28:31], v[124:127], v[116:119], v[28:31]
  v_mfma_f32_16x16x32_bf16 v[32:35], v[128:131], v[116:119], v[32:35]
  v_mfma_f32_16x16x32_bf16 v[36:39], v[132:135], v[116:119], v[36:39]
  v_mfma_f32_16x16x32_bf16 v[40:43], v[136:139], v[116:119], v[40:43]
  s_waitcnt lgkmcnt(0)
  v_mfma_f32_16x16x32_bf16 v[24:27], v[48:51], v[44:47], v[24:27]
  ds_read_b128 v[92:95], v8 offset:24576
  ds_read_b128 v[96:99], v10 offset:34816
  v_mfma_f32_16x16x32_bf16 v[28:31], v[52:55], v[44:47], v[28:31]
  ds_read_b128 v[116:119], v8 offset:28672
  ds_read_b128 v[100:103], v10 offset:35840
  v_mfma_f32_16x16x32_bf16 v[32:35], v[56:59], v[44:47], v[32:35]
  ds_read_b128 v[104:107], v10 offset:36864
  ds_read_b128 v[108:111], v10 offset:37888
  v_mfma_f32_16x16x32_bf16 v[36:39], v[60:63], v[44:47], v[36:39]
  ds_read_b128 v[112:115], v10 offset:38912
  ds_read_b128 v[120:123], v10 offset:39936
  v_mfma_f32_16x16x32_bf16 v[40:43], v[64:67], v[44:47], v[40:43]
  ds_read_b128 v[124:127], v10 offset:40960
  ds_read_b128 v[128:131], v10 offset:41984
  v_mfma_f32_16x16x32_bf16 v[24:27], v[72:75], v[68:71], v[24:27]
  ds_read_b128 v[132:135], v10 offset:43008
  ds_read_b128 v[136:139], v10 offset:44032
  v_mfma_f32_16x16x32_bf16 v[28:31], v[76:79], v[68:71], v[28:31]
  v_mfma_f32_16x16x32_bf16 v[32:35], v[80:83], v[68:71], v[32:35]
  v_mfma_f32_16x16x32_bf16 v[36:39], v[84:87], v[68:71], v[36:39]
  v_mfma_f32_16x16x32_bf16 v[40:43], v[88:91], v[68:71], v[40:43]
  s_waitcnt lgkmcnt(0)
  v_mfma_f32_16x16x32_bf16 v[24:27], v[96:99], v[92:95], v[24:27]
  v_mfma_f32_16x16x32_bf16 v[28:31], v[100:103], v[92:95], v[28:31]
  s_barrier
  v_mfma_f32_16x16x32_bf16 v[32:35], v[104:107], v[92:95], v[32:35]
  ds_read_b128 v[44:47], v8 offset:32768
  ds_read_b128 v[48:51], v10 offset:45056
  ds_read_b128 v[68:71], v8 offset:36864
  v_mfma_f32_16x16x32_bf16 v[36:39], v[108:111], v[92:95], v[36:39]
  ds_read_b128 v[52:55], v10 offset:46080
  ds_read_b128 v[56:59], v10 offset:47104
  ds_read_b128 v[60:63], v10 offset:48128
  v_mfma_f32_16x16x32_bf16 v[40:43], v[112:115], v[92:95], v[40:43]
  ds_read_b128 v[64:67], v10 offset:49152
  ds_read_b128 v[72:75], v10 offset:50176
  ds_read_b128 v[76:79], v10 offset:51200
  v_mfma_f32_16x16x32_bf16 v[24:27], v[120:123], v[116:119], v[24:27]
  ds_read_b128 v[80:83], v10 offset:52224
  ds_read_b128 v[84:87], v10 offset:53248
  ds_read_b128 v[88:91], v10 offset:54272
  v_mfma_f32_16x16x32_bf16 v[28:31], v[124:127], v[116:119], v[28:31]
  v_mfma_f32_16x16x32_bf16 v[32:35], v[128:131], v[116:119], v[32:35]
  v_mfma_f32_16x16x32_bf16 v[36:39], v[132:135], v[116:119], v[36:39]
  v_mfma_f32_16x16x32_bf16 v[40:43], v[136:139], v[116:119], v[40:43]
  s_waitcnt lgkmcnt(0)
  v_mfma_f32_16x16x32_bf16 v[24:27], v[48:51], v[44:47], v[24:27]
  ds_read_b128 v[92:95], v8 offset:40960
  ds_read_b128 v[96:99], v10 offset:55296
  v_mfma_f32_16x16x32_bf16 v[28:31], v[52:55], v[44:47], v[28:31]
  ds_read_b128 v[116:119], v8 offset:45056
  ds_read_b128 v[100:103], v10 offset:56320
  v_mfma_f32_16x16x32_bf16 v[32:35], v[56:59], v[44:47], v[32:35]
  ds_read_b128 v[104:107], v10 offset:57344
  ds_read_b128 v[108:111], v10 offset:58368
  v_mfma_f32_16x16x32_bf16 v[36:39], v[60:63], v[44:47], v[36:39]
  ds_read_b128 v[112:115], v10 offset:59392
  ds_read_b128 v[120:123], v10 offset:60416
  v_mfma_f32_16x16x32_bf16 v[40:43], v[64:67], v[44:47], v[40:43]
  ds_read_b128 v[124:127], v10 offset:61440
  ds_read_b128 v[128:131], v10 offset:62464
  v_mfma_f32_16x16x32_bf16 v[24:27], v[72:75], v[68:71], v[24:27]
  ds_read_b128 v[132:135], v10 offset:63488
  ds_read_b128 v[136:139], v10 offset:64512
  v_mfma_f32_16x16x32_bf16 v[28:31], v[76:79], v[68:71], v[28:31]
  v_mfma_f32_16x16x32_bf16 v[32:35], v[80:83], v[68:71], v[32:35]
  v_mfma_f32_16x16x32_bf16 v[36:39], v[84:87], v[68:71], v[36:39]
  v_mfma_f32_16x16x32_bf16 v[40:43], v[88:91], v[68:71], v[40:43]
  s_waitcnt lgkmcnt(0)
  v_mfma_f32_16x16x32_bf16 v[24:27], v[96:99], v[92:95], v[24:27]
  v_mfma_f32_16x16x32_bf16 v[28:31], v[100:103], v[92:95], v[28:31]
  s_barrier
  v_mfma_f32_16x16x32_bf16 v[32:35], v[104:107], v[92:95], v[32:35]
  ds_read_b128 v[44:47], v8 offset:49152
  ds_read_b128 v[48:51], v11 offset:0
  ds_read_b128 v[68:71], v8 offset:53248
  v_mfma_f32_16x16x32_bf16 v[36:39], v[108:111], v[92:95], v[36:39]
  ds_read_b128 v[52:55], v11 offset:1024
  ds_read_b128 v[56:59], v11 offset:2048
  ds_read_b128 v[60:63], v11 offset:3072
  v_mfma_f32_16x16x32_bf16 v[40:43], v[112:115], v[92:95], v[40:43]
  ds_read_b128 v[64:67], v11 offset:4096
  ds_read_b128 v[72:75], v11 offset:5120
  ds_read_b128 v[76:79], v11 offset:6144
  v_mfma_f32_16x16x32_bf16 v[24:27], v[120:123], v[116:119], v[24:27]
  ds_read_b128 v[80:83], v11 offset:7168
  ds_read_b128 v[84:87], v11 offset:8192
  ds_read_b128 v[88:91], v11 offset:9216
  v_mfma_f32_16x16x32_bf16 v[28:31], v[124:127], v[116:119], v[28:31]
  v_mfma_f32_16x16x32_bf16 v[32:35], v[128:131], v[116:119], v[32:35]
  v_mfma_f32_16x16x32_bf16 v[36:39], v[132:135], v[116:119], v[36:39]
  v_mfma_f32_16x16x32_bf16 v[40:43], v[136:139], v[116:119], v[40:43]
  s_waitcnt lgkmcnt(0)
  v_mfma_f32_16x16x32_bf16 v[24:27], v[48:51], v[44:47], v[24:27]
  ds_read_b128 v[92:95], v8 offset:57344
  ds_read_b128 v[96:99], v11 offset:10240
  v_mfma_f32_16x16x32_bf16 v[28:31], v[52:55], v[44:47], v[28:31]
  ds_read_b128 v[116:119], v8 offset:61440
  ds_read_b128 v[100:103], v11 offset:11264
  v_mfma_f32_16x16x32_bf16 v[32:35], v[56:59], v[44:47], v[32:35]
  ds_read_b128 v[104:107], v11 offset:12288
  ds_read_b128 v[108:111], v11 offset:13312
  v_mfma_f32_16x16x32_bf16 v[36:39], v[60:63], v[44:47], v[36:39]
  ds_read_b128 v[112:115], v11 offset:14336
  ds_read_b128 v[120:123], v11 offset:15360
  v_mfma_f32_16x16x32_bf16 v[40:43], v[64:67], v[44:47], v[40:43]
  ds_read_b128 v[124:127], v11 offset:16384
  ds_read_b128 v[128:131], v11 offset:17408
  v_mfma_f32_16x16x32_bf16 v[24:27], v[72:75], v[68:71], v[24:27]
  ds_read_b128 v[132:135], v11 offset:18432
  ds_read_b128 v[136:139], v11 offset:19456
  v_mfma_f32_16x16x32_bf16 v[28:31], v[76:79], v[68:71], v[28:31]
  v_mfma_f32_16x16x32_bf16 v[32:35], v[80:83], v[68:71], v[32:35]
  v_mfma_f32_16x16x32_bf16 v[36:39], v[84:87], v[68:71], v[36:39]
  v_mfma_f32_16x16x32_bf16 v[40:43], v[88:91], v[68:71], v[40:43]
  s_waitcnt lgkmcnt(0)
  v_mfma_f32_16x16x32_bf16 v[24:27], v[96:99], v[92:95], v[24:27]
  v_mfma_f32_16x16x32_bf16 v[28:31], v[100:103], v[92:95], v[28:31]
  s_barrier
  v_mfma_f32_16x16x32_bf16 v[32:35], v[104:107], v[92:95], v[32:35]
  ds_read_b128 v[44:47], v8 offset:0
  ds_read_b128 v[48:51], v10 offset:4096
  ds_read_b128 v[68:71], v8 offset:4096
  v_mfma_f32_16x16x32_bf16 v[36:39], v[108:111], v[92:95], v[36:39]
  ds_read_b128 v[52:55], v10 offset:5120
  ds_read_b128 v[56:59], v10 offset:6144
  ds_read_b128 v[60:63], v10 offset:7168
  v_mfma_f32_16x16x32_bf16 v[40:43], v[112:115], v[92:95], v[40:43]
  ds_read_b128 v[64:67], v10 offset:8192
  ds_read_b128 v[72:75], v10 offset:9216
  ds_read_b128 v[76:79], v10 offset:10240
  v_mfma_f32_16x16x32_bf16 v[24:27], v[120:123], v[116:119], v[24:27]
  ds_read_b128 v[80:83], v10 offset:11264
  ds_read_b128 v[84:87], v10 offset:12288
  ds_read_b128 v[88:91], v10 offset:13312
  v_mfma_f32_16x16x32_bf16 v[28:31], v[124:127], v[116:119], v[28:31]
  v_mfma_f32_16x16x32_bf16 v[32:35], v[128:131], v[116:119], v[32:35]
  v_mfma_f32_16x16x32_bf16 v[36:39], v[132:135], v[116:119], v[36:39]
  v_mfma_f32_16x16x32_bf16 v[40:43], v[136:139], v[116:119], v[40:43]
  s_waitcnt lgkmcnt(0)
  v_mfma_f32_16x16x32_bf16 v[24:27], v[48:51], v[44:47], v[24:27]
  ds_read_b128 v[92:95], v8 offset:8192
  ds_read_b128 v[96:99], v10 offset:14336
  v_mfma_f32_16x16x32_bf16 v[28:31], v[52:55], v[44:47], v[28:31]
  ds_read_b128 v[116:119], v8 offset:12288
  ds_read_b128 v[100:103], v10 offset:15360
  v_mfma_f32_16x16x32_bf16 v[32:35], v[56:59], v[44:47], v[32:35]
  ds_read_b128 v[104:107], v10 offset:16384
  ds_read_b128 v[108:111], v10 offset:17408
  v_mfma_f32_16x16x32_bf16 v[36:39], v[60:63], v[44:47], v[36:39]
  ds_read_b128 v[112:115], v10 offset:18432
  ds_read_b128 v[120:123], v10 offset:19456
  v_mfma_f32_16x16x32_bf16 v[40:43], v[64:67], v[44:47], v[40:43]
  ds_read_b128 v[124:127], v10 offset:20480
  ds_read_b128 v[128:131], v10 offset:21504
  v_mfma_f32_16x16x32_bf16 v[24:27], v[72:75], v[68:71], v[24:27]
  ds_read_b128 v[132:135], v10 offset:22528
  ds_read_b128 v[136:139], v10 offset:23552
  v_mfma_f32_16x16x32_bf16 v[28:31], v[76:79], v[68:71], v[28:31]
  v_mfma_f32_16x16x32_bf16 v[32:35], v[80:83], v[68:71], v[32:35]
  v_mfma_f32_16x16x32_bf16 v[36:39], v[84:87], v[68:71], v[36:39]
  v_mfma_f32_16x16x32_bf16 v[40:43], v[88:91], v[68:71], v[40:43]
  s_waitcnt lgkmcnt(0)
  v_mfma_f32_16x16x32_bf16 v[24:27], v[96:99], v[92:95], v[24:27]
  v_mfma_f32_16x16x32_bf16 v[28:31], v[100:103], v[92:95], v[28:31]
  s_barrier
  v_mfma_f32_16x16x32_bf16 v[32:35], v[104:107], v[92:95], v[32:35]
  ds_read_b128 v[44:47], v8 offset:16384
  ds_read_b128 v[48:51], v10 offset:24576
  ds_read_b128 v[68:71], v8 offset:20480
  v_mfma_f32_16x16x32_bf16 v[36:39], v[108:111], v[92:95], v[36:39]
  ds_read_b128 v[52:55], v10 offset:25600
  ds_read_b128 v[56:59], v10 offset:26624
  ds_read_b128 v[60:63], v10 offset:27648
  v_mfma_f32_16x16x32_bf16 v[40:43], v[112:115], v[92:95], v[40:43]
  ds_read_b128 v[64:67], v10 offset:28672
  ds_read_b128 v[72:75], v10 offset:29696
  ds_read_b128 v[76:79], v10 offset:30720
  v_mfma_f32_16x16x32_bf16 v[24:27], v[120:123], v[116:119], v[24:27]
  ds_read_b128 v[80:83], v10 offset:31744
  ds_read_b128 v[84:87], v10 offset:32768
  ds_read_b128 v[88:91], v10 offset:33792
  v_mfma_f32_16x16x32_bf16 v[28:31], v[124:127], v[116:119], v[28:31]
  v_mfma_f32_16x16x32_bf16 v[32:35], v[128:131], v[116:119], v[32:35]
  v_mfma_f32_16x16x32_bf16 v[36:39], v[132:135], v[116:119], v[36:39]
  v_mfma_f32_16x16x32_bf16 v[40:43], v[136:139], v[116:119], v[40:43]
  s_waitcnt lgkmcnt(0)
  v_mfma_f32_16x16x32_bf16 v[24:27], v[48:51], v[44:47], v[24:27]
  ds_read_b128 v[92:95], v8 offset:24576
  ds_read_b128 v[96:99], v10 offset:34816
  v_mfma_f32_16x16x32_bf16 v[28:31], v[52:55], v[44:47], v[28:31]
  ds_read_b128 v[116:119], v8 offset:28672
  ds_read_b128 v[100:103], v10 offset:35840
  v_mfma_f32_16x16x32_bf16 v[32:35], v[56:59], v[44:47], v[32:35]
  ds_read_b128 v[104:107], v10 offset:36864
  ds_read_b128 v[108:111], v10 offset:37888
  v_mfma_f32_16x16x32_bf16 v[36:39], v[60:63], v[44:47], v[36:39]
  ds_read_b128 v[112:115], v10 offset:38912
  ds_read_b128 v[120:123], v10 offset:39936
  v_mfma_f32_16x16x32_bf16 v[40:43], v[64:67], v[44:47], v[40:43]
  ds_read_b128 v[124:127], v10 offset:40960
  ds_read_b128 v[128:131], v10 offset:41984
  v_mfma_f32_16x16x32_bf16 v[24:27], v[72:75], v[68:71], v[24:27]
  ds_read_b128 v[132:135], v10 offset:43008
  ds_read_b128 v[136:139], v10 offset:44032
  v_mfma_f32_16x16x32_bf16 v[28:31], v[76:79], v[68:71], v[28:31]
  v_mfma_f32_16x16x32_bf16 v[32:35], v[80:83], v[68:71], v[32:35]
  v_mfma_f32_16x16x32_bf16 v[36:39], v[84:87], v[68:71], v[36:39]
  v_mfma_f32_16x16x32_bf16 v[40:43], v[88:91], v[68:71], v[40:43]
  s_waitcnt lgkmcnt(0)
  v_mfma_f32_16x16x32_bf16 v[24:27], v[96:99], v[92:95], v[24:27]
  v_mfma_f32_16x16x32_bf16 v[28:31], v[100:103], v[92:95], v[28:31]
  s_barrier
  v_mfma_f32_16x16x32_bf16 v[32:35], v[104:107], v[92:95], v[32:35]
  ds_read_b128 v[44:47], v8 offset:32768
  ds_read_b128 v[48:51], v10 offset:45056
  ds_read_b128 v[68:71], v8 offset:36864
  v_mfma_f32_16x16x32_bf16 v[36:39], v[108:111], v[92:95], v[36:39]
  ds_read_b128 v[52:55], v10 offset:46080
  ds_read_b128 v[56:59], v10 offset:47104
  ds_read_b128 v[60:63], v10 offset:48128
  v_mfma_f32_16x16x32_bf16 v[40:43], v[112:115], v[92:95], v[40:43]
  ds_read_b128 v[64:67], v10 offset:49152
  ds_read_b128 v[72:75], v10 offset:50176
  ds_read_b128 v[76:79], v10 offset:51200
  v_mfma_f32_16x16x32_bf16 v[24:27], v[120:123], v[116:119], v[24:27]
  ds_read_b128 v[80:83], v10 offset:52224
  ds_read_b128 v[84:87], v10 offset:53248
  ds_read_b128 v[88:91], v10 offset:54272
  v_mfma_f32_16x16x32_bf16 v[28:31], v[124:127], v[116:119], v[28:31]
  v_mfma_f32_16x16x32_bf16 v[32:35], v[128:131], v[116:119], v[32:35]
  v_mfma_f32_16x16x32_bf16 v[36:39], v[132:135], v[116:119], v[36:39]
  v_mfma_f32_16x16x32_bf16 v[40:43], v[136:139], v[116:119], v[40:43]
  s_waitcnt lgkmcnt(0)
  v_mfma_f32_16x16x32_bf16 v[24:27], v[48:51], v[44:47], v[24:27]
  ds_read_b128 v[92:95], v8 offset:40960
  ds_read_b128 v[96:99], v10 offset:55296
  v_mfma_f32_16x16x32_bf16 v[28:31], v[52:55], v[44:47], v[28:31]
  ds_read_b128 v[116:119], v8 offset:45056
  ds_read_b128 v[100:103], v10 offset:56320
  v_mfma_f32_16x16x32_bf16 v[32:35], v[56:59], v[44:47], v[32:35]
  ds_read_b128 v[104:107], v10 offset:57344
  ds_read_b128 v[108:111], v10 offset:58368
  v_mfma_f32_16x16x32_bf16 v[36:39], v[60:63], v[44:47], v[36:39]
  ds_read_b128 v[112:115], v10 offset:59392
  ds_read_b128 v[120:123], v10 offset:60416
  v_mfma_f32_16x16x32_bf16 v[40:43], v[64:67], v[44:47], v[40:43]
  ds_read_b128 v[124:127], v10 offset:61440
  ds_read_b128 v[128:131], v10 offset:62464
  v_mfma_f32_16x16x32_bf16 v[24:27], v[72:75], v[68:71], v[24:27]
  ds_read_b128 v[132:135], v10 offset:63488
  ds_read_b128 v[136:139], v10 offset:64512
  v_mfma_f32_16x16x32_bf16 v[28:31], v[76:79], v[68:71], v[28:31]
  v_mfma_f32_16x16x32_bf16 v[32:35], v[80:83], v[68:71], v[32:35]
  v_mfma_f32_16x16x32_bf16 v[36:39], v[84:87], v[68:71], v[36:39]
  v_mfma_f32_16x16x32_bf16 v[40:43], v[88:91], v[68:71], v[40:43]
  s_waitcnt lgkmcnt(0)
  v_mfma_f32_16x16x32_bf16 v[24:27], v[96:99], v[92:95], v[24:27]
  v_mfma_f32_16x16x32_bf16 v[28:31], v[100:103], v[92:95], v[28:31]
  s_barrier
  v_mfma_f32_16x16x32_bf16 v[32:35], v[104:107], v[92:95], v[32:35]
  ds_read_b128 v[44:47], v8 offset:49152
  ds_read_b128 v[48:51], v11 offset:0
  ds_read_b128 v[68:71], v8 offset:53248
  v_mfma_f32_16x16x32_bf16 v[36:39], v[108:111], v[92:95], v[36:39]
  ds_read_b128 v[52:55], v11 offset:1024
  ds_read_b128 v[56:59], v11 offset:2048
  ds_read_b128 v[60:63], v11 offset:3072
  v_mfma_f32_16x16x32_bf16 v[40:43], v[112:115], v[92:95], v[40:43]
  ds_read_b128 v[64:67], v11 offset:4096
  ds_read_b128 v[72:75], v11 offset:5120
  ds_read_b128 v[76:79], v11 offset:6144
  v_mfma_f32_16x16x32_bf16 v[24:27], v[120:123], v[116:119], v[24:27]
  ds_read_b128 v[80:83], v11 offset:7168
  ds_read_b128 v[84:87], v11 offset:8192
  ds_read_b128 v[88:91], v11 offset:9216
  v_mfma_f32_16x16x32_bf16 v[28:31], v[124:127], v[116:119], v[28:31]
  v_mfma_f32_16x16x32_bf16 v[32:35], v[128:131], v[116:119], v[32:35]
  v_mfma_f32_16x16x32_bf16 v[36:39], v[132:135], v[116:119], v[36:39]
  v_mfma_f32_16x16x32_bf16 v[40:43], v[136:139], v[116:119], v[40:43]
  s_waitcnt lgkmcnt(0)
  v_mfma_f32_16x16x32_bf16 v[24:27], v[48:51], v[44:47], v[24:27]
  ds_read_b128 v[92:95], v8 offset:57344
  ds_read_b128 v[96:99], v11 offset:10240
  v_mfma_f32_16x16x32_bf16 v[28:31], v[52:55], v[44:47], v[28:31]
  ds_read_b128 v[116:119], v8 offset:61440
  ds_read_b128 v[100:103], v11 offset:11264
  v_mfma_f32_16x16x32_bf16 v[32:35], v[56:59], v[44:47], v[32:35]
  ds_read_b128 v[104:107], v11 offset:12288
  ds_read_b128 v[108:111], v11 offset:13312
  v_mfma_f32_16x16x32_bf16 v[36:39], v[60:63], v[44:47], v[36:39]
  ds_read_b128 v[112:115], v11 offset:14336
  ds_read_b128 v[120:123], v11 offset:15360
  v_mfma_f32_16x16x32_bf16 v[40:43], v[64:67], v[44:47], v[40:43]
  ds_read_b128 v[124:127], v11 offset:16384
  ds_read_b128 v[128:131], v11 offset:17408
  v_mfma_f32_16x16x32_bf16 v[24:27], v[72:75], v[68:71], v[24:27]
  ds_read_b128 v[132:135], v11 offset:18432
  ds_read_b128 v[136:139], v11 offset:19456
  v_mfma_f32_16x16x32_bf16 v[28:31], v[76:79], v[68:71], v[28:31]
  v_mfma_f32_16x16x32_bf16 v[32:35], v[80:83], v[68:71], v[32:35]
  v_mfma_f32_16x16x32_bf16 v[36:39], v[84:87], v[68:71], v[36:39]
  v_mfma_f32_16x16x32_bf16 v[40:43], v[88:91], v[68:71], v[40:43]
  s_waitcnt lgkmcnt(0)
  v_mfma_f32_16x16x32_bf16 v[24:27], v[96:99], v[92:95], v[24:27]
  v_mfma_f32_16x16x32_bf16 v[28:31], v[100:103], v[92:95], v[28:31]
  v_mfma_f32_16x16x32_bf16 v[32:35], v[104:107], v[92:95], v[32:35]
  v_mfma_f32_16x16x32_bf16 v[36:39], v[108:111], v[92:95], v[36:39]
  v_mfma_f32_16x16x32_bf16 v[40:43], v[112:115], v[92:95], v[40:43]
  v_mfma_f32_16x16x32_bf16 v[24:27], v[120:123], v[116:119], v[24:27]
  v_mfma_f32_16x16x32_bf16 v[28:31], v[124:127], v[116:119], v[28:31]
  v_mfma_f32_16x16x32_bf16 v[32:35], v[128:131], v[116:119], v[32:35]
  v_mfma_f32_16x16x32_bf16 v[36:39], v[132:135], v[116:119], v[36:39]
  v_mfma_f32_16x16x32_bf16 v[40:43], v[136:139], v[116:119], v[40:43]
  s_barrier
  s_nop 7
  v_lshlrev_b32 v4, 16, v246
  v_and_b32 v5, 0xffff0000, v246
  v_lshlrev_b32 v6, 16, v247
  v_and_b32 v7, 0xffff0000, v247
  v_pk_add_f32 v[24:25], v[24:25], v[4:5]
  v_pk_add_f32 v[26:27], v[26:27], v[6:7]
  v_cvt_pk_bf16_f32 v246, v24, v25
  v_cvt_pk_bf16_f32 v247, v26, v27

  v_lshlrev_b32 v4, 16, v248
  v_and_b32 v5, 0xffff0000, v248
  v_lshlrev_b32 v6, 16, v249
  v_and_b32 v7, 0xffff0000, v249
  v_pk_add_f32 v[28:29], v[28:29], v[4:5]
  v_pk_add_f32 v[30:31], v[30:31], v[6:7]
  v_cvt_pk_bf16_f32 v248, v28, v29
  v_cvt_pk_bf16_f32 v249, v30, v31

  v_lshlrev_b32 v4, 16, v250
  v_and_b32 v5, 0xffff0000, v250
  v_lshlrev_b32 v6, 16, v251
  v_and_b32 v7, 0xffff0000, v251
  v_pk_add_f32 v[32:33], v[32:33], v[4:5]
  v_pk_add_f32 v[34:35], v[34:35], v[6:7]
  v_cvt_pk_bf16_f32 v250, v32, v33
  v_cvt_pk_bf16_f32 v251, v34, v35

  v_lshlrev_b32 v4, 16, v252
  v_and_b32 v5, 0xffff0000, v252
  v_lshlrev_b32 v6, 16, v253
  v_and_b32 v7, 0xffff0000, v253
  v_pk_add_f32 v[36:37], v[36:37], v[4:5]
  v_pk_add_f32 v[38:39], v[38:39], v[6:7]
  v_cvt_pk_bf16_f32 v252, v36, v37
  v_cvt_pk_bf16_f32 v253, v38, v39

  v_lshlrev_b32 v4, 16, v254
  v_and_b32 v5, 0xffff0000, v254
  v_lshlrev_b32 v6, 16, v255
  v_and_b32 v7, 0xffff0000, v255
  v_pk_add_f32 v[40:41], v[40:41], v[4:5]
  v_pk_add_f32 v[42:43], v[42:43], v[6:7]
  v_cvt_pk_bf16_f32 v254, v40, v41
  v_cvt_pk_bf16_f32 v255, v42, v43

  v_mov_b32 v44, v246
  v_mov_b32 v45, v247
  v_mov_b32 v46, v248
  v_mov_b32 v47, v249
  v_mov_b32 v48, v250
  v_mov_b32 v49, v251
  v_mov_b32 v50, v252
  v_mov_b32 v51, v253
  s_cmp_eq_u32 s30, 1
  s_cbranch_scc1 Lout_43
  s_mul_i32 s37, s28, 163840
  s_add_u32 s37, s37, s32
  s_add_u32 s37, s37, 19398656
  s_and_b32 s38, s52, 1
  s_lshl_b32 s38, s38, 2
  s_add_u32 s38, s38, s33
  s_lshl_b32 s38, s38, 11
  s_add_u32 s37, s37, s38
  s_mul_i32 s38, s53, 10
  v_and_b32 v4, 1, v3
  v_lshrrev_b32 v5, 1, v3
  v_lshl_add_u32 v6, v4, 1, v5
  v_add_u32 v6, s38, v6
  v_add_u32 v7, s38, v5
  v_permlane16_swap_b32 v44, v46
  v_permlane16_swap_b32 v45, v47
  v_permlane16_swap_b32 v48, v50
  v_permlane16_swap_b32 v49, v51

  v_add_u32 v8, 0, v6
  v_lshrrev_b32 v9, 3, v8
  v_lshlrev_b32 v9, 14, v9
  v_and_b32 v8, 7, v8
  v_lshl_add_u32 v9, v8, 8, v9
  v_lshl_add_u32 v52, v2, 4, v9
  buffer_store_dwordx4 v[44:47], v52, s[16:19], s37 offen sc0 sc1

  v_add_u32 v8, 4, v6
  v_lshrrev_b32 v9, 3, v8
  v_lshlrev_b32 v9, 14, v9
  v_and_b32 v8, 7, v8
  v_lshl_add_u32 v9, v8, 8, v9
  v_lshl_add_u32 v53, v2, 4, v9
  buffer_store_dwordx4 v[48:51], v53, s[16:19], s37 offen sc0 sc1

  v_add_u32 v8, 8, v7
  v_lshrrev_b32 v9, 3, v8
  v_lshlrev_b32 v9, 14, v9
  v_and_b32 v8, 7, v8
  v_lshl_add_u32 v9, v8, 8, v9
  v_lshl_add_u32 v9, v2, 4, v9
  v_lshl_add_u32 v54, v4, 3, v9
  buffer_store_dwordx2 v[254:255], v54, s[16:19], s37 offen sc0 sc1
  s_mov_b32 s60, 0x3f803f80
  v_mov_b32 v12, 0
  v_mov_b32 v13, 0

  v_dot2_f32_bf16 v12, v246, s60, v12
  v_dot2_f32_bf16 v13, v246, v246, v13
  v_dot2_f32_bf16 v12, v247, s60, v12
  v_dot2_f32_bf16 v13, v247, v247, v13
  v_dot2_f32_bf16 v12, v248, s60, v12
  v_dot2_f32_bf16 v13, v248, v248, v13
  v_dot2_f32_bf16 v12, v249, s60, v12
  v_dot2_f32_bf16 v13, v249, v249, v13
  v_dot2_f32_bf16 v12, v250, s60, v12
  v_dot2_f32_bf16 v13, v250, v250, v13
  v_dot2_f32_bf16 v12, v251, s60, v12
  v_dot2_f32_bf16 v13, v251, v251, v13
  v_dot2_f32_bf16 v12, v252, s60, v12
  v_dot2_f32_bf16 v13, v252, v252, v13
  v_dot2_f32_bf16 v12, v253, s60, v12
  v_dot2_f32_bf16 v13, v253, v253, v13
  v_dot2_f32_bf16 v12, v254, s60, v12
  v_dot2_f32_bf16 v13, v254, v254, v13
  v_dot2_f32_bf16 v12, v255, s60, v12
  v_dot2_f32_bf16 v13, v255, v255, v13
  s_nop 2
  v_mov_b32 v14, v12
  v_mov_b32 v15, v13
  s_nop 1
  v_permlane16_swap_b32 v12, v14
  v_permlane16_swap_b32 v13, v15
  s_nop 1
  v_add_f32 v12, v12, v14
  v_add_f32 v13, v13, v15
  v_mov_b32 v14, v12
  v_mov_b32 v15, v13
  s_nop 1
  v_permlane32_swap_b32 v12, v14
  v_permlane32_swap_b32 v13, v15
  s_nop 1
  v_add_f32 v12, v12, v14
  v_add_f32 v13, v13, v15
  s_lshl_b32 s37, s52, 2
  s_add_u32 s37, s37, s33
  s_lshl_b32 s37, s37, 3
  s_add_u32 s37, s37, s53
  s_lshl_b32 s37, s37, 7
  s_add_u32 s37, s37, s32
  s_add_u32 s37, s37, 22151168
  v_lshlrev_b32 v4, 3, v2
  s_mov_b64 exec, 0xffff
  buffer_store_dwordx2 v[12:13], v4, s[16:19], s37 offen sc0 sc1
  s_mov_b64 exec, -1

  s_branch Le35_44
  Lout_43:
  s_lshl_b32 s37, s52, 2
  s_add_u32 s37, s37, s33
  s_mul_i32 s37, s37, 20480
  s_mul_i32 s38, s53, 160
  s_add_u32 s37, s37, s38
  v_mul_u32_u24 v6, 1280, v2
  v_and_b32 v4, 1, v3
  v_lshrrev_b32 v5, 1, v3
  v_lshl_add_u32 v7, v4, 5, v6
  v_lshl_add_u32 v7, v5, 4, v7
  v_lshl_add_u32 v8, v3, 3, v6
  v_permlane16_swap_b32 v44, v46
  v_permlane16_swap_b32 v45, v47
  v_permlane16_swap_b32 v48, v50
  v_permlane16_swap_b32 v49, v51
  s_nop 1
  buffer_store_dwordx4 v[44:47], v7, s[20:23], s37 offen
  buffer_store_dwordx4 v[48:51], v7, s[20:23], s37 offen offset:64
  buffer_store_dwordx2 v[254:255], v8, s[20:23], s37 offen offset:128
  Le35_44:

  s_waitcnt vmcnt(0)
  s_cmp_eq_u32 s30, 1
  s_cbranch_scc1 LM_fin
  s_barrier
  s_barrier
  s_mov_b32 s30, 1
  s_add_u32 s32, s32, 25165824
  s_add_u32 s46, s46, 40960

  v_mov_b32 v8, v1
  v_add_u32 v9, 1024, v1
  s_lshl_b32 s35, s33, 13
  s_add_u32 s35, s35, 53248
  v_add_u32 v8, s35, v8
  v_add_u32 v9, s35, v9
  v_add_u32 v22, 0x10000, v8
  v_add_u32 v23, 0x10000, v9

  v_mov_b32 v10, v1
  v_add_u32 v11, 0x10000, v1
  v_mov_b32 v152, 0
  v_mov_b32 v153, 0
  v_mov_b32 v154, 0
  v_mov_b32 v155, 0
  v_mov_b32 v156, 0
  v_mov_b32 v157, 0
  v_mov_b32 v158, 0
  v_mov_b32 v159, 0
  v_mov_b32 v160, 0
  v_mov_b32 v161, 0
  v_mov_b32 v162, 0
  v_mov_b32 v163, 0
  v_mov_b32 v164, 0
  v_mov_b32 v165, 0
  v_mov_b32 v166, 0
  v_mov_b32 v167, 0
  v_mov_b32 v168, 0x3f803f80
  v_mov_b32 v169, 0x3f803f80
  v_mov_b32 v170, 0x3f803f80
  v_mov_b32 v171, 0x3f803f80
  v_mov_b32 v24, 0
  v_mov_b32 v25, 0
  v_mov_b32 v26, 0
  v_mov_b32 v27, 0
  v_mov_b32 v28, 0
  v_mov_b32 v29, 0
  v_mov_b32 v30, 0
  v_mov_b32 v31, 0
  v_mov_b32 v32, 0
  v_mov_b32 v33, 0
  v_mov_b32 v34, 0
  v_mov_b32 v35, 0
  v_mov_b32 v36, 0
  v_mov_b32 v37, 0
  v_mov_b32 v38, 0
  v_mov_b32 v39, 0
  v_mov_b32 v40, 0
  v_mov_b32 v41, 0
  v_mov_b32 v42, 0
  v_mov_b32 v43, 0
  v_mov_b32 v44, 0
  v_mov_b32 v45, 0
  v_mov_b32 v46, 0
  v_mov_b32 v47, 0
  v_mov_b32 v48, 0
  v_mov_b32 v49, 0
  v_mov_b32 v50, 0
  v_mov_b32 v51, 0
  v_mov_b32 v52, 0
  v_mov_b32 v53, 0
  v_mov_b32 v54, 0
  v_mov_b32 v55, 0
  v_mov_b32 v56, 0
  v_mov_b32 v57, 0
  v_mov_b32 v58, 0
  v_mov_b32 v59, 0
  v_mov_b32 v60, 0
  v_mov_b32 v61, 0
  v_mov_b32 v62, 0
  v_mov_b32 v63, 0
  v_mov_b32 v64, 0
  v_mov_b32 v65, 0
  v_mov_b32 v66, 0
  v_mov_b32 v67, 0
  v_mov_b32 v68, 0
  v_mov_b32 v69, 0
  v_mov_b32 v70, 0
  v_mov_b32 v71, 0
  v_mov_b32 v72, 0
  v_mov_b32 v73, 0
  v_mov_b32 v74, 0
  v_mov_b32 v75, 0
  v_mov_b32 v76, 0
  v_mov_b32 v77, 0
  v_mov_b32 v78, 0
  v_mov_b32 v79, 0
  v_mov_b32 v80, 0
  v_mov_b32 v81, 0
  v_mov_b32 v82, 0
  v_mov_b32 v83, 0
  v_mov_b32 v84, 0
  v_mov_b32 v85, 0
  v_mov_b32 v86, 0
  v_mov_b32 v87, 0
  s_barrier
  ds_read_b128 v[88:91], v8 offset:0
  ds_read_b128 v[104:107], v10 offset:4096
  ds_read_b128 v[92:95], v8 offset:2048
  ds_read_b128 v[108:111], v10 offset:5120
  ds_read_b128 v[96:99], v8 offset:4096
  ds_read_b128 v[112:115], v10 offset:6144
  ds_read_b128 v[100:103], v8 offset:6144
  ds_read_b128 v[116:119], v10 offset:7168
  s_waitcnt lgkmcnt(0)
  v_mfma_f32_16x16x32_bf16 v[24:27], v[88:91], v[104:107], v[24:27]
  ds_read_b128 v[120:123], v9 offset:0
  v_mfma_f32_16x16x32_bf16 v[28:31], v[88:91], v[108:111], v[28:31]
  ds_read_b128 v[136:139], v10 offset:8192
  v_mfma_f32_16x16x32_bf16 v[32:35], v[88:91], v[112:115], v[32:35]
  ds_read_b128 v[124:127], v9 offset:2048
  v_mfma_f32_16x16x32_bf16 v[36:39], v[88:91], v[116:119], v[36:39]
  ds_read_b128 v[140:143], v10 offset:9216
  v_mfma_f32_16x16x32_bf16 v[40:43], v[92:95], v[104:107], v[40:43]
  ds_read_b128 v[128:131], v9 offset:4096
  v_mfma_f32_16x16x32_bf16 v[44:47], v[92:95], v[108:111], v[44:47]
  ds_read_b128 v[144:147], v10 offset:10240
  v_mfma_f32_16x16x32_bf16 v[48:51], v[92:95], v[112:115], v[48:51]
  ds_read_b128 v[132:135], v9 offset:6144
  v_mfma_f32_16x16x32_bf16 v[52:55], v[92:95], v[116:119], v[52:55]
  ds_read_b128 v[148:151], v10 offset:11264
  v_mfma_f32_16x16x32_bf16 v[56:59], v[96:99], v[104:107], v[56:59]
  v_mfma_f32_16x16x32_bf16 v[60:63], v[96:99], v[108:111], v[60:63]
  v_mfma_f32_16x16x32_bf16 v[64:67], v[96:99], v[112:115], v[64:67]
  v_mfma_f32_16x16x32_bf16 v[68:71], v[96:99], v[116:119], v[68:71]
  v_mfma_f32_16x16x32_bf16 v[72:75], v[100:103], v[104:107], v[72:75]
  v_mfma_f32_16x16x32_bf16 v[76:79], v[100:103], v[108:111], v[76:79]
  v_mfma_f32_16x16x32_bf16 v[80:83], v[100:103], v[112:115], v[80:83]
  v_mfma_f32_16x16x32_bf16 v[84:87], v[100:103], v[116:119], v[84:87]
  v_mfma_f32_16x16x32_bf16 v[152:155], v[168:171], v[104:107], v[152:155]
  v_mfma_f32_16x16x32_bf16 v[156:159], v[168:171], v[108:111], v[156:159]
  v_mfma_f32_16x16x32_bf16 v[160:163], v[168:171], v[112:115], v[160:163]
  v_mfma_f32_16x16x32_bf16 v[164:167], v[168:171], v[116:119], v[164:167]
  s_waitcnt lgkmcnt(0)
  v_mfma_f32_16x16x32_bf16 v[24:27], v[120:123], v[136:139], v[24:27]
  v_mfma_f32_16x16x32_bf16 v[28:31], v[120:123], v[140:143], v[28:31]
  s_barrier
  v_mfma_f32_16x16x32_bf16 v[32:35], v[120:123], v[144:147], v[32:35]
  ds_read_b128 v[88:91], v8 offset:32768
  v_mfma_f32_16x16x32_bf16 v[36:39], v[120:123], v[148:151], v[36:39]
  ds_read_b128 v[104:107], v10 offset:12288
  v_mfma_f32_16x16x32_bf16 v[40:43], v[124:127], v[136:139], v[40:43]
  ds_read_b128 v[92:95], v8 offset:34816
  v_mfma_f32_16x16x32_bf16 v[44:47], v[124:127], v[140:143], v[44:47]
  ds_read_b128 v[108:111], v10 offset:13312
  v_mfma_f32_16x16x32_bf16 v[48:51], v[124:127], v[144:147], v[48:51]
  ds_read_b128 v[96:99], v8 offset:36864
  v_mfma_f32_16x16x32_bf16 v[52:55], v[124:127], v[148:151], v[52:55]
  ds_read_b128 v[112:115], v10 offset:14336
  v_mfma_f32_16x16x32_bf16 v[56:59], v[128:131], v[136:139], v[56:59]
  ds_read_b128 v[100:103], v8 offset:38912
  v_mfma_f32_16x16x32_bf16 v[60:63], v[128:131], v[140:143], v[60:63]
  ds_read_b128 v[116:119], v10 offset:15360
  v_mfma_f32_16x16x32_bf16 v[64:67], v[128:131], v[144:147], v[64:67]
  v_mfma_f32_16x16x32_bf16 v[68:71], v[128:131], v[148:151], v[68:71]
  v_mfma_f32_16x16x32_bf16 v[72:75], v[132:135], v[136:139], v[72:75]
  v_mfma_f32_16x16x32_bf16 v[76:79], v[132:135], v[140:143], v[76:79]
  v_mfma_f32_16x16x32_bf16 v[80:83], v[132:135], v[144:147], v[80:83]
  v_mfma_f32_16x16x32_bf16 v[84:87], v[132:135], v[148:151], v[84:87]
  v_mfma_f32_16x16x32_bf16 v[152:155], v[168:171], v[136:139], v[152:155]
  v_mfma_f32_16x16x32_bf16 v[156:159], v[168:171], v[140:143], v[156:159]
  v_mfma_f32_16x16x32_bf16 v[160:163], v[168:171], v[144:147], v[160:163]
  v_mfma_f32_16x16x32_bf16 v[164:167], v[168:171], v[148:151], v[164:167]
  s_waitcnt lgkmcnt(0)
  v_mfma_f32_16x16x32_bf16 v[24:27], v[88:91], v[104:107], v[24:27]
  ds_read_b128 v[120:123], v9 offset:32768
  v_mfma_f32_16x16x32_bf16 v[28:31], v[88:91], v[108:111], v[28:31]
  ds_read_b128 v[136:139], v10 offset:16384
  v_mfma_f32_16x16x32_bf16 v[32:35], v[88:91], v[112:115], v[32:35]
  ds_read_b128 v[124:127], v9 offset:34816
  v_mfma_f32_16x16x32_bf16 v[36:39], v[88:91], v[116:119], v[36:39]
  ds_read_b128 v[140:143], v10 offset:17408
  v_mfma_f32_16x16x32_bf16 v[40:43], v[92:95], v[104:107], v[40:43]
  ds_read_b128 v[128:131], v9 offset:36864
  v_mfma_f32_16x16x32_bf16 v[44:47], v[92:95], v[108:111], v[44:47]
  ds_read_b128 v[144:147], v10 offset:18432
  v_mfma_f32_16x16x32_bf16 v[48:51], v[92:95], v[112:115], v[48:51]
  ds_read_b128 v[132:135], v9 offset:38912
  v_mfma_f32_16x16x32_bf16 v[52:55], v[92:95], v[116:119], v[52:55]
  ds_read_b128 v[148:151], v10 offset:19456
  v_mfma_f32_16x16x32_bf16 v[56:59], v[96:99], v[104:107], v[56:59]
  v_mfma_f32_16x16x32_bf16 v[60:63], v[96:99], v[108:111], v[60:63]
  v_mfma_f32_16x16x32_bf16 v[64:67], v[96:99], v[112:115], v[64:67]
  v_mfma_f32_16x16x32_bf16 v[68:71], v[96:99], v[116:119], v[68:71]
  v_mfma_f32_16x16x32_bf16 v[72:75], v[100:103], v[104:107], v[72:75]
  v_mfma_f32_16x16x32_bf16 v[76:79], v[100:103], v[108:111], v[76:79]
  v_mfma_f32_16x16x32_bf16 v[80:83], v[100:103], v[112:115], v[80:83]
  v_mfma_f32_16x16x32_bf16 v[84:87], v[100:103], v[116:119], v[84:87]
  v_mfma_f32_16x16x32_bf16 v[152:155], v[168:171], v[104:107], v[152:155]
  v_mfma_f32_16x16x32_bf16 v[156:159], v[168:171], v[108:111], v[156:159]
  v_mfma_f32_16x16x32_bf16 v[160:163], v[168:171], v[112:115], v[160:163]
  v_mfma_f32_16x16x32_bf16 v[164:167], v[168:171], v[116:119], v[164:167]
  s_waitcnt lgkmcnt(0)
  v_mfma_f32_16x16x32_bf16 v[24:27], v[120:123], v[136:139], v[24:27]
  v_mfma_f32_16x16x32_bf16 v[28:31], v[120:123], v[140:143], v[28:31]
  s_barrier
  v_mfma_f32_16x16x32_bf16 v[32:35], v[120:123], v[144:147], v[32:35]
  ds_read_b128 v[88:91], v22 offset:0
  v_mfma_f32_16x16x32_bf16 v[36:39], v[120:123], v[148:151], v[36:39]
  ds_read_b128 v[104:107], v10 offset:20480
  v_mfma_f32_16x16x32_bf16 v[40:43], v[124:127], v[136:139], v[40:43]
  ds_read_b128 v[92:95], v22 offset:2048
  v_mfma_f32_16x16x32_bf16 v[44:47], v[124:127], v[140:143], v[44:47]
  ds_read_b128 v[108:111], v10 offset:21504
  v_mfma_f32_16x16x32_bf16 v[48:51], v[124:127], v[144:147], v[48:51]
  ds_read_b128 v[96:99], v22 offset:4096
  v_mfma_f32_16x16x32_bf16 v[52:55], v[124:127], v[148:151], v[52:55]
  ds_read_b128 v[112:115], v10 offset:22528
  v_mfma_f32_16x16x32_bf16 v[56:59], v[128:131], v[136:139], v[56:59]
  ds_read_b128 v[100:103], v22 offset:6144
  v_mfma_f32_16x16x32_bf16 v[60:63], v[128:131], v[140:143], v[60:63]
  ds_read_b128 v[116:119], v10 offset:23552
  v_mfma_f32_16x16x32_bf16 v[64:67], v[128:131], v[144:147], v[64:67]
  v_mfma_f32_16x16x32_bf16 v[68:71], v[128:131], v[148:151], v[68:71]
  v_mfma_f32_16x16x32_bf16 v[72:75], v[132:135], v[136:139], v[72:75]
  v_mfma_f32_16x16x32_bf16 v[76:79], v[132:135], v[140:143], v[76:79]
  v_mfma_f32_16x16x32_bf16 v[80:83], v[132:135], v[144:147], v[80:83]
  v_mfma_f32_16x16x32_bf16 v[84:87], v[132:135], v[148:151], v[84:87]
  v_mfma_f32_16x16x32_bf16 v[152:155], v[168:171], v[136:139], v[152:155]
  v_mfma_f32_16x16x32_bf16 v[156:159], v[168:171], v[140:143], v[156:159]
  v_mfma_f32_16x16x32_bf16 v[160:163], v[168:171], v[144:147], v[160:163]
  v_mfma_f32_16x16x32_bf16 v[164:167], v[168:171], v[148:151], v[164:167]
  s_waitcnt lgkmcnt(0)
  v_mfma_f32_16x16x32_bf16 v[24:27], v[88:91], v[104:107], v[24:27]
  ds_read_b128 v[120:123], v23 offset:0
  v_mfma_f32_16x16x32_bf16 v[28:31], v[88:91], v[108:111], v[28:31]
  ds_read_b128 v[136:139], v10 offset:24576
  v_mfma_f32_16x16x32_bf16 v[32:35], v[88:91], v[112:115], v[32:35]
  ds_read_b128 v[124:127], v23 offset:2048
  v_mfma_f32_16x16x32_bf16 v[36:39], v[88:91], v[116:119], v[36:39]
  ds_read_b128 v[140:143], v10 offset:25600
  v_mfma_f32_16x16x32_bf16 v[40:43], v[92:95], v[104:107], v[40:43]
  ds_read_b128 v[128:131], v23 offset:4096
  v_mfma_f32_16x16x32_bf16 v[44:47], v[92:95], v[108:111], v[44:47]
  ds_read_b128 v[144:147], v10 offset:26624
  v_mfma_f32_16x16x32_bf16 v[48:51], v[92:95], v[112:115], v[48:51]
  ds_read_b128 v[132:135], v23 offset:6144
  v_mfma_f32_16x16x32_bf16 v[52:55], v[92:95], v[116:119], v[52:55]
  ds_read_b128 v[148:151], v10 offset:27648
  v_mfma_f32_16x16x32_bf16 v[56:59], v[96:99], v[104:107], v[56:59]
  v_mfma_f32_16x16x32_bf16 v[60:63], v[96:99], v[108:111], v[60:63]
  v_mfma_f32_16x16x32_bf16 v[64:67], v[96:99], v[112:115], v[64:67]
  v_mfma_f32_16x16x32_bf16 v[68:71], v[96:99], v[116:119], v[68:71]
  v_mfma_f32_16x16x32_bf16 v[72:75], v[100:103], v[104:107], v[72:75]
  v_mfma_f32_16x16x32_bf16 v[76:79], v[100:103], v[108:111], v[76:79]
  v_mfma_f32_16x16x32_bf16 v[80:83], v[100:103], v[112:115], v[80:83]
  v_mfma_f32_16x16x32_bf16 v[84:87], v[100:103], v[116:119], v[84:87]
  v_mfma_f32_16x16x32_bf16 v[152:155], v[168:171], v[104:107], v[152:155]
  v_mfma_f32_16x16x32_bf16 v[156:159], v[168:171], v[108:111], v[156:159]
  v_mfma_f32_16x16x32_bf16 v[160:163], v[168:171], v[112:115], v[160:163]
  v_mfma_f32_16x16x32_bf16 v[164:167], v[168:171], v[116:119], v[164:167]
  s_waitcnt lgkmcnt(0)
  v_mfma_f32_16x16x32_bf16 v[24:27], v[120:123], v[136:139], v[24:27]
  v_mfma_f32_16x16x32_bf16 v[28:31], v[120:123], v[140:143], v[28:31]
  s_barrier
  v_mfma_f32_16x16x32_bf16 v[32:35], v[120:123], v[144:147], v[32:35]
  ds_read_b128 v[88:91], v8 offset:0
  v_mfma_f32_16x16x32_bf16 v[36:39], v[120:123], v[148:151], v[36:39]
  ds_read_b128 v[104:107], v10 offset:28672
  v_mfma_f32_16x16x32_bf16 v[40:43], v[124:127], v[136:139], v[40:43]
  ds_read_b128 v[92:95], v8 offset:2048
  v_mfma_f32_16x16x32_bf16 v[44:47], v[124:127], v[140:143], v[44:47]
  ds_read_b128 v[108:111], v10 offset:29696
  v_mfma_f32_16x16x32_bf16 v[48:51], v[124:127], v[144:147], v[48:51]
  ds_read_b128 v[96:99], v8 offset:4096
  v_mfma_f32_16x16x32_bf16 v[52:55], v[124:127], v[148:151], v[52:55]
  ds_read_b128 v[112:115], v10 offset:30720
  v_mfma_f32_16x16x32_bf16 v[56:59], v[128:131], v[136:139], v[56:59]
  ds_read_b128 v[100:103], v8 offset:6144
  v_mfma_f32_16x16x32_bf16 v[60:63], v[128:131], v[140:143], v[60:63]
  ds_read_b128 v[116:119], v10 offset:31744
  v_mfma_f32_16x16x32_bf16 v[64:67], v[128:131], v[144:147], v[64:67]
  v_mfma_f32_16x16x32_bf16 v[68:71], v[128:131], v[148:151], v[68:71]
  v_mfma_f32_16x16x32_bf16 v[72:75], v[132:135], v[136:139], v[72:75]
  v_mfma_f32_16x16x32_bf16 v[76:79], v[132:135], v[140:143], v[76:79]
  v_mfma_f32_16x16x32_bf16 v[80:83], v[132:135], v[144:147], v[80:83]
  v_mfma_f32_16x16x32_bf16 v[84:87], v[132:135], v[148:151], v[84:87]
  v_mfma_f32_16x16x32_bf16 v[152:155], v[168:171], v[136:139], v[152:155]
  v_mfma_f32_16x16x32_bf16 v[156:159], v[168:171], v[140:143], v[156:159]
  v_mfma_f32_16x16x32_bf16 v[160:163], v[168:171], v[144:147], v[160:163]
  v_mfma_f32_16x16x32_bf16 v[164:167], v[168:171], v[148:151], v[164:167]
  s_waitcnt lgkmcnt(0)
  v_mfma_f32_16x16x32_bf16 v[24:27], v[88:91], v[104:107], v[24:27]
  ds_read_b128 v[120:123], v9 offset:0
  v_mfma_f32_16x16x32_bf16 v[28:31], v[88:91], v[108:111], v[28:31]
  ds_read_b128 v[136:139], v10 offset:32768
  v_mfma_f32_16x16x32_bf16 v[32:35], v[88:91], v[112:115], v[32:35]
  ds_read_b128 v[124:127], v9 offset:2048
  v_mfma_f32_16x16x32_bf16 v[36:39], v[88:91], v[116:119], v[36:39]
  ds_read_b128 v[140:143], v10 offset:33792
  v_mfma_f32_16x16x32_bf16 v[40:43], v[92:95], v[104:107], v[40:43]
  ds_read_b128 v[128:131], v9 offset:4096
  v_mfma_f32_16x16x32_bf16 v[44:47], v[92:95], v[108:111], v[44:47]
  ds_read_b128 v[144:147], v10 offset:34816
  v_mfma_f32_16x16x32_bf16 v[48:51], v[92:95], v[112:115], v[48:51]
  ds_read_b128 v[132:135], v9 offset:6144
  v_mfma_f32_16x16x32_bf16 v[52:55], v[92:95], v[116:119], v[52:55]
  ds_read_b128 v[148:151], v10 offset:35840
  v_mfma_f32_16x16x32_bf16 v[56:59], v[96:99], v[104:107], v[56:59]
  v_mfma_f32_16x16x32_bf16 v[60:63], v[96:99], v[108:111], v[60:63]
  v_mfma_f32_16x16x32_bf16 v[64:67], v[96:99], v[112:115], v[64:67]
  v_mfma_f32_16x16x32_bf16 v[68:71], v[96:99], v[116:119], v[68:71]
  v_mfma_f32_16x16x32_bf16 v[72:75], v[100:103], v[104:107], v[72:75]
  v_mfma_f32_16x16x32_bf16 v[76:79], v[100:103], v[108:111], v[76:79]
  v_mfma_f32_16x16x32_bf16 v[80:83], v[100:103], v[112:115], v[80:83]
  v_mfma_f32_16x16x32_bf16 v[84:87], v[100:103], v[116:119], v[84:87]
  v_mfma_f32_16x16x32_bf16 v[152:155], v[168:171], v[104:107], v[152:155]
  v_mfma_f32_16x16x32_bf16 v[156:159], v[168:171], v[108:111], v[156:159]
  v_mfma_f32_16x16x32_bf16 v[160:163], v[168:171], v[112:115], v[160:163]
  v_mfma_f32_16x16x32_bf16 v[164:167], v[168:171], v[116:119], v[164:167]
  s_waitcnt lgkmcnt(0)
  v_mfma_f32_16x16x32_bf16 v[24:27], v[120:123], v[136:139], v[24:27]
  v_mfma_f32_16x16x32_bf16 v[28:31], v[120:123], v[140:143], v[28:31]
  s_barrier
  v_mfma_f32_16x16x32_bf16 v[32:35], v[120:123], v[144:147], v[32:35]
  ds_read_b128 v[88:91], v8 offset:32768
  v_mfma_f32_16x16x32_bf16 v[36:39], v[120:123], v[148:151], v[36:39]
  ds_read_b128 v[104:107], v10 offset:36864
  v_mfma_f32_16x16x32_bf16 v[40:43], v[124:127], v[136:139], v[40:43]
  ds_read_b128 v[92:95], v8 offset:34816
  v_mfma_f32_16x16x32_bf16 v[44:47], v[124:127], v[140:143], v[44:47]
  ds_read_b128 v[108:111], v10 offset:37888
  v_mfma_f32_16x16x32_bf16 v[48:51], v[124:127], v[144:147], v[48:51]
  ds_read_b128 v[96:99], v8 offset:36864
  v_mfma_f32_16x16x32_bf16 v[52:55], v[124:127], v[148:151], v[52:55]
  ds_read_b128 v[112:115], v10 offset:38912
  v_mfma_f32_16x16x32_bf16 v[56:59], v[128:131], v[136:139], v[56:59]
  ds_read_b128 v[100:103], v8 offset:38912
  v_mfma_f32_16x16x32_bf16 v[60:63], v[128:131], v[140:143], v[60:63]
  ds_read_b128 v[116:119], v10 offset:39936
  v_mfma_f32_16x16x32_bf16 v[64:67], v[128:131], v[144:147], v[64:67]
  v_mfma_f32_16x16x32_bf16 v[68:71], v[128:131], v[148:151], v[68:71]
  v_mfma_f32_16x16x32_bf16 v[72:75], v[132:135], v[136:139], v[72:75]
  v_mfma_f32_16x16x32_bf16 v[76:79], v[132:135], v[140:143], v[76:79]
  v_mfma_f32_16x16x32_bf16 v[80:83], v[132:135], v[144:147], v[80:83]
  v_mfma_f32_16x16x32_bf16 v[84:87], v[132:135], v[148:151], v[84:87]
  v_mfma_f32_16x16x32_bf16 v[152:155], v[168:171], v[136:139], v[152:155]
  v_mfma_f32_16x16x32_bf16 v[156:159], v[168:171], v[140:143], v[156:159]
  v_mfma_f32_16x16x32_bf16 v[160:163], v[168:171], v[144:147], v[160:163]
  v_mfma_f32_16x16x32_bf16 v[164:167], v[168:171], v[148:151], v[164:167]
  s_waitcnt lgkmcnt(0)
  v_mfma_f32_16x16x32_bf16 v[24:27], v[88:91], v[104:107], v[24:27]
  ds_read_b128 v[120:123], v9 offset:32768
  v_mfma_f32_16x16x32_bf16 v[28:31], v[88:91], v[108:111], v[28:31]
  ds_read_b128 v[136:139], v10 offset:40960
  v_mfma_f32_16x16x32_bf16 v[32:35], v[88:91], v[112:115], v[32:35]
  ds_read_b128 v[124:127], v9 offset:34816
  v_mfma_f32_16x16x32_bf16 v[36:39], v[88:91], v[116:119], v[36:39]
  ds_read_b128 v[140:143], v10 offset:41984
  v_mfma_f32_16x16x32_bf16 v[40:43], v[92:95], v[104:107], v[40:43]
  ds_read_b128 v[128:131], v9 offset:36864
  v_mfma_f32_16x16x32_bf16 v[44:47], v[92:95], v[108:111], v[44:47]
  ds_read_b128 v[144:147], v10 offset:43008
  v_mfma_f32_16x16x32_bf16 v[48:51], v[92:95], v[112:115], v[48:51]
  ds_read_b128 v[132:135], v9 offset:38912
  v_mfma_f32_16x16x32_bf16 v[52:55], v[92:95], v[116:119], v[52:55]
  ds_read_b128 v[148:151], v10 offset:44032
  v_mfma_f32_16x16x32_bf16 v[56:59], v[96:99], v[104:107], v[56:59]
  v_mfma_f32_16x16x32_bf16 v[60:63], v[96:99], v[108:111], v[60:63]
  v_mfma_f32_16x16x32_bf16 v[64:67], v[96:99], v[112:115], v[64:67]
  v_mfma_f32_16x16x32_bf16 v[68:71], v[96:99], v[116:119], v[68:71]
  v_mfma_f32_16x16x32_bf16 v[72:75], v[100:103], v[104:107], v[72:75]
  v_mfma_f32_16x16x32_bf16 v[76:79], v[100:103], v[108:111], v[76:79]
  v_mfma_f32_16x16x32_bf16 v[80:83], v[100:103], v[112:115], v[80:83]
  v_mfma_f32_16x16x32_bf16 v[84:87], v[100:103], v[116:119], v[84:87]
  v_mfma_f32_16x16x32_bf16 v[152:155], v[168:171], v[104:107], v[152:155]
  v_mfma_f32_16x16x32_bf16 v[156:159], v[168:171], v[108:111], v[156:159]
  v_mfma_f32_16x16x32_bf16 v[160:163], v[168:171], v[112:115], v[160:163]
  v_mfma_f32_16x16x32_bf16 v[164:167], v[168:171], v[116:119], v[164:167]
  s_waitcnt lgkmcnt(0)
  v_mfma_f32_16x16x32_bf16 v[24:27], v[120:123], v[136:139], v[24:27]
  v_mfma_f32_16x16x32_bf16 v[28:31], v[120:123], v[140:143], v[28:31]
  s_barrier
  v_mfma_f32_16x16x32_bf16 v[32:35], v[120:123], v[144:147], v[32:35]
  ds_read_b128 v[88:91], v22 offset:0
  v_mfma_f32_16x16x32_bf16 v[36:39], v[120:123], v[148:151], v[36:39]
  ds_read_b128 v[104:107], v10 offset:45056
  v_mfma_f32_16x16x32_bf16 v[40:43], v[124:127], v[136:139], v[40:43]
  ds_read_b128 v[92:95], v22 offset:2048
  v_mfma_f32_16x16x32_bf16 v[44:47], v[124:127], v[140:143], v[44:47]
  ds_read_b128 v[108:111], v10 offset:46080
  v_mfma_f32_16x16x32_bf16 v[48:51], v[124:127], v[144:147], v[48:51]
  ds_read_b128 v[96:99], v22 offset:4096
  v_mfma_f32_16x16x32_bf16 v[52:55], v[124:127], v[148:151], v[52:55]
  ds_read_b128 v[112:115], v10 offset:47104
  v_mfma_f32_16x16x32_bf16 v[56:59], v[128:131], v[136:139], v[56:59]
  ds_read_b128 v[100:103], v22 offset:6144
  v_mfma_f32_16x16x32_bf16 v[60:63], v[128:131], v[140:143], v[60:63]
  ds_read_b128 v[116:119], v10 offset:48128
  v_mfma_f32_16x16x32_bf16 v[64:67], v[128:131], v[144:147], v[64:67]
  v_mfma_f32_16x16x32_bf16 v[68:71], v[128:131], v[148:151], v[68:71]
  v_mfma_f32_16x16x32_bf16 v[72:75], v[132:135], v[136:139], v[72:75]
  v_mfma_f32_16x16x32_bf16 v[76:79], v[132:135], v[140:143], v[76:79]
  v_mfma_f32_16x16x32_bf16 v[80:83], v[132:135], v[144:147], v[80:83]
  v_mfma_f32_16x16x32_bf16 v[84:87], v[132:135], v[148:151], v[84:87]
  v_mfma_f32_16x16x32_bf16 v[152:155], v[168:171], v[136:139], v[152:155]
  v_mfma_f32_16x16x32_bf16 v[156:159], v[168:171], v[140:143], v[156:159]
  v_mfma_f32_16x16x32_bf16 v[160:163], v[168:171], v[144:147], v[160:163]
  v_mfma_f32_16x16x32_bf16 v[164:167], v[168:171], v[148:151], v[164:167]
  s_waitcnt lgkmcnt(0)
  v_mfma_f32_16x16x32_bf16 v[24:27], v[88:91], v[104:107], v[24:27]
  ds_read_b128 v[120:123], v23 offset:0
  v_mfma_f32_16x16x32_bf16 v[28:31], v[88:91], v[108:111], v[28:31]
  ds_read_b128 v[136:139], v10 offset:49152
  v_mfma_f32_16x16x32_bf16 v[32:35], v[88:91], v[112:115], v[32:35]
  ds_read_b128 v[124:127], v23 offset:2048
  v_mfma_f32_16x16x32_bf16 v[36:39], v[88:91], v[116:119], v[36:39]
  ds_read_b128 v[140:143], v10 offset:50176
  v_mfma_f32_16x16x32_bf16 v[40:43], v[92:95], v[104:107], v[40:43]
  ds_read_b128 v[128:131], v23 offset:4096
  v_mfma_f32_16x16x32_bf16 v[44:47], v[92:95], v[108:111], v[44:47]
  ds_read_b128 v[144:147], v10 offset:51200
  v_mfma_f32_16x16x32_bf16 v[48:51], v[92:95], v[112:115], v[48:51]
  ds_read_b128 v[132:135], v23 offset:6144
  v_mfma_f32_16x16x32_bf16 v[52:55], v[92:95], v[116:119], v[52:55]
  ds_read_b128 v[148:151], v10 offset:52224
  v_mfma_f32_16x16x32_bf16 v[56:59], v[96:99], v[104:107], v[56:59]
  v_mfma_f32_16x16x32_bf16 v[60:63], v[96:99], v[108:111], v[60:63]
  v_mfma_f32_16x16x32_bf16 v[64:67], v[96:99], v[112:115], v[64:67]
  v_mfma_f32_16x16x32_bf16 v[68:71], v[96:99], v[116:119], v[68:71]
  v_mfma_f32_16x16x32_bf16 v[72:75], v[100:103], v[104:107], v[72:75]
  v_mfma_f32_16x16x32_bf16 v[76:79], v[100:103], v[108:111], v[76:79]
  v_mfma_f32_16x16x32_bf16 v[80:83], v[100:103], v[112:115], v[80:83]
  v_mfma_f32_16x16x32_bf16 v[84:87], v[100:103], v[116:119], v[84:87]
  v_mfma_f32_16x16x32_bf16 v[152:155], v[168:171], v[104:107], v[152:155]
  v_mfma_f32_16x16x32_bf16 v[156:159], v[168:171], v[108:111], v[156:159]
  v_mfma_f32_16x16x32_bf16 v[160:163], v[168:171], v[112:115], v[160:163]
  v_mfma_f32_16x16x32_bf16 v[164:167], v[168:171], v[116:119], v[164:167]
  s_waitcnt lgkmcnt(0)
  v_mfma_f32_16x16x32_bf16 v[24:27], v[120:123], v[136:139], v[24:27]
  v_mfma_f32_16x16x32_bf16 v[28:31], v[120:123], v[140:143], v[28:31]
  s_barrier
  v_mfma_f32_16x16x32_bf16 v[32:35], v[120:123], v[144:147], v[32:35]
  ds_read_b128 v[88:91], v8 offset:0
  v_mfma_f32_16x16x32_bf16 v[36:39], v[120:123], v[148:151], v[36:39]
  ds_read_b128 v[104:107], v10 offset:4096
  v_mfma_f32_16x16x32_bf16 v[40:43], v[124:127], v[136:139], v[40:43]
  ds_read_b128 v[92:95], v8 offset:2048
  v_mfma_f32_16x16x32_bf16 v[44:47], v[124:127], v[140:143], v[44:47]
  ds_read_b128 v[108:111], v10 offset:5120
  v_mfma_f32_16x16x32_bf16 v[48:51], v[124:127], v[144:147], v[48:51]
  ds_read_b128 v[96:99], v8 offset:4096
  v_mfma_f32_16x16x32_bf16 v[52:55], v[124:127], v[148:151], v[52:55]
  ds_read_b128 v[112:115], v10 offset:6144
  v_mfma_f32_16x16x32_bf16 v[56:59], v[128:131], v[136:139], v[56:59]
  ds_read_b128 v[100:103], v8 offset:6144
  v_mfma_f32_16x16x32_bf16 v[60:63], v[128:131], v[140:143], v[60:63]
  ds_read_b128 v[116:119], v10 offset:7168
  v_mfma_f32_16x16x32_bf16 v[64:67], v[128:131], v[144:147], v[64:67]
  v_mfma_f32_16x16x32_bf16 v[68:71], v[128:131], v[148:151], v[68:71]
  v_mfma_f32_16x16x32_bf16 v[72:75], v[132:135], v[136:139], v[72:75]
  v_mfma_f32_16x16x32_bf16 v[76:79], v[132:135], v[140:143], v[76:79]
  v_mfma_f32_16x16x32_bf16 v[80:83], v[132:135], v[144:147], v[80:83]
  v_mfma_f32_16x16x32_bf16 v[84:87], v[132:135], v[148:151], v[84:87]
  v_mfma_f32_16x16x32_bf16 v[152:155], v[168:171], v[136:139], v[152:155]
  v_mfma_f32_16x16x32_bf16 v[156:159], v[168:171], v[140:143], v[156:159]
  v_mfma_f32_16x16x32_bf16 v[160:163], v[168:171], v[144:147], v[160:163]
  v_mfma_f32_16x16x32_bf16 v[164:167], v[168:171], v[148:151], v[164:167]
  s_waitcnt lgkmcnt(0)
  v_mfma_f32_16x16x32_bf16 v[24:27], v[88:91], v[104:107], v[24:27]
  ds_read_b128 v[120:123], v9 offset:0
  v_mfma_f32_16x16x32_bf16 v[28:31], v[88:91], v[108:111], v[28:31]
  ds_read_b128 v[136:139], v10 offset:8192
  v_mfma_f32_16x16x32_bf16 v[32:35], v[88:91], v[112:115], v[32:35]
  ds_read_b128 v[124:127], v9 offset:2048
  v_mfma_f32_16x16x32_bf16 v[36:39], v[88:91], v[116:119], v[36:39]
  ds_read_b128 v[140:143], v10 offset:9216
  v_mfma_f32_16x16x32_bf16 v[40:43], v[92:95], v[104:107], v[40:43]
  ds_read_b128 v[128:131], v9 offset:4096
  v_mfma_f32_16x16x32_bf16 v[44:47], v[92:95], v[108:111], v[44:47]
  ds_read_b128 v[144:147], v10 offset:10240
  v_mfma_f32_16x16x32_bf16 v[48:51], v[92:95], v[112:115], v[48:51]
  ds_read_b128 v[132:135], v9 offset:6144
  v_mfma_f32_16x16x32_bf16 v[52:55], v[92:95], v[116:119], v[52:55]
  ds_read_b128 v[148:151], v10 offset:11264
  v_mfma_f32_16x16x32_bf16 v[56:59], v[96:99], v[104:107], v[56:59]
  v_mfma_f32_16x16x32_bf16 v[60:63], v[96:99], v[108:111], v[60:63]
  v_mfma_f32_16x16x32_bf16 v[64:67], v[96:99], v[112:115], v[64:67]
  v_mfma_f32_16x16x32_bf16 v[68:71], v[96:99], v[116:119], v[68:71]
  v_mfma_f32_16x16x32_bf16 v[72:75], v[100:103], v[104:107], v[72:75]
  v_mfma_f32_16x16x32_bf16 v[76:79], v[100:103], v[108:111], v[76:79]
  v_mfma_f32_16x16x32_bf16 v[80:83], v[100:103], v[112:115], v[80:83]
  v_mfma_f32_16x16x32_bf16 v[84:87], v[100:103], v[116:119], v[84:87]
  v_mfma_f32_16x16x32_bf16 v[152:155], v[168:171], v[104:107], v[152:155]
  v_mfma_f32_16x16x32_bf16 v[156:159], v[168:171], v[108:111], v[156:159]
  v_mfma_f32_16x16x32_bf16 v[160:163], v[168:171], v[112:115], v[160:163]
  v_mfma_f32_16x16x32_bf16 v[164:167], v[168:171], v[116:119], v[164:167]
  s_waitcnt lgkmcnt(0)
  v_mfma_f32_16x16x32_bf16 v[24:27], v[120:123], v[136:139], v[24:27]
  v_mfma_f32_16x16x32_bf16 v[28:31], v[120:123], v[140:143], v[28:31]
  s_barrier
  v_mfma_f32_16x16x32_bf16 v[32:35], v[120:123], v[144:147], v[32:35]
  ds_read_b128 v[88:91], v8 offset:32768
  v_mfma_f32_16x16x32_bf16 v[36:39], v[120:123], v[148:151], v[36:39]
  ds_read_b128 v[104:107], v10 offset:12288
  v_mfma_f32_16x16x32_bf16 v[40:43], v[124:127], v[136:139], v[40:43]
  ds_read_b128 v[92:95], v8 offset:34816
  v_mfma_f32_16x16x32_bf16 v[44:47], v[124:127], v[140:143], v[44:47]
  ds_read_b128 v[108:111], v10 offset:13312
  v_mfma_f32_16x16x32_bf16 v[48:51], v[124:127], v[144:147], v[48:51]
  ds_read_b128 v[96:99], v8 offset:36864
  v_mfma_f32_16x16x32_bf16 v[52:55], v[124:127], v[148:151], v[52:55]
  ds_read_b128 v[112:115], v10 offset:14336
  v_mfma_f32_16x16x32_bf16 v[56:59], v[128:131], v[136:139], v[56:59]
  ds_read_b128 v[100:103], v8 offset:38912
  v_mfma_f32_16x16x32_bf16 v[60:63], v[128:131], v[140:143], v[60:63]
  ds_read_b128 v[116:119], v10 offset:15360
  v_mfma_f32_16x16x32_bf16 v[64:67], v[128:131], v[144:147], v[64:67]
  v_mfma_f32_16x16x32_bf16 v[68:71], v[128:131], v[148:151], v[68:71]
  v_mfma_f32_16x16x32_bf16 v[72:75], v[132:135], v[136:139], v[72:75]
  v_mfma_f32_16x16x32_bf16 v[76:79], v[132:135], v[140:143], v[76:79]
  v_mfma_f32_16x16x32_bf16 v[80:83], v[132:135], v[144:147], v[80:83]
  v_mfma_f32_16x16x32_bf16 v[84:87], v[132:135], v[148:151], v[84:87]
  v_mfma_f32_16x16x32_bf16 v[152:155], v[168:171], v[136:139], v[152:155]
  v_mfma_f32_16x16x32_bf16 v[156:159], v[168:171], v[140:143], v[156:159]
  v_mfma_f32_16x16x32_bf16 v[160:163], v[168:171], v[144:147], v[160:163]
  v_mfma_f32_16x16x32_bf16 v[164:167], v[168:171], v[148:151], v[164:167]
  s_waitcnt lgkmcnt(0)
  v_mfma_f32_16x16x32_bf16 v[24:27], v[88:91], v[104:107], v[24:27]
  ds_read_b128 v[120:123], v9 offset:32768
  v_mfma_f32_16x16x32_bf16 v[28:31], v[88:91], v[108:111], v[28:31]
  ds_read_b128 v[136:139], v10 offset:16384
  v_mfma_f32_16x16x32_bf16 v[32:35], v[88:91], v[112:115], v[32:35]
  ds_read_b128 v[124:127], v9 offset:34816
  v_mfma_f32_16x16x32_bf16 v[36:39], v[88:91], v[116:119], v[36:39]
  ds_read_b128 v[140:143], v10 offset:17408
  v_mfma_f32_16x16x32_bf16 v[40:43], v[92:95], v[104:107], v[40:43]
  ds_read_b128 v[128:131], v9 offset:36864
  v_mfma_f32_16x16x32_bf16 v[44:47], v[92:95], v[108:111], v[44:47]
  ds_read_b128 v[144:147], v10 offset:18432
  v_mfma_f32_16x16x32_bf16 v[48:51], v[92:95], v[112:115], v[48:51]
  ds_read_b128 v[132:135], v9 offset:38912
  v_mfma_f32_16x16x32_bf16 v[52:55], v[92:95], v[116:119], v[52:55]
  ds_read_b128 v[148:151], v10 offset:19456
  v_mfma_f32_16x16x32_bf16 v[56:59], v[96:99], v[104:107], v[56:59]
  v_mfma_f32_16x16x32_bf16 v[60:63], v[96:99], v[108:111], v[60:63]
  v_mfma_f32_16x16x32_bf16 v[64:67], v[96:99], v[112:115], v[64:67]
  v_mfma_f32_16x16x32_bf16 v[68:71], v[96:99], v[116:119], v[68:71]
  v_mfma_f32_16x16x32_bf16 v[72:75], v[100:103], v[104:107], v[72:75]
  v_mfma_f32_16x16x32_bf16 v[76:79], v[100:103], v[108:111], v[76:79]
  v_mfma_f32_16x16x32_bf16 v[80:83], v[100:103], v[112:115], v[80:83]
  v_mfma_f32_16x16x32_bf16 v[84:87], v[100:103], v[116:119], v[84:87]
  v_mfma_f32_16x16x32_bf16 v[152:155], v[168:171], v[104:107], v[152:155]
  v_mfma_f32_16x16x32_bf16 v[156:159], v[168:171], v[108:111], v[156:159]
  v_mfma_f32_16x16x32_bf16 v[160:163], v[168:171], v[112:115], v[160:163]
  v_mfma_f32_16x16x32_bf16 v[164:167], v[168:171], v[116:119], v[164:167]
  s_waitcnt lgkmcnt(0)
  v_mfma_f32_16x16x32_bf16 v[24:27], v[120:123], v[136:139], v[24:27]
  v_mfma_f32_16x16x32_bf16 v[28:31], v[120:123], v[140:143], v[28:31]
  s_barrier
  v_mfma_f32_16x16x32_bf16 v[32:35], v[120:123], v[144:147], v[32:35]
  ds_read_b128 v[88:91], v22 offset:0
  v_mfma_f32_16x16x32_bf16 v[36:39], v[120:123], v[148:151], v[36:39]
  ds_read_b128 v[104:107], v10 offset:20480
  v_mfma_f32_16x16x32_bf16 v[40:43], v[124:127], v[136:139], v[40:43]
  ds_read_b128 v[92:95], v22 offset:2048
  v_mfma_f32_16x16x32_bf16 v[44:47], v[124:127], v[140:143], v[44:47]
  ds_read_b128 v[108:111], v10 offset:21504
  v_mfma_f32_16x16x32_bf16 v[48:51], v[124:127], v[144:147], v[48:51]
  ds_read_b128 v[96:99], v22 offset:4096
  v_mfma_f32_16x16x32_bf16 v[52:55], v[124:127], v[148:151], v[52:55]
  ds_read_b128 v[112:115], v10 offset:22528
  v_mfma_f32_16x16x32_bf16 v[56:59], v[128:131], v[136:139], v[56:59]
  ds_read_b128 v[100:103], v22 offset:6144
  v_mfma_f32_16x16x32_bf16 v[60:63], v[128:131], v[140:143], v[60:63]
  ds_read_b128 v[116:119], v10 offset:23552
  v_mfma_f32_16x16x32_bf16 v[64:67], v[128:131], v[144:147], v[64:67]
  v_mfma_f32_16x16x32_bf16 v[68:71], v[128:131], v[148:151], v[68:71]
  v_mfma_f32_16x16x32_bf16 v[72:75], v[132:135], v[136:139], v[72:75]
  v_mfma_f32_16x16x32_bf16 v[76:79], v[132:135], v[140:143], v[76:79]
  v_mfma_f32_16x16x32_bf16 v[80:83], v[132:135], v[144:147], v[80:83]
  v_mfma_f32_16x16x32_bf16 v[84:87], v[132:135], v[148:151], v[84:87]
  v_mfma_f32_16x16x32_bf16 v[152:155], v[168:171], v[136:139], v[152:155]
  v_mfma_f32_16x16x32_bf16 v[156:159], v[168:171], v[140:143], v[156:159]
  v_mfma_f32_16x16x32_bf16 v[160:163], v[168:171], v[144:147], v[160:163]
  v_mfma_f32_16x16x32_bf16 v[164:167], v[168:171], v[148:151], v[164:167]
  s_waitcnt lgkmcnt(0)
  v_mfma_f32_16x16x32_bf16 v[24:27], v[88:91], v[104:107], v[24:27]
  ds_read_b128 v[120:123], v23 offset:0
  v_mfma_f32_16x16x32_bf16 v[28:31], v[88:91], v[108:111], v[28:31]
  ds_read_b128 v[136:139], v10 offset:24576
  v_mfma_f32_16x16x32_bf16 v[32:35], v[88:91], v[112:115], v[32:35]
  ds_read_b128 v[124:127], v23 offset:2048
  v_mfma_f32_16x16x32_bf16 v[36:39], v[88:91], v[116:119], v[36:39]
  ds_read_b128 v[140:143], v10 offset:25600
  v_mfma_f32_16x16x32_bf16 v[40:43], v[92:95], v[104:107], v[40:43]
  ds_read_b128 v[128:131], v23 offset:4096
  v_mfma_f32_16x16x32_bf16 v[44:47], v[92:95], v[108:111], v[44:47]
  ds_read_b128 v[144:147], v10 offset:26624
  v_mfma_f32_16x16x32_bf16 v[48:51], v[92:95], v[112:115], v[48:51]
  ds_read_b128 v[132:135], v23 offset:6144
  v_mfma_f32_16x16x32_bf16 v[52:55], v[92:95], v[116:119], v[52:55]
  ds_read_b128 v[148:151], v10 offset:27648
  v_mfma_f32_16x16x32_bf16 v[56:59], v[96:99], v[104:107], v[56:59]
  v_mfma_f32_16x16x32_bf16 v[60:63], v[96:99], v[108:111], v[60:63]
  v_mfma_f32_16x16x32_bf16 v[64:67], v[96:99], v[112:115], v[64:67]
  v_mfma_f32_16x16x32_bf16 v[68:71], v[96:99], v[116:119], v[68:71]
  v_mfma_f32_16x16x32_bf16 v[72:75], v[100:103], v[104:107], v[72:75]
  v_mfma_f32_16x16x32_bf16 v[76:79], v[100:103], v[108:111], v[76:79]
  v_mfma_f32_16x16x32_bf16 v[80:83], v[100:103], v[112:115], v[80:83]
  v_mfma_f32_16x16x32_bf16 v[84:87], v[100:103], v[116:119], v[84:87]
  v_mfma_f32_16x16x32_bf16 v[152:155], v[168:171], v[104:107], v[152:155]
  v_mfma_f32_16x16x32_bf16 v[156:159], v[168:171], v[108:111], v[156:159]
  v_mfma_f32_16x16x32_bf16 v[160:163], v[168:171], v[112:115], v[160:163]
  v_mfma_f32_16x16x32_bf16 v[164:167], v[168:171], v[116:119], v[164:167]
  s_waitcnt lgkmcnt(0)
  v_mfma_f32_16x16x32_bf16 v[24:27], v[120:123], v[136:139], v[24:27]
  v_mfma_f32_16x16x32_bf16 v[28:31], v[120:123], v[140:143], v[28:31]
  s_barrier
  v_mfma_f32_16x16x32_bf16 v[32:35], v[120:123], v[144:147], v[32:35]
  ds_read_b128 v[88:91], v8 offset:0
  v_mfma_f32_16x16x32_bf16 v[36:39], v[120:123], v[148:151], v[36:39]
  ds_read_b128 v[104:107], v10 offset:28672
  v_mfma_f32_16x16x32_bf16 v[40:43], v[124:127], v[136:139], v[40:43]
  ds_read_b128 v[92:95], v8 offset:2048
  v_mfma_f32_16x16x32_bf16 v[44:47], v[124:127], v[140:143], v[44:47]
  ds_read_b128 v[108:111], v10 offset:29696
  v_mfma_f32_16x16x32_bf16 v[48:51], v[124:127], v[144:147], v[48:51]
  ds_read_b128 v[96:99], v8 offset:4096
  v_mfma_f32_16x16x32_bf16 v[52:55], v[124:127], v[148:151], v[52:55]
  ds_read_b128 v[112:115], v10 offset:30720
  v_mfma_f32_16x16x32_bf16 v[56:59], v[128:131], v[136:139], v[56:59]
  ds_read_b128 v[100:103], v8 offset:6144
  v_mfma_f32_16x16x32_bf16 v[60:63], v[128:131], v[140:143], v[60:63]
  ds_read_b128 v[116:119], v10 offset:31744
  v_mfma_f32_16x16x32_bf16 v[64:67], v[128:131], v[144:147], v[64:67]
  v_mfma_f32_16x16x32_bf16 v[68:71], v[128:131], v[148:151], v[68:71]
  v_mfma_f32_16x16x32_bf16 v[72:75], v[132:135], v[136:139], v[72:75]
  v_mfma_f32_16x16x32_bf16 v[76:79], v[132:135], v[140:143], v[76:79]
  v_mfma_f32_16x16x32_bf16 v[80:83], v[132:135], v[144:147], v[80:83]
  v_mfma_f32_16x16x32_bf16 v[84:87], v[132:135], v[148:151], v[84:87]
  v_mfma_f32_16x16x32_bf16 v[152:155], v[168:171], v[136:139], v[152:155]
  v_mfma_f32_16x16x32_bf16 v[156:159], v[168:171], v[140:143], v[156:159]
  v_mfma_f32_16x16x32_bf16 v[160:163], v[168:171], v[144:147], v[160:163]
  v_mfma_f32_16x16x32_bf16 v[164:167], v[168:171], v[148:151], v[164:167]
  s_waitcnt lgkmcnt(0)
  v_mfma_f32_16x16x32_bf16 v[24:27], v[88:91], v[104:107], v[24:27]
  ds_read_b128 v[120:123], v9 offset:0
  v_mfma_f32_16x16x32_bf16 v[28:31], v[88:91], v[108:111], v[28:31]
  ds_read_b128 v[136:139], v10 offset:32768
  v_mfma_f32_16x16x32_bf16 v[32:35], v[88:91], v[112:115], v[32:35]
  ds_read_b128 v[124:127], v9 offset:2048
  v_mfma_f32_16x16x32_bf16 v[36:39], v[88:91], v[116:119], v[36:39]
  ds_read_b128 v[140:143], v10 offset:33792
  v_mfma_f32_16x16x32_bf16 v[40:43], v[92:95], v[104:107], v[40:43]
  ds_read_b128 v[128:131], v9 offset:4096
  v_mfma_f32_16x16x32_bf16 v[44:47], v[92:95], v[108:111], v[44:47]
  ds_read_b128 v[144:147], v10 offset:34816
  v_mfma_f32_16x16x32_bf16 v[48:51], v[92:95], v[112:115], v[48:51]
  ds_read_b128 v[132:135], v9 offset:6144
  v_mfma_f32_16x16x32_bf16 v[52:55], v[92:95], v[116:119], v[52:55]
  ds_read_b128 v[148:151], v10 offset:35840
  v_mfma_f32_16x16x32_bf16 v[56:59], v[96:99], v[104:107], v[56:59]
  v_mfma_f32_16x16x32_bf16 v[60:63], v[96:99], v[108:111], v[60:63]
  v_mfma_f32_16x16x32_bf16 v[64:67], v[96:99], v[112:115], v[64:67]
  v_mfma_f32_16x16x32_bf16 v[68:71], v[96:99], v[116:119], v[68:71]
  v_mfma_f32_16x16x32_bf16 v[72:75], v[100:103], v[104:107], v[72:75]
  v_mfma_f32_16x16x32_bf16 v[76:79], v[100:103], v[108:111], v[76:79]
  v_mfma_f32_16x16x32_bf16 v[80:83], v[100:103], v[112:115], v[80:83]
  v_mfma_f32_16x16x32_bf16 v[84:87], v[100:103], v[116:119], v[84:87]
  v_mfma_f32_16x16x32_bf16 v[152:155], v[168:171], v[104:107], v[152:155]
  v_mfma_f32_16x16x32_bf16 v[156:159], v[168:171], v[108:111], v[156:159]
  v_mfma_f32_16x16x32_bf16 v[160:163], v[168:171], v[112:115], v[160:163]
  v_mfma_f32_16x16x32_bf16 v[164:167], v[168:171], v[116:119], v[164:167]
  s_waitcnt lgkmcnt(0)
  v_mfma_f32_16x16x32_bf16 v[24:27], v[120:123], v[136:139], v[24:27]
  v_mfma_f32_16x16x32_bf16 v[28:31], v[120:123], v[140:143], v[28:31]
  v_mfma_f32_16x16x32_bf16 v[32:35], v[120:123], v[144:147], v[32:35]
  v_mfma_f32_16x16x32_bf16 v[36:39], v[120:123], v[148:151], v[36:39]
  v_mfma_f32_16x16x32_bf16 v[40:43], v[124:127], v[136:139], v[40:43]
  v_mfma_f32_16x16x32_bf16 v[44:47], v[124:127], v[140:143], v[44:47]
  v_mfma_f32_16x16x32_bf16 v[48:51], v[124:127], v[144:147], v[48:51]
  v_mfma_f32_16x16x32_bf16 v[52:55], v[124:127], v[148:151], v[52:55]
  v_mfma_f32_16x16x32_bf16 v[56:59], v[128:131], v[136:139], v[56:59]
  v_mfma_f32_16x16x32_bf16 v[60:63], v[128:131], v[140:143], v[60:63]
  v_mfma_f32_16x16x32_bf16 v[64:67], v[128:131], v[144:147], v[64:67]
  v_mfma_f32_16x16x32_bf16 v[68:71], v[128:131], v[148:151], v[68:71]
  v_mfma_f32_16x16x32_bf16 v[72:75], v[132:135], v[136:139], v[72:75]
  v_mfma_f32_16x16x32_bf16 v[76:79], v[132:135], v[140:143], v[76:79]
  v_mfma_f32_16x16x32_bf16 v[80:83], v[132:135], v[144:147], v[80:83]
  v_mfma_f32_16x16x32_bf16 v[84:87], v[132:135], v[148:151], v[84:87]
  v_mfma_f32_16x16x32_bf16 v[152:155], v[168:171], v[136:139], v[152:155]
  v_mfma_f32_16x16x32_bf16 v[156:159], v[168:171], v[140:143], v[156:159]
  v_mfma_f32_16x16x32_bf16 v[160:163], v[168:171], v[144:147], v[160:163]
  v_mfma_f32_16x16x32_bf16 v[164:167], v[168:171], v[148:151], v[164:167]
  s_barrier
  s_nop 7
  s_lshl_b32 s37, s33, 8
  v_lshl_add_u32 v4, v3, 4, s37

  ds_read_b128 v[88:91], v4 offset:0
  ds_read_b128 v[104:107], v4 offset:1024
  ds_read_b128 v[92:95], v4 offset:64
  ds_read_b128 v[108:111], v4 offset:1088
  ds_read_b128 v[96:99], v4 offset:128
  ds_read_b128 v[112:115], v4 offset:1152
  ds_read_b128 v[100:103], v4 offset:192
  ds_read_b128 v[116:119], v4 offset:1216
  s_mul_i32 s37, s33, 2560
  v_and_b32 v5, 7, v2
  v_xor_b32 v5, v5, v3
  v_lshlrev_b32 v5, 3, v5
  v_lshl_add_u32 v5, v2, 6, v5
  s_add_u32 s38, s37, 126976
  v_add_u32 v8, s38, v5
  v_xor_b32 v16, 32, v8
  s_add_u32 s38, s37, 96256
  v_add_u32 v9, s38, v5
  v_xor_b32 v17, 32, v9
  v_and_b32 v6, 1, v3
  v_mul_u32_u24 v6, 320, v6
  v_lshrrev_b32 v7, 1, v3
  v_lshl_add_u32 v6, v7, 3, v6
  v_lshl_add_u32 v7, v2, 4, v6
  s_add_u32 s38, s37, 116736
  v_add_u32 v10, s38, v7
  v_and_b32 v5, 3, v2
  v_add_u32 v7, 16, v5
  v_lshl_add_u32 v12, v7, 4, v6
  v_add_u32 v12, s38, v12
  v_xor_b32 v5, v5, v3
  v_lshlrev_b32 v5, 3, v5
  v_lshl_add_u32 v11, v7, 6, v5
  v_mov_b32 v5, 126976
  v_mov_b32 v6, 96256
  v_cmp_gt_u32 vcc, 4, v2
  s_nop 1
  v_cndmask_b32 v5, v6, v5, vcc
  v_add_u32 v11, v11, v5
  v_add_u32 v11, s37, v11
  v_xor_b32 v18, 32, v11
  v_mov_b32 v14, 1.0
  v_mov_b32 v15, 0x3ea52b5c
  v_cndmask_b32 v14, v14, v15, vcc
  s_mov_b32 s60, 0x3ea52b5c
  s_mov_b32 s61, 0x3ea52b5c
  s_mov_b32 s56, 0x00ff00ff
  s_mov_b32 s57, 0x00ff00ff
  s_mov_b32 s58, 0x0f000f00
  s_mov_b32 s59, 0x0f000f00
  s_waitcnt vmcnt(0) lgkmcnt(0)

  v_pk_mul_f32 v[88:89], v[88:89], v[104:105]
  v_pk_mul_f32 v[90:91], v[90:91], v[106:107]
  v_pk_mul_f32 v[92:93], v[92:93], v[108:109]
  v_pk_mul_f32 v[94:95], v[94:95], v[110:111]
  v_pk_mul_f32 v[96:97], v[96:97], v[112:113]
  v_pk_mul_f32 v[98:99], v[98:99], v[114:115]
  v_pk_mul_f32 v[100:101], v[100:101], v[116:117]
  v_pk_mul_f32 v[102:103], v[102:103], v[118:119]
  v_pk_mul_f32 v[180:181], v[88:89], v[152:153] op_sel_hi:[1,0]
  v_pk_mul_f32 v[182:183], v[90:91], v[152:153] op_sel_hi:[1,0]
  v_pk_mul_f32 v[184:185], v[88:89], v[156:157] op_sel_hi:[1,0]
  v_pk_mul_f32 v[186:187], v[90:91], v[156:157] op_sel_hi:[1,0]
  v_pk_fma_f32 v[24:25], v[104:105], v[24:25], v[180:181] neg_lo:[0,0,1] neg_hi:[0,0,1]
  v_pk_fma_f32 v[26:27], v[106:107], v[26:27], v[182:183] neg_lo:[0,0,1] neg_hi:[0,0,1]
  v_pk_mul_f32 v[180:181], v[88:89], v[160:161] op_sel_hi:[1,0]
  v_pk_mul_f32 v[182:183], v[90:91], v[160:161] op_sel_hi:[1,0]
  v_pk_fma_f32 v[28:29], v[104:105], v[28:29], v[184:185] neg_lo:[0,0,1] neg_hi:[0,0,1]
  v_pk_fma_f32 v[30:31], v[106:107], v[30:31], v[186:187] neg_lo:[0,0,1] neg_hi:[0,0,1]
  v_pk_mul_f32 v[24:25], v[24:25], s[60:61]
  v_pk_mul_f32 v[26:27], v[26:27], s[60:61]
  v_pk_mul_f32 v[184:185], v[88:89], v[164:165] op_sel_hi:[1,0]
  v_pk_mul_f32 v[186:187], v[90:91], v[164:165] op_sel_hi:[1,0]
  v_pk_fma_f32 v[32:33], v[104:105], v[32:33], v[180:181] neg_lo:[0,0,1] neg_hi:[0,0,1]
  v_pk_fma_f32 v[34:35], v[106:107], v[34:35], v[182:183] neg_lo:[0,0,1] neg_hi:[0,0,1]
  v_cvt_pk_bf16_f32 v120, v24, v25
  v_cvt_pk_bf16_f32 v121, v26, v27
  v_pk_mul_f32 v[180:181], v[92:93], v[152:153] op_sel_hi:[1,0]
  v_pk_mul_f32 v[182:183], v[94:95], v[152:153] op_sel_hi:[1,0]
  v_pk_fma_f32 v[36:37], v[104:105], v[36:37], v[184:185] neg_lo:[0,0,1] neg_hi:[0,0,1]
  v_pk_fma_f32 v[38:39], v[106:107], v[38:39], v[186:187] neg_lo:[0,0,1] neg_hi:[0,0,1]
  v_cvt_pk_bf16_f32 v122, v28, v29
  v_cvt_pk_bf16_f32 v123, v30, v31
  ds_write_b64 v8, v[120:121] offset:0
  v_pk_mul_f32 v[184:185], v[92:93], v[156:157] op_sel_hi:[1,0]
  v_pk_mul_f32 v[186:187], v[94:95], v[156:157] op_sel_hi:[1,0]
  v_pk_fma_f32 v[40:41], v[108:109], v[40:41], v[180:181] neg_lo:[0,0,1] neg_hi:[0,0,1]
  v_pk_fma_f32 v[42:43], v[110:111], v[42:43], v[182:183] neg_lo:[0,0,1] neg_hi:[0,0,1]
  v_pk_mul_f32 v[36:37], v[36:37], v[14:15] op_sel_hi:[1,0]
  v_pk_mul_f32 v[38:39], v[38:39], v[14:15] op_sel_hi:[1,0]
  v_cvt_pk_bf16_f32 v124, v32, v33
  v_cvt_pk_bf16_f32 v125, v34, v35
  ds_write_b64 v9, v[122:123] offset:0
  v_pk_mul_f32 v[180:181], v[92:93], v[160:161] op_sel_hi:[1,0]
  v_pk_mul_f32 v[182:183], v[94:95], v[160:161] op_sel_hi:[1,0]
  v_pk_fma_f32 v[44:45], v[108:109], v[44:45], v[184:185] neg_lo:[0,0,1] neg_hi:[0,0,1]
  v_pk_fma_f32 v[46:47], v[110:111], v[46:47], v[186:187] neg_lo:[0,0,1] neg_hi:[0,0,1]
  v_pk_mul_f32 v[40:41], v[40:41], s[60:61]
  v_pk_mul_f32 v[42:43], v[42:43], s[60:61]
  v_cvt_pk_bf16_f32 v126, v36, v37
  v_cvt_pk_bf16_f32 v127, v38, v39
  ds_write_b64 v10, v[124:125] offset:0
  v_pk_mul_f32 v[184:185], v[92:93], v[164:165] op_sel_hi:[1,0]
  v_pk_mul_f32 v[186:187], v[94:95], v[164:165] op_sel_hi:[1,0]
  v_pk_fma_f32 v[48:49], v[108:109], v[48:49], v[180:181] neg_lo:[0,0,1] neg_hi:[0,0,1]
  v_pk_fma_f32 v[50:51], v[110:111], v[50:51], v[182:183] neg_lo:[0,0,1] neg_hi:[0,0,1]
  v_cvt_pk_bf16_f32 v128, v40, v41
  v_cvt_pk_bf16_f32 v129, v42, v43
  s_mov_b64 exec, s[56:57]
  ds_write_b64 v11, v[126:127] offset:0
  s_mov_b64 exec, s[58:59]
  ds_write_b64 v12, v[126:127] offset:0
  s_mov_b64 exec, -1
  v_pk_mul_f32 v[180:181], v[96:97], v[152:153] op_sel_hi:[1,0]
  v_pk_mul_f32 v[182:183], v[98:99], v[152:153] op_sel_hi:[1,0]
  v_pk_fma_f32 v[52:53], v[108:109], v[52:53], v[184:185] neg_lo:[0,0,1] neg_hi:[0,0,1]
  v_pk_fma_f32 v[54:55], v[110:111], v[54:55], v[186:187] neg_lo:[0,0,1] neg_hi:[0,0,1]
  v_cvt_pk_bf16_f32 v130, v44, v45
  v_cvt_pk_bf16_f32 v131, v46, v47
  ds_write_b64 v16, v[128:129] offset:0
  v_pk_mul_f32 v[184:185], v[96:97], v[156:157] op_sel_hi:[1,0]
  v_pk_mul_f32 v[186:187], v[98:99], v[156:157] op_sel_hi:[1,0]
  v_pk_fma_f32 v[56:57], v[112:113], v[56:57], v[180:181] neg_lo:[0,0,1] neg_hi:[0,0,1]
  v_pk_fma_f32 v[58:59], v[114:115], v[58:59], v[182:183] neg_lo:[0,0,1] neg_hi:[0,0,1]
  v_pk_mul_f32 v[52:53], v[52:53], v[14:15] op_sel_hi:[1,0]
  v_pk_mul_f32 v[54:55], v[54:55], v[14:15] op_sel_hi:[1,0]
  v_cvt_pk_bf16_f32 v132, v48, v49
  v_cvt_pk_bf16_f32 v133, v50, v51
  ds_write_b64 v17, v[130:131] offset:0
  v_pk_mul_f32 v[180:181], v[96:97], v[160:161] op_sel_hi:[1,0]
  v_pk_mul_f32 v[182:183], v[98:99], v[160:161] op_sel_hi:[1,0]
  v_pk_fma_f32 v[60:61], v[112:113], v[60:61], v[184:185] neg_lo:[0,0,1] neg_hi:[0,0,1]
  v_pk_fma_f32 v[62:63], v[114:115], v[62:63], v[186:187] neg_lo:[0,0,1] neg_hi:[0,0,1]
  v_pk_mul_f32 v[56:57], v[56:57], s[60:61]
  v_pk_mul_f32 v[58:59], v[58:59], s[60:61]
  v_cvt_pk_bf16_f32 v134, v52, v53
  v_cvt_pk_bf16_f32 v135, v54, v55
  ds_write_b64 v10, v[132:133] offset:640
  v_pk_mul_f32 v[184:185], v[96:97], v[164:165] op_sel_hi:[1,0]
  v_pk_mul_f32 v[186:187], v[98:99], v[164:165] op_sel_hi:[1,0]
  v_pk_fma_f32 v[64:65], v[112:113], v[64:65], v[180:181] neg_lo:[0,0,1] neg_hi:[0,0,1]
  v_pk_fma_f32 v[66:67], v[114:115], v[66:67], v[182:183] neg_lo:[0,0,1] neg_hi:[0,0,1]
  v_cvt_pk_bf16_f32 v120, v56, v57
  v_cvt_pk_bf16_f32 v121, v58, v59
  s_mov_b64 exec, s[56:57]
  ds_write_b64 v18, v[134:135] offset:0
  s_mov_b64 exec, s[58:59]
  ds_write_b64 v12, v[134:135] offset:640
  s_mov_b64 exec, -1
  v_pk_mul_f32 v[180:181], v[100:101], v[152:153] op_sel_hi:[1,0]
  v_pk_mul_f32 v[182:183], v[102:103], v[152:153] op_sel_hi:[1,0]
  v_pk_fma_f32 v[68:69], v[112:113], v[68:69], v[184:185] neg_lo:[0,0,1] neg_hi:[0,0,1]
  v_pk_fma_f32 v[70:71], v[114:115], v[70:71], v[186:187] neg_lo:[0,0,1] neg_hi:[0,0,1]
  v_cvt_pk_bf16_f32 v122, v60, v61
  v_cvt_pk_bf16_f32 v123, v62, v63
  ds_write_b64 v8, v[120:121] offset:1280
  v_pk_mul_f32 v[184:185], v[100:101], v[156:157] op_sel_hi:[1,0]
  v_pk_mul_f32 v[186:187], v[102:103], v[156:157] op_sel_hi:[1,0]
  v_pk_fma_f32 v[72:73], v[116:117], v[72:73], v[180:181] neg_lo:[0,0,1] neg_hi:[0,0,1]
  v_pk_fma_f32 v[74:75], v[118:119], v[74:75], v[182:183] neg_lo:[0,0,1] neg_hi:[0,0,1]
  v_pk_mul_f32 v[68:69], v[68:69], v[14:15] op_sel_hi:[1,0]
  v_pk_mul_f32 v[70:71], v[70:71], v[14:15] op_sel_hi:[1,0]
  v_cvt_pk_bf16_f32 v124, v64, v65
  v_cvt_pk_bf16_f32 v125, v66, v67
  ds_write_b64 v9, v[122:123] offset:1280
  v_pk_mul_f32 v[180:181], v[100:101], v[160:161] op_sel_hi:[1,0]
  v_pk_mul_f32 v[182:183], v[102:103], v[160:161] op_sel_hi:[1,0]
  v_pk_fma_f32 v[76:77], v[116:117], v[76:77], v[184:185] neg_lo:[0,0,1] neg_hi:[0,0,1]
  v_pk_fma_f32 v[78:79], v[118:119], v[78:79], v[186:187] neg_lo:[0,0,1] neg_hi:[0,0,1]
  v_pk_mul_f32 v[72:73], v[72:73], s[60:61]
  v_pk_mul_f32 v[74:75], v[74:75], s[60:61]
  v_cvt_pk_bf16_f32 v126, v68, v69
  v_cvt_pk_bf16_f32 v127, v70, v71
  ds_write_b64 v10, v[124:125] offset:1280
  v_pk_mul_f32 v[184:185], v[100:101], v[164:165] op_sel_hi:[1,0]
  v_pk_mul_f32 v[186:187], v[102:103], v[164:165] op_sel_hi:[1,0]
  v_pk_fma_f32 v[80:81], v[116:117], v[80:81], v[180:181] neg_lo:[0,0,1] neg_hi:[0,0,1]
  v_pk_fma_f32 v[82:83], v[118:119], v[82:83], v[182:183] neg_lo:[0,0,1] neg_hi:[0,0,1]
  v_cvt_pk_bf16_f32 v128, v72, v73
  v_cvt_pk_bf16_f32 v129, v74, v75
  s_mov_b64 exec, s[56:57]
  ds_write_b64 v11, v[126:127] offset:1280
  s_mov_b64 exec, s[58:59]
  ds_write_b64 v12, v[126:127] offset:1280
  s_mov_b64 exec, -1
  v_pk_fma_f32 v[84:85], v[116:117], v[84:85], v[184:185] neg_lo:[0,0,1] neg_hi:[0,0,1]
  v_pk_fma_f32 v[86:87], v[118:119], v[86:87], v[186:187] neg_lo:[0,0,1] neg_hi:[0,0,1]
  v_cvt_pk_bf16_f32 v130, v76, v77
  v_cvt_pk_bf16_f32 v131, v78, v79
  ds_write_b64 v16, v[128:129] offset:1280
  v_pk_mul_f32 v[84:85], v[84:85], v[14:15] op_sel_hi:[1,0]
  v_pk_mul_f32 v[86:87], v[86:87], v[14:15] op_sel_hi:[1,0]
  v_cvt_pk_bf16_f32 v132, v80, v81
  v_cvt_pk_bf16_f32 v133, v82, v83
  ds_write_b64 v17, v[130:131] offset:1280
  v_cvt_pk_bf16_f32 v134, v84, v85
  v_cvt_pk_bf16_f32 v135, v86, v87
  ds_write_b64 v10, v[132:133] offset:1920
  s_mov_b64 exec, s[56:57]
  ds_write_b64 v18, v[134:135] offset:1280
  s_mov_b64 exec, s[58:59]
  ds_write_b64 v12, v[134:135] offset:1920
  s_mov_b64 exec, -1
  s_waitcnt lgkmcnt(0)
  s_branch LC_common
LM_fin:
  s_branch LM_done
LM_loader:
  s_mul_i32 s42, s33, 2048
  s_mul_i32 s40, s49, 81920
  s_add_u32 s40, s40, 7340032
  s_add_u32 s40, s40, s42

  s_lshl_b32 s43, s33, 13
  s_lshl_b32 s35, s48, 2
  s_add_u32 s35, s35, s33
  s_mul_i32 s41, s35, 81920
  s_movk_i32 s44, 128
  s_mov_b32 s47, 40960
  s_mov_b32 s45, 196608

  v_add_u32 v4, 0, v3
  v_and_b32 v4, 7, v4
  v_and_b32 v5, 7, v0
  v_xor_b32 v4, v4, v5
  v_lshrrev_b32 v5, 3, v0
  v_add_u32 v5, 0, v5
  v_mul_u32_u24 v5, 1280, v5
  v_lshl_add_u32 v5, v4, 4, v5
  v_subrev_u32 v12, 0, v5

  v_add_u32 v4, 4, v3
  v_and_b32 v4, 7, v4
  v_and_b32 v5, 7, v0
  v_xor_b32 v4, v4, v5
  v_lshrrev_b32 v5, 3, v0
  v_add_u32 v5, 8, v5
  v_mul_u32_u24 v5, 1280, v5
  v_lshl_add_u32 v5, v4, 4, v5
  v_subrev_u32 v13, 1024, v5

  v_add_u32 v4, 8, v3
  v_and_b32 v4, 7, v4
  v_and_b32 v5, 7, v0
  v_xor_b32 v4, v4, v5
  v_lshrrev_b32 v5, 3, v0
  v_add_u32 v5, 16, v5
  v_mul_u32_u24 v5, 1280, v5
  v_lshl_add_u32 v5, v4, 4, v5
  v_subrev_u32 v14, 2048, v5

  v_add_u32 v4, 12, v3
  v_and_b32 v4, 7, v4
  v_and_b32 v5, 7, v0
  v_xor_b32 v4, v4, v5
  v_lshrrev_b32 v5, 3, v0
  v_add_u32 v5, 24, v5
  v_mul_u32_u24 v5, 1280, v5
  v_lshl_add_u32 v5, v4, 4, v5
  v_subrev_u32 v15, 3072, v5

  s_mul_i32 s39, s44, 0
  s_add_u32 s39, s39, s41
  s_add_u32 m0, s43, 53248
  s_nop 0
  buffer_load_dwordx4 v12, s[24:27], s39 offen sc1 lds
  buffer_load_dwordx4 v13, s[24:27], s39 offen offset:1024 sc1 lds
  buffer_load_dwordx4 v14, s[24:27], s39 offen offset:2048 sc1 lds
  buffer_load_dwordx4 v15, s[24:27], s39 offen offset:3072 sc1 lds
  s_add_u32 m0, s43, 57344
  s_add_u32 s39, s39, s47
  buffer_load_dwordx4 v12, s[24:27], s39 offen sc1 lds
  buffer_load_dwordx4 v13, s[24:27], s39 offen offset:1024 sc1 lds
  buffer_load_dwordx4 v14, s[24:27], s39 offen offset:2048 sc1 lds
  buffer_load_dwordx4 v15, s[24:27], s39 offen offset:3072 sc1 lds
  s_add_u32 m0, s42, 4096
  s_add_u32 s34, s40, 0
  buffer_load_dwordx4 v1, s[16:19], s34 offen sc1 lds
  buffer_load_dwordx4 v1, s[16:19], s34 offen offset:1024 sc1 lds
  s_mul_i32 s39, s44, 1
  s_add_u32 s39, s39, s41
  s_add_u32 m0, s43, 86016
  s_nop 0
  buffer_load_dwordx4 v12, s[24:27], s39 offen sc1 lds
  buffer_load_dwordx4 v13, s[24:27], s39 offen offset:1024 sc1 lds
  buffer_load_dwordx4 v14, s[24:27], s39 offen offset:2048 sc1 lds
  buffer_load_dwordx4 v15, s[24:27], s39 offen offset:3072 sc1 lds
  s_add_u32 m0, s43, 90112
  s_add_u32 s39, s39, s47
  buffer_load_dwordx4 v12, s[24:27], s39 offen sc1 lds
  buffer_load_dwordx4 v13, s[24:27], s39 offen offset:1024 sc1 lds
  buffer_load_dwordx4 v14, s[24:27], s39 offen offset:2048 sc1 lds
  buffer_load_dwordx4 v15, s[24:27], s39 offen offset:3072 sc1 lds
  s_add_u32 m0, s42, 12288
  s_add_u32 s34, s40, 8192
  buffer_load_dwordx4 v1, s[16:19], s34 offen sc1 lds
  buffer_load_dwordx4 v1, s[16:19], s34 offen offset:1024 sc1 lds
  s_waitcnt vmcnt(10)
  s_barrier
  s_mul_i32 s39, s44, 2
  s_add_u32 s39, s39, s41
  s_add_u32 m0, s43, 118784
  s_nop 0
  buffer_load_dwordx4 v12, s[24:27], s39 offen sc1 lds
  buffer_load_dwordx4 v13, s[24:27], s39 offen offset:1024 sc1 lds
  buffer_load_dwordx4 v14, s[24:27], s39 offen offset:2048 sc1 lds
  buffer_load_dwordx4 v15, s[24:27], s39 offen offset:3072 sc1 lds
  s_add_u32 m0, s43, 122880
  s_add_u32 s39, s39, s47
  buffer_load_dwordx4 v12, s[24:27], s39 offen sc1 lds
  buffer_load_dwordx4 v13, s[24:27], s39 offen offset:1024 sc1 lds
  buffer_load_dwordx4 v14, s[24:27], s39 offen offset:2048 sc1 lds
  buffer_load_dwordx4 v15, s[24:27], s39 offen offset:3072 sc1 lds
  s_add_u32 m0, s42, 20480
  s_add_u32 s34, s40, 16384
  buffer_load_dwordx4 v1, s[16:19], s34 offen sc1 lds
  buffer_load_dwordx4 v1, s[16:19], s34 offen offset:1024 sc1 lds
  s_add_u32 m0, s42, 28672
  s_add_u32 s34, s40, 24576
  buffer_load_dwordx4 v1, s[16:19], s34 offen sc1 lds
  buffer_load_dwordx4 v1, s[16:19], s34 offen offset:1024 sc1 lds
  s_add_u32 m0, s42, 36864
  s_add_u32 s34, s40, 32768
  buffer_load_dwordx4 v1, s[16:19], s34 offen sc1 lds
  buffer_load_dwordx4 v1, s[16:19], s34 offen offset:1024 sc1 lds
  s_add_u32 m0, s42, 45056
  s_add_u32 s34, s40, 40960
  buffer_load_dwordx4 v1, s[16:19], s34 offen sc1 lds
  buffer_load_dwordx4 v1, s[16:19], s34 offen offset:1024 sc1 lds
  v_lshlrev_b32 v4, 10, v3
  v_lshl_add_u32 v4, v2, 3, v4
  s_lshl_b32 s35, s48, 14
  s_add_u32 s35, s35, s45
  s_lshl_b32 s36, s33, 12
  s_add_u32 s35, s35, s36

  buffer_load_dwordx2 v[28:29], v4, s[16:19], s35 offen offset:0 sc1
  buffer_load_dwordx2 v[30:31], v4, s[16:19], s35 offen offset:128 sc1
  buffer_load_dwordx2 v[32:33], v4, s[16:19], s35 offen offset:256 sc1
  buffer_load_dwordx2 v[34:35], v4, s[16:19], s35 offen offset:384 sc1
  buffer_load_dwordx2 v[36:37], v4, s[16:19], s35 offen offset:512 sc1
  buffer_load_dwordx2 v[38:39], v4, s[16:19], s35 offen offset:640 sc1
  buffer_load_dwordx2 v[40:41], v4, s[16:19], s35 offen offset:768 sc1
  buffer_load_dwordx2 v[42:43], v4, s[16:19], s35 offen offset:896 sc1
  s_waitcnt vmcnt(24)
  s_barrier
  s_add_u32 m0, s42, 4096
  s_add_u32 s34, s40, 49152
  buffer_load_dwordx4 v1, s[16:19], s34 offen sc1 lds
  buffer_load_dwordx4 v1, s[16:19], s34 offen offset:1024 sc1 lds
  s_mul_i32 s39, s44, 3
  s_add_u32 s39, s39, s41
  s_add_u32 m0, s43, 53248
  s_nop 0
  buffer_load_dwordx4 v12, s[24:27], s39 offen sc1 lds
  buffer_load_dwordx4 v13, s[24:27], s39 offen offset:1024 sc1 lds
  buffer_load_dwordx4 v14, s[24:27], s39 offen offset:2048 sc1 lds
  buffer_load_dwordx4 v15, s[24:27], s39 offen offset:3072 sc1 lds
  s_add_u32 m0, s43, 57344
  s_add_u32 s39, s39, s47
  buffer_load_dwordx4 v12, s[24:27], s39 offen sc1 lds
  buffer_load_dwordx4 v13, s[24:27], s39 offen offset:1024 sc1 lds
  buffer_load_dwordx4 v14, s[24:27], s39 offen offset:2048 sc1 lds
  buffer_load_dwordx4 v15, s[24:27], s39 offen offset:3072 sc1 lds
  s_waitcnt vmcnt(24)
  s_barrier
  s_add_u32 m0, s42, 12288
  s_add_u32 s34, s40, 57344
  buffer_load_dwordx4 v1, s[16:19], s34 offen sc1 lds
  buffer_load_dwordx4 v1, s[16:19], s34 offen offset:1024 sc1 lds
  s_mul_i32 s39, s44, 4
  s_add_u32 s39, s39, s41
  s_add_u32 m0, s43, 86016
  s_nop 0
  buffer_load_dwordx4 v12, s[24:27], s39 offen sc1 lds
  buffer_load_dwordx4 v13, s[24:27], s39 offen offset:1024 sc1 lds
  buffer_load_dwordx4 v14, s[24:27], s39 offen offset:2048 sc1 lds
  buffer_load_dwordx4 v15, s[24:27], s39 offen offset:3072 sc1 lds
  s_add_u32 m0, s43, 90112
  s_add_u32 s39, s39, s47
  buffer_load_dwordx4 v12, s[24:27], s39 offen sc1 lds
  buffer_load_dwordx4 v13, s[24:27], s39 offen offset:1024 sc1 lds
  buffer_load_dwordx4 v14, s[24:27], s39 offen offset:2048 sc1 lds
  buffer_load_dwordx4 v15, s[24:27], s39 offen offset:3072 sc1 lds
  s_waitcnt vmcnt(10)
  s_barrier
  s_add_u32 m0, s42, 20480
  s_add_u32 s34, s40, 65536
  buffer_load_dwordx4 v1, s[16:19], s34 offen sc1 lds
  buffer_load_dwordx4 v1, s[16:19], s34 offen offset:1024 sc1 lds
  s_mul_i32 s39, s44, 5
  s_add_u32 s39, s39, s41
  s_add_u32 m0, s43, 118784
  s_nop 0
  buffer_load_dwordx4 v12, s[24:27], s39 offen sc1 lds
  buffer_load_dwordx4 v13, s[24:27], s39 offen offset:1024 sc1 lds
  buffer_load_dwordx4 v14, s[24:27], s39 offen offset:2048 sc1 lds
  buffer_load_dwordx4 v15, s[24:27], s39 offen offset:3072 sc1 lds
  s_add_u32 m0, s43, 122880
  s_add_u32 s39, s39, s47
  buffer_load_dwordx4 v12, s[24:27], s39 offen sc1 lds
  buffer_load_dwordx4 v13, s[24:27], s39 offen offset:1024 sc1 lds
  buffer_load_dwordx4 v14, s[24:27], s39 offen offset:2048 sc1 lds
  buffer_load_dwordx4 v15, s[24:27], s39 offen offset:3072 sc1 lds
  v_add_f32 v16, v28, v30
  v_add_f32 v17, v29, v31
  v_add_f32 v16, v16, v32
  v_add_f32 v17, v17, v33
  v_add_f32 v16, v16, v34
  v_add_f32 v17, v17, v35
  v_add_f32 v16, v16, v36
  v_add_f32 v17, v17, v37
  v_add_f32 v16, v16, v38
  v_add_f32 v17, v17, v39
  v_add_f32 v16, v16, v40
  v_add_f32 v17, v17, v41
  v_add_f32 v16, v16, v42
  v_add_f32 v17, v17, v43
  s_mov_b32 s61, 0x3acccccd
  s_mov_b32 s62, 0x3727c5ac
  v_mul_f32 v16, s61, v16
  v_mul_f32 v17, s61, v17
  v_fma_f32 v17, -v16, v16, v17
  v_max_f32 v17, 0, v17

  v_cvt_pk_bf16_f32 v4, v16, v16
  v_lshlrev_b32 v16, 16, v4
  v_cvt_pk_bf16_f32 v4, v17, v17
  v_lshlrev_b32 v17, 16, v4
  v_add_f32 v17, s62, v17
  v_cvt_pk_bf16_f32 v4, v17, v17
  v_lshlrev_b32 v17, 16, v4
  v_sqrt_f32 v17, v17
  s_nop 0
  v_cvt_pk_bf16_f32 v4, v17, v17
  v_lshlrev_b32 v17, 16, v4
  v_rcp_f32 v17, v17
  v_lshlrev_b32 v4, 2, v0
  s_lshl_b32 s35, s33, 8
  v_add_u32 v4, s35, v4

  ds_write_b32 v4, v16 offset:0
  ds_write_b32 v4, v17 offset:1024
  s_mov_b64 exec, -1

  s_waitcnt vmcnt(10)
  s_barrier
  s_add_u32 m0, s42, 28672
  s_add_u32 s34, s40, 73728
  buffer_load_dwordx4 v1, s[16:19], s34 offen sc1 lds
  buffer_load_dwordx4 v1, s[16:19], s34 offen offset:1024 sc1 lds
  s_mul_i32 s39, s44, 6
  s_add_u32 s39, s39, s41
  s_add_u32 m0, s43, 53248
  s_nop 0
  buffer_load_dwordx4 v12, s[24:27], s39 offen sc1 lds
  buffer_load_dwordx4 v13, s[24:27], s39 offen offset:1024 sc1 lds
  buffer_load_dwordx4 v14, s[24:27], s39 offen offset:2048 sc1 lds
  buffer_load_dwordx4 v15, s[24:27], s39 offen offset:3072 sc1 lds
  s_add_u32 m0, s43, 57344
  s_add_u32 s39, s39, s47
  buffer_load_dwordx4 v12, s[24:27], s39 offen sc1 lds
  buffer_load_dwordx4 v13, s[24:27], s39 offen offset:1024 sc1 lds
  buffer_load_dwordx4 v14, s[24:27], s39 offen offset:2048 sc1 lds
  buffer_load_dwordx4 v15, s[24:27], s39 offen offset:3072 sc1 lds
  s_waitcnt vmcnt(10)
  s_barrier
  s_mul_i32 s39, s44, 7
  s_add_u32 s39, s39, s41
  s_add_u32 m0, s43, 86016
  s_nop 0
  buffer_load_dwordx4 v12, s[24:27], s39 offen sc1 lds
  buffer_load_dwordx4 v13, s[24:27], s39 offen offset:1024 sc1 lds
  buffer_load_dwordx4 v14, s[24:27], s39 offen offset:2048 sc1 lds
  buffer_load_dwordx4 v15, s[24:27], s39 offen offset:3072 sc1 lds
  s_add_u32 m0, s43, 90112
  s_add_u32 s39, s39, s47
  buffer_load_dwordx4 v12, s[24:27], s39 offen sc1 lds
  buffer_load_dwordx4 v13, s[24:27], s39 offen offset:1024 sc1 lds
  buffer_load_dwordx4 v14, s[24:27], s39 offen offset:2048 sc1 lds
  buffer_load_dwordx4 v15, s[24:27], s39 offen offset:3072 sc1 lds
  s_waitcnt vmcnt(8)
  s_barrier
  s_mul_i32 s39, s44, 8
  s_add_u32 s39, s39, s41
  s_add_u32 m0, s43, 118784
  s_nop 0
  buffer_load_dwordx4 v12, s[24:27], s39 offen sc1 lds
  buffer_load_dwordx4 v13, s[24:27], s39 offen offset:1024 sc1 lds
  buffer_load_dwordx4 v14, s[24:27], s39 offen offset:2048 sc1 lds
  buffer_load_dwordx4 v15, s[24:27], s39 offen offset:3072 sc1 lds
  s_add_u32 m0, s43, 122880
  s_add_u32 s39, s39, s47
  buffer_load_dwordx4 v12, s[24:27], s39 offen sc1 lds
  buffer_load_dwordx4 v13, s[24:27], s39 offen offset:1024 sc1 lds
  buffer_load_dwordx4 v14, s[24:27], s39 offen offset:2048 sc1 lds
  buffer_load_dwordx4 v15, s[24:27], s39 offen offset:3072 sc1 lds
  s_waitcnt vmcnt(8)
  s_barrier
  s_mul_i32 s39, s44, 9
  s_add_u32 s39, s39, s41
  s_add_u32 m0, s43, 53248
  s_nop 0
  buffer_load_dwordx4 v12, s[24:27], s39 offen sc1 lds
  buffer_load_dwordx4 v13, s[24:27], s39 offen offset:1024 sc1 lds
  buffer_load_dwordx4 v14, s[24:27], s39 offen offset:2048 sc1 lds
  buffer_load_dwordx4 v15, s[24:27], s39 offen offset:3072 sc1 lds
  s_add_u32 m0, s43, 57344
  s_add_u32 s39, s39, s47
  buffer_load_dwordx4 v12, s[24:27], s39 offen sc1 lds
  buffer_load_dwordx4 v13, s[24:27], s39 offen offset:1024 sc1 lds
  buffer_load_dwordx4 v14, s[24:27], s39 offen offset:2048 sc1 lds
  buffer_load_dwordx4 v15, s[24:27], s39 offen offset:3072 sc1 lds
  s_waitcnt vmcnt(8)
  s_barrier
  s_waitcnt vmcnt(0)
  s_barrier
  s_waitcnt lgkmcnt(0)
  s_barrier
LL_afterP1:
  s_barrier
  s_sub_u32 s36, 11, s3
  s_cmp_lt_u32 s3, 4
  s_cselect_b32 s50, s3, s36
  s_mul_i32 s38, s50, 1280
  s_add_u32 s37, s38, 86016
  v_lshrrev_b32 v4, 1, v3
  v_bfe_u32 v5, v0, 2, 2
  v_and_b32 v6, 3, v0
  v_and_b32 v7, 1, v3
  v_lshl_add_u32 v7, v7, 2, v6
  v_xor_b32 v7, v7, v5
  v_lshlrev_b32 v7, 3, v7
  v_lshl_add_u32 v6, v4, 3, v5
  v_lshl_add_u32 v8, v6, 6, v7
  v_add_u32 v6, 16, v5
  v_lshl_add_u32 v9, v6, 6, v7
  s_add_u32 s39, s38, 126976
  v_add_u32 v208, s39, v8
  v_add_u32 v209, s39, v9
  v_xor_b32 v210, 32, v208
  v_add_u32 v8, s37, v8
  v_add_u32 v9, s37, v9
  v_xor_b32 v15, 32, v8
  ds_read_b64_tr_b16 v[184:185], v208
  ds_read_b64_tr_b16 v[186:187], v210 offset:256
  ds_read_b64_tr_b16 v[188:189], v209
  v_and_b32 v6, 31, v0
  v_mul_u32_u24 v7, 320, v4
  v_lshl_add_u32 v10, v6, 4, v7
  s_add_u32 s37, s37, 20480
  v_add_u32 v10, s37, v10
  v_lshlrev_b32 v7, 2, v4
  v_sub_u32 v11, v6, v7
  v_mov_b32 v12, 0xf149f2ca
  v_mov_b32 v13, 0
  s_sub_u32 s62, 8, s50
  s_sub_u32 s63, 7, s50
  v_mov_b32 v7, 0x3f803f80
  v_cmp_eq_u32 vcc, 20, v6
  s_nop 1
  v_cndmask_b32 v7, 0, v7, vcc
  s_mov_b32 s56, 0xfffff
  s_mov_b32 s57, 0xfffff

  ds_read_b64_tr_b16 v[160:161], v8 offset:10240
  ds_read_b64_tr_b16 v[162:163], v15 offset:10496
  ds_read_b64_tr_b16 v[164:165], v9 offset:10240
  ds_read_b64_tr_b16 v[154:155], v8 offset:8960
  ds_read_b64_tr_b16 v[156:157], v15 offset:9216
  ds_read_b64_tr_b16 v[158:159], v9 offset:8960
  ds_read_b64_tr_b16 v[148:149], v8 offset:7680
  ds_read_b64_tr_b16 v[150:151], v15 offset:7936
  ds_read_b64_tr_b16 v[152:153], v9 offset:7680
  v_mov_b32 v168, v7
  v_mov_b32 v169, v7
  v_mov_b32 v170, v7
  v_mov_b32 v171, v7
  v_mov_b32 v172, v7
  v_mov_b32 v173, v7
  v_mov_b32 v174, v7
  v_mov_b32 v175, v7
  v_mov_b32 v176, v7
  v_mov_b32 v177, v7
  v_mov_b32 v178, v7
  v_mov_b32 v179, v7
  v_mov_b32 v180, v7
  v_mov_b32 v181, v7
  v_mov_b32 v182, v7
  v_mov_b32 v183, v7
  v_mov_b32 v96, 0
  v_mov_b32 v97, 0
  v_mov_b32 v98, 0
  v_mov_b32 v99, 0
  v_mov_b32 v100, 0
  v_mov_b32 v101, 0
  v_mov_b32 v102, 0
  v_mov_b32 v103, 0
  v_mov_b32 v104, 0
  v_mov_b32 v105, 0
  v_mov_b32 v106, 0
  v_mov_b32 v107, 0
  v_mov_b32 v108, 0
  v_mov_b32 v109, 0
  v_mov_b32 v110, 0
  v_mov_b32 v111, 0
  v_cmp_gt_i32 s[64:65], 0, v11
  v_cmp_gt_i32 s[66:67], 1, v11
  v_cmp_gt_i32 s[68:69], 2, v11
  v_cmp_gt_i32 s[70:71], 3, v11
  s_nop 1
  v_cndmask_b32 v64, v12, v13, s[64:65]
  v_cndmask_b32 v80, v13, v12, s[64:65]
  v_cndmask_b32 v65, v12, v13, s[66:67]
  v_cndmask_b32 v81, v13, v12, s[66:67]
  v_cndmask_b32 v66, v12, v13, s[68:69]
  v_cndmask_b32 v82, v13, v12, s[68:69]
  v_cndmask_b32 v67, v12, v13, s[70:71]
  v_cndmask_b32 v83, v13, v12, s[70:71]
  v_cmp_gt_i32 s[64:65], 8, v11
  v_cmp_gt_i32 s[66:67], 9, v11
  v_cmp_gt_i32 s[68:69], 10, v11
  v_cmp_gt_i32 s[70:71], 11, v11
  s_nop 1
  v_cndmask_b32 v68, v12, v13, s[64:65]
  v_cndmask_b32 v84, v13, v12, s[64:65]
  v_cndmask_b32 v69, v12, v13, s[66:67]
  v_cndmask_b32 v85, v13, v12, s[66:67]
  v_cndmask_b32 v70, v12, v13, s[68:69]
  v_cndmask_b32 v86, v13, v12, s[68:69]
  v_cndmask_b32 v71, v12, v13, s[70:71]
  v_cndmask_b32 v87, v13, v12, s[70:71]
  v_cmp_gt_i32 s[64:65], 16, v11
  v_cmp_gt_i32 s[66:67], 17, v11
  v_cmp_gt_i32 s[68:69], 18, v11
  v_cmp_gt_i32 s[70:71], 19, v11
  s_nop 1
  v_cndmask_b32 v72, v12, v13, s[64:65]
  v_cndmask_b32 v88, v13, v12, s[64:65]
  v_cndmask_b32 v73, v12, v13, s[66:67]
  v_cndmask_b32 v89, v13, v12, s[66:67]
  v_cndmask_b32 v74, v12, v13, s[68:69]
  v_cndmask_b32 v90, v13, v12, s[68:69]
  v_cndmask_b32 v75, v12, v13, s[70:71]
  v_cndmask_b32 v91, v13, v12, s[70:71]
  v_cmp_gt_i32 s[64:65], 24, v11
  v_cmp_gt_i32 s[66:67], 25, v11
  v_cmp_gt_i32 s[68:69], 26, v11
  v_cmp_gt_i32 s[70:71], 27, v11
  s_nop 1
  v_cndmask_b32 v76, v12, v13, s[64:65]
  v_cndmask_b32 v92, v13, v12, s[64:65]
  v_cndmask_b32 v77, v12, v13, s[66:67]
  v_cndmask_b32 v93, v13, v12, s[66:67]
  v_cndmask_b32 v78, v12, v13, s[68:69]
  v_cndmask_b32 v94, v13, v12, s[68:69]
  v_cndmask_b32 v79, v12, v13, s[70:71]
  v_cndmask_b32 v95, v13, v12, s[70:71]
  s_waitcnt lgkmcnt(9)
  s_mov_b32 exec_lo, 0
  v_mov_b32 v188, 0
  v_mov_b32 v189, 0
  s_mov_b32 exec_lo, -1

  v_mov_b32 v4, v12
  v_mov_b32 v5, v12
  v_mov_b32 v6, v12
  v_mov_b32 v7, v12
  v_mov_b32 v32, v12
  v_mov_b32 v33, v12
  v_mov_b32 v34, v12
  v_mov_b32 v35, v12
  v_mov_b32 v36, v12
  v_mov_b32 v37, v12
  v_mov_b32 v38, v12
  v_mov_b32 v39, v12
  v_mov_b32 v40, v12
  v_mov_b32 v41, v12
  v_mov_b32 v42, v12
  v_mov_b32 v43, v12
  v_mov_b32 v44, v12
  v_mov_b32 v45, v12
  v_mov_b32 v46, v12
  v_mov_b32 v47, v12
  s_waitcnt lgkmcnt(6)
  v_mfma_f32_32x32x16_bf16 v[16:31], v[160:163], v[184:187], v[80:95]
  ds_read_b64_tr_b16 v[142:143], v8 offset:6400
  ds_read_b64_tr_b16 v[144:145], v15 offset:6656
  ds_read_b64_tr_b16 v[146:147], v9 offset:6400
  v_mfma_f32_32x32x8_bf16 v[16:31], v[164:165], v[188:189], v[16:31]
  s_cmp_eq_u32 s62, 8
  s_cbranch_scc1 Lx1_45
  s_waitcnt lgkmcnt(6)
  v_mfma_f32_32x32x16_bf16 v[32:47], v[154:157], v[184:187], 0
  ds_read_b64_tr_b16 v[136:137], v8 offset:5120
  ds_read_b64_tr_b16 v[138:139], v15 offset:5376
  ds_read_b64_tr_b16 v[140:141], v9 offset:5120
  s_nop 0
  v_max3_f32 v4, v4, v16, v17
  v_max3_f32 v5, v5, v18, v19
  v_max3_f32 v6, v6, v20, v21
  v_max3_f32 v7, v7, v22, v23
  v_mfma_f32_32x32x8_bf16 v[32:47], v[158:159], v[188:189], v[32:47]
  v_max3_f32 v4, v4, v24, v25
  v_max3_f32 v5, v5, v26, v27
  v_max3_f32 v6, v6, v28, v29
  v_max3_f32 v7, v7, v30, v31
  s_cmp_eq_u32 s62, 7
  s_cbranch_scc1 Lx1_45
  s_waitcnt lgkmcnt(6)
  v_mfma_f32_32x32x16_bf16 v[16:31], v[148:151], v[184:187], 0
  ds_read_b64_tr_b16 v[130:131], v8 offset:3840
  ds_read_b64_tr_b16 v[132:133], v15 offset:4096
  ds_read_b64_tr_b16 v[134:135], v9 offset:3840
  s_nop 0
  v_max3_f32 v4, v4, v32, v33
  v_max3_f32 v5, v5, v34, v35
  v_max3_f32 v6, v6, v36, v37
  v_max3_f32 v7, v7, v38, v39
  v_mfma_f32_32x32x8_bf16 v[16:31], v[152:153], v[188:189], v[16:31]
  v_max3_f32 v4, v4, v40, v41
  v_max3_f32 v5, v5, v42, v43
  v_max3_f32 v6, v6, v44, v45
  v_max3_f32 v7, v7, v46, v47
  s_cmp_eq_u32 s62, 6
  s_cbranch_scc1 Lx1_45
  s_waitcnt lgkmcnt(6)
  v_mfma_f32_32x32x16_bf16 v[32:47], v[142:145], v[184:187], 0
  ds_read_b64_tr_b16 v[124:125], v8 offset:2560
  ds_read_b64_tr_b16 v[126:127], v15 offset:2816
  ds_read_b64_tr_b16 v[128:129], v9 offset:2560
  s_nop 0
  v_max3_f32 v4, v4, v16, v17
  v_max3_f32 v5, v5, v18, v19
  v_max3_f32 v6, v6, v20, v21
  v_max3_f32 v7, v7, v22, v23
  v_mfma_f32_32x32x8_bf16 v[32:47], v[146:147], v[188:189], v[32:47]
  v_max3_f32 v4, v4, v24, v25
  v_max3_f32 v5, v5, v26, v27
  v_max3_f32 v6, v6, v28, v29
  v_max3_f32 v7, v7, v30, v31
  s_cmp_eq_u32 s62, 5
  s_cbranch_scc1 Lx1_45
  s_waitcnt lgkmcnt(6)
  v_mfma_f32_32x32x16_bf16 v[16:31], v[136:139], v[184:187], 0
  ds_read_b64_tr_b16 v[118:119], v8 offset:1280
  ds_read_b64_tr_b16 v[120:121], v15 offset:1536
  ds_read_b64_tr_b16 v[122:123], v9 offset:1280
  s_nop 0
  v_max3_f32 v4, v4, v32, v33
  v_max3_f32 v5, v5, v34, v35
  v_max3_f32 v6, v6, v36, v37
  v_max3_f32 v7, v7, v38, v39
  v_mfma_f32_32x32x8_bf16 v[16:31], v[140:141], v[188:189], v[16:31]
  v_max3_f32 v4, v4, v40, v41
  v_max3_f32 v5, v5, v42, v43
  v_max3_f32 v6, v6, v44, v45
  v_max3_f32 v7, v7, v46, v47
  s_cmp_eq_u32 s62, 4
  s_cbranch_scc1 Lx1_45
  s_waitcnt lgkmcnt(6)
  v_mfma_f32_32x32x16_bf16 v[32:47], v[130:133], v[184:187], 0
  s_nop 3
  v_max3_f32 v4, v4, v16, v17
  v_max3_f32 v5, v5, v18, v19
  v_max3_f32 v6, v6, v20, v21
  v_max3_f32 v7, v7, v22, v23
  v_mfma_f32_32x32x8_bf16 v[32:47], v[134:135], v[188:189], v[32:47]
  v_max3_f32 v4, v4, v24, v25
  v_max3_f32 v5, v5, v26, v27
  v_max3_f32 v6, v6, v28, v29
  v_max3_f32 v7, v7, v30, v31
  s_cmp_eq_u32 s62, 3
  s_cbranch_scc1 Lx1_45
  s_waitcnt lgkmcnt(3)
  v_mfma_f32_32x32x16_bf16 v[16:31], v[124:127], v[184:187], 0
  s_nop 3
  v_max3_f32 v4, v4, v32, v33
  v_max3_f32 v5, v5, v34, v35
  v_max3_f32 v6, v6, v36, v37
  v_max3_f32 v7, v7, v38, v39
  v_mfma_f32_32x32x8_bf16 v[16:31], v[128:129], v[188:189], v[16:31]
  v_max3_f32 v4, v4, v40, v41
  v_max3_f32 v5, v5, v42, v43
  v_max3_f32 v6, v6, v44, v45
  v_max3_f32 v7, v7, v46, v47
  s_cmp_eq_u32 s62, 2
  s_cbranch_scc1 Lx1_45
  s_waitcnt lgkmcnt(0)
  v_mfma_f32_32x32x16_bf16 v[32:47], v[118:121], v[184:187], 0
  s_nop 3
  v_max3_f32 v4, v4, v16, v17
  v_max3_f32 v5, v5, v18, v19
  v_max3_f32 v6, v6, v20, v21
  v_max3_f32 v7, v7, v22, v23
  v_mfma_f32_32x32x8_bf16 v[32:47], v[122:123], v[188:189], v[32:47]
  v_max3_f32 v4, v4, v24, v25
  v_max3_f32 v5, v5, v26, v27
  v_max3_f32 v6, v6, v28, v29
  v_max3_f32 v7, v7, v30, v31
Lx1_45:
  s_nop 13
  v_max3_f32 v4, v4, v16, v17
  v_max3_f32 v5, v5, v18, v19
  v_max3_f32 v6, v6, v20, v21
  v_max3_f32 v7, v7, v22, v23
  v_max3_f32 v4, v4, v24, v25
  v_max3_f32 v5, v5, v26, v27
  v_max3_f32 v6, v6, v28, v29
  v_max3_f32 v7, v7, v30, v31
  v_max3_f32 v4, v4, v32, v33
  v_max3_f32 v5, v5, v34, v35
  v_max3_f32 v6, v6, v36, v37
  v_max3_f32 v7, v7, v38, v39
  v_max3_f32 v4, v4, v40, v41
  v_max3_f32 v5, v5, v42, v43
  v_max3_f32 v6, v6, v44, v45
  v_max3_f32 v7, v7, v46, v47
  v_max3_f32 v4, v4, v5, v6
  v_max_f32 v4, v4, v7
  v_mov_b32 v5, v4
  s_nop 1
  v_permlane32_swap_b32 v4, v5
  s_nop 1
  v_max_f32 v4, v4, v5

  v_mov_b32 v14, v4
  v_sub_f32 v48, 0, v14
  v_sub_f32 v49, 0, v14
  v_sub_f32 v50, 0, v14
  v_sub_f32 v51, 0, v14
  v_sub_f32 v52, 0, v14
  v_sub_f32 v53, 0, v14
  v_sub_f32 v54, 0, v14
  v_sub_f32 v55, 0, v14
  v_sub_f32 v56, 0, v14
  v_sub_f32 v57, 0, v14
  v_sub_f32 v58, 0, v14
  v_sub_f32 v59, 0, v14
  v_sub_f32 v60, 0, v14
  v_sub_f32 v61, 0, v14
  v_sub_f32 v62, 0, v14
  v_sub_f32 v63, 0, v14
  v_sub_f32 v80, v80, v14
  v_sub_f32 v81, v81, v14
  v_sub_f32 v82, v82, v14
  v_sub_f32 v83, v83, v14
  v_sub_f32 v84, v84, v14
  v_sub_f32 v85, v85, v14
  v_sub_f32 v86, v86, v14
  v_sub_f32 v87, v87, v14
  v_sub_f32 v88, v88, v14
  v_sub_f32 v89, v89, v14
  v_sub_f32 v90, v90, v14
  v_sub_f32 v91, v91, v14
  v_sub_f32 v92, v92, v14
  v_sub_f32 v93, v93, v14
  v_sub_f32 v94, v94, v14
  v_sub_f32 v95, v95, v14
  s_waitcnt lgkmcnt(0)
  s_mov_b64 exec, s[56:57]
  ds_read_b128 v[168:171], v10 offset:10240
  ds_read_b128 v[172:175], v10 offset:10880
  s_mov_b64 exec, -1
  v_mfma_f32_32x32x16_bf16 v[16:31], v[160:163], v[184:187], v[80:95]
  v_mfma_f32_32x32x8_bf16 v[16:31], v[164:165], v[188:189], v[16:31]
  s_nop 11
  v_mfma_f32_32x32x16_bf16 v[32:47], v[154:157], v[184:187], v[48:63]
  v_exp_f32 v16, v16
  v_exp_f32 v17, v17
  v_exp_f32 v18, v18
  v_exp_f32 v19, v19
  v_cvt_pk_bf16_f32 v192, v16, v17
  v_mfma_f32_32x32x8_bf16 v[32:47], v[158:159], v[188:189], v[32:47]
  v_exp_f32 v20, v20
  v_exp_f32 v21, v21
  v_cvt_pk_bf16_f32 v193, v18, v19
  v_exp_f32 v22, v22
  v_exp_f32 v23, v23
  v_cvt_pk_bf16_f32 v194, v20, v21
  v_exp_f32 v24, v24
  v_exp_f32 v25, v25
  v_cvt_pk_bf16_f32 v195, v22, v23
  v_exp_f32 v26, v26
  v_exp_f32 v27, v27
  v_cvt_pk_bf16_f32 v196, v24, v25
  v_exp_f32 v28, v28
  v_exp_f32 v29, v29
  v_cvt_pk_bf16_f32 v197, v26, v27
  v_exp_f32 v30, v30
  v_exp_f32 v31, v31
  v_cvt_pk_bf16_f32 v198, v28, v29
  s_nop 0
  v_cvt_pk_bf16_f32 v199, v30, v31
  s_mov_b64 exec, s[56:57]
  ds_read_b128 v[176:179], v10 offset:8960
  ds_read_b128 v[180:183], v10 offset:9600
  s_mov_b64 exec, -1
  s_cmp_eq_u32 s62, 8
  s_cbranch_scc1 Lst_47
  v_mfma_f32_32x32x16_bf16 v[16:31], v[148:151], v[184:187], v[48:63]
  v_exp_f32 v32, v32
  v_exp_f32 v33, v33
  v_exp_f32 v34, v34
  v_exp_f32 v35, v35
  v_cvt_pk_bf16_f32 v200, v32, v33
  s_waitcnt lgkmcnt(2)
  v_mfma_f32_32x32x16_bf16 v[96:111], v[168:171], v[192:195], v[96:111]
  v_exp_f32 v36, v36
  v_exp_f32 v37, v37
  v_cvt_pk_bf16_f32 v201, v34, v35
  v_exp_f32 v38, v38
  v_exp_f32 v39, v39
  v_cvt_pk_bf16_f32 v202, v36, v37
  v_mfma_f32_32x32x8_bf16 v[16:31], v[152:153], v[188:189], v[16:31]
  v_exp_f32 v40, v40
  v_exp_f32 v41, v41
  v_cvt_pk_bf16_f32 v203, v38, v39
  v_exp_f32 v42, v42
  v_exp_f32 v43, v43
  v_cvt_pk_bf16_f32 v204, v40, v41
  v_mfma_f32_32x32x16_bf16 v[96:111], v[172:175], v[196:199], v[96:111]
  v_exp_f32 v44, v44
  v_exp_f32 v45, v45
  v_cvt_pk_bf16_f32 v205, v42, v43
  v_exp_f32 v46, v46
  v_exp_f32 v47, v47
  v_cvt_pk_bf16_f32 v206, v44, v45
  s_nop 0
  v_cvt_pk_bf16_f32 v207, v46, v47
  s_mov_b64 exec, s[56:57]
  ds_read_b128 v[168:171], v10 offset:7680
  ds_read_b128 v[172:175], v10 offset:8320
  s_mov_b64 exec, -1
  s_cmp_eq_u32 s62, 7
  s_cbranch_scc1 Lst_48
  v_mfma_f32_32x32x16_bf16 v[32:47], v[142:145], v[184:187], v[48:63]
  v_exp_f32 v16, v16
  v_exp_f32 v17, v17
  v_exp_f32 v18, v18
  v_exp_f32 v19, v19
  v_cvt_pk_bf16_f32 v192, v16, v17
  s_waitcnt lgkmcnt(2)
  v_mfma_f32_32x32x16_bf16 v[96:111], v[176:179], v[200:203], v[96:111]
  v_exp_f32 v20, v20
  v_exp_f32 v21, v21
  v_cvt_pk_bf16_f32 v193, v18, v19
  v_exp_f32 v22, v22
  v_exp_f32 v23, v23
  v_cvt_pk_bf16_f32 v194, v20, v21
  v_mfma_f32_32x32x8_bf16 v[32:47], v[146:147], v[188:189], v[32:47]
  v_exp_f32 v24, v24
  v_exp_f32 v25, v25
  v_cvt_pk_bf16_f32 v195, v22, v23
  v_exp_f32 v26, v26
  v_exp_f32 v27, v27
  v_cvt_pk_bf16_f32 v196, v24, v25
  v_mfma_f32_32x32x16_bf16 v[96:111], v[180:183], v[204:207], v[96:111]
  v_exp_f32 v28, v28
  v_exp_f32 v29, v29
  v_cvt_pk_bf16_f32 v197, v26, v27
  v_exp_f32 v30, v30
  v_exp_f32 v31, v31
  v_cvt_pk_bf16_f32 v198, v28, v29
  s_nop 0
  v_cvt_pk_bf16_f32 v199, v30, v31
  s_mov_b64 exec, s[56:57]
  ds_read_b128 v[176:179], v10 offset:6400
  ds_read_b128 v[180:183], v10 offset:7040
  s_mov_b64 exec, -1
  s_cmp_eq_u32 s62, 6
  s_cbranch_scc1 Lst_49
  v_mfma_f32_32x32x16_bf16 v[16:31], v[136:139], v[184:187], v[48:63]
  v_exp_f32 v32, v32
  v_exp_f32 v33, v33
  v_exp_f32 v34, v34
  v_exp_f32 v35, v35
  v_cvt_pk_bf16_f32 v200, v32, v33
  s_waitcnt lgkmcnt(2)
  v_mfma_f32_32x32x16_bf16 v[96:111], v[168:171], v[192:195], v[96:111]
  v_exp_f32 v36, v36
  v_exp_f32 v37, v37
  v_cvt_pk_bf16_f32 v201, v34, v35
  v_exp_f32 v38, v38
  v_exp_f32 v39, v39
  v_cvt_pk_bf16_f32 v202, v36, v37
  v_mfma_f32_32x32x8_bf16 v[16:31], v[140:141], v[188:189], v[16:31]
  v_exp_f32 v40, v40
  v_exp_f32 v41, v41
  v_cvt_pk_bf16_f32 v203, v38, v39
  v_exp_f32 v42, v42
  v_exp_f32 v43, v43
  v_cvt_pk_bf16_f32 v204, v40, v41
  v_mfma_f32_32x32x16_bf16 v[96:111], v[172:175], v[196:199], v[96:111]
  v_exp_f32 v44, v44
  v_exp_f32 v45, v45
  v_cvt_pk_bf16_f32 v205, v42, v43
  v_exp_f32 v46, v46
  v_exp_f32 v47, v47
  v_cvt_pk_bf16_f32 v206, v44, v45
  s_nop 0
  v_cvt_pk_bf16_f32 v207, v46, v47
  s_mov_b64 exec, s[56:57]
  ds_read_b128 v[168:171], v10 offset:5120
  ds_read_b128 v[172:175], v10 offset:5760
  s_mov_b64 exec, -1
  s_cmp_eq_u32 s62, 5
  s_cbranch_scc1 Lst_50
  v_mfma_f32_32x32x16_bf16 v[32:47], v[130:133], v[184:187], v[48:63]
  v_exp_f32 v16, v16
  v_exp_f32 v17, v17
  v_exp_f32 v18, v18
  v_exp_f32 v19, v19
  v_cvt_pk_bf16_f32 v192, v16, v17
  s_waitcnt lgkmcnt(2)
  v_mfma_f32_32x32x16_bf16 v[96:111], v[176:179], v[200:203], v[96:111]
  v_exp_f32 v20, v20
  v_exp_f32 v21, v21
  v_cvt_pk_bf16_f32 v193, v18, v19
  v_exp_f32 v22, v22
  v_exp_f32 v23, v23
  v_cvt_pk_bf16_f32 v194, v20, v21
  v_mfma_f32_32x32x8_bf16 v[32:47], v[134:135], v[188:189], v[32:47]
  v_exp_f32 v24, v24
  v_exp_f32 v25, v25
  v_cvt_pk_bf16_f32 v195, v22, v23
  v_exp_f32 v26, v26
  v_exp_f32 v27, v27
  v_cvt_pk_bf16_f32 v196, v24, v25
  v_mfma_f32_32x32x16_bf16 v[96:111], v[180:183], v[204:207], v[96:111]
  v_exp_f32 v28, v28
  v_exp_f32 v29, v29
  v_cvt_pk_bf16_f32 v197, v26, v27
  v_exp_f32 v30, v30
  v_exp_f32 v31, v31
  v_cvt_pk_bf16_f32 v198, v28, v29
  s_nop 0
  v_cvt_pk_bf16_f32 v199, v30, v31
  s_mov_b64 exec, s[56:57]
  ds_read_b128 v[176:179], v10 offset:3840
  ds_read_b128 v[180:183], v10 offset:4480
  s_mov_b64 exec, -1
  s_cmp_eq_u32 s62, 4
  s_cbranch_scc1 Lst_51
  v_mfma_f32_32x32x16_bf16 v[16:31], v[124:127], v[184:187], v[48:63]
  v_exp_f32 v32, v32
  v_exp_f32 v33, v33
  v_exp_f32 v34, v34
  v_exp_f32 v35, v35
  v_cvt_pk_bf16_f32 v200, v32, v33
  s_waitcnt lgkmcnt(2)
  v_mfma_f32_32x32x16_bf16 v[96:111], v[168:171], v[192:195], v[96:111]
  v_exp_f32 v36, v36
  v_exp_f32 v37, v37
  v_cvt_pk_bf16_f32 v201, v34, v35
  v_exp_f32 v38, v38
  v_exp_f32 v39, v39
  v_cvt_pk_bf16_f32 v202, v36, v37
  v_mfma_f32_32x32x8_bf16 v[16:31], v[128:129], v[188:189], v[16:31]
  v_exp_f32 v40, v40
  v_exp_f32 v41, v41
  v_cvt_pk_bf16_f32 v203, v38, v39
  v_exp_f32 v42, v42
  v_exp_f32 v43, v43
  v_cvt_pk_bf16_f32 v204, v40, v41
  v_mfma_f32_32x32x16_bf16 v[96:111], v[172:175], v[196:199], v[96:111]
  v_exp_f32 v44, v44
  v_exp_f32 v45, v45
  v_cvt_pk_bf16_f32 v205, v42, v43
  v_exp_f32 v46, v46
  v_exp_f32 v47, v47
  v_cvt_pk_bf16_f32 v206, v44, v45
  s_nop 0
  v_cvt_pk_bf16_f32 v207, v46, v47
  s_mov_b64 exec, s[56:57]
  ds_read_b128 v[168:171], v10 offset:2560
  ds_read_b128 v[172:175], v10 offset:3200
  s_mov_b64 exec, -1
  s_cmp_eq_u32 s62, 3
  s_cbranch_scc1 Lst_52
  v_mfma_f32_32x32x16_bf16 v[32:47], v[118:121], v[184:187], v[48:63]
  v_exp_f32 v16, v16
  v_exp_f32 v17, v17
  v_exp_f32 v18, v18
  v_exp_f32 v19, v19
  v_cvt_pk_bf16_f32 v192, v16, v17
  s_waitcnt lgkmcnt(2)
  v_mfma_f32_32x32x16_bf16 v[96:111], v[176:179], v[200:203], v[96:111]
  v_exp_f32 v20, v20
  v_exp_f32 v21, v21
  v_cvt_pk_bf16_f32 v193, v18, v19
  v_exp_f32 v22, v22
  v_exp_f32 v23, v23
  v_cvt_pk_bf16_f32 v194, v20, v21
  v_mfma_f32_32x32x8_bf16 v[32:47], v[122:123], v[188:189], v[32:47]
  v_exp_f32 v24, v24
  v_exp_f32 v25, v25
  v_cvt_pk_bf16_f32 v195, v22, v23
  v_exp_f32 v26, v26
  v_exp_f32 v27, v27
  v_cvt_pk_bf16_f32 v196, v24, v25
  v_mfma_f32_32x32x16_bf16 v[96:111], v[180:183], v[204:207], v[96:111]
  v_exp_f32 v28, v28
  v_exp_f32 v29, v29
  v_cvt_pk_bf16_f32 v197, v26, v27
  v_exp_f32 v30, v30
  v_exp_f32 v31, v31
  v_cvt_pk_bf16_f32 v198, v28, v29
  s_nop 0
  v_cvt_pk_bf16_f32 v199, v30, v31
  s_mov_b64 exec, s[56:57]
  ds_read_b128 v[176:179], v10 offset:1280
  ds_read_b128 v[180:183], v10 offset:1920
  s_mov_b64 exec, -1
  s_cmp_eq_u32 s62, 2
  s_cbranch_scc1 Lst_53
  s_waitcnt lgkmcnt(2)
  v_mfma_f32_32x32x16_bf16 v[96:111], v[168:171], v[192:195], v[96:111]
  v_exp_f32 v32, v32
  v_exp_f32 v33, v33
  v_exp_f32 v34, v34
  v_exp_f32 v35, v35
  v_cvt_pk_bf16_f32 v200, v32, v33
  v_mfma_f32_32x32x16_bf16 v[96:111], v[172:175], v[196:199], v[96:111]
  v_exp_f32 v36, v36
  v_exp_f32 v37, v37
  v_cvt_pk_bf16_f32 v201, v34, v35
  v_exp_f32 v38, v38
  v_exp_f32 v39, v39
  v_cvt_pk_bf16_f32 v202, v36, v37
  v_exp_f32 v40, v40
  v_exp_f32 v41, v41
  v_cvt_pk_bf16_f32 v203, v38, v39
  v_exp_f32 v42, v42
  v_exp_f32 v43, v43
  v_cvt_pk_bf16_f32 v204, v40, v41
  v_exp_f32 v44, v44
  v_exp_f32 v45, v45
  v_cvt_pk_bf16_f32 v205, v42, v43
  v_exp_f32 v46, v46
  v_exp_f32 v47, v47
  v_cvt_pk_bf16_f32 v206, v44, v45
  s_nop 0
  v_cvt_pk_bf16_f32 v207, v46, v47
  s_waitcnt lgkmcnt(0)
  s_nop 0
  v_mfma_f32_32x32x16_bf16 v[96:111], v[176:179], v[200:203], v[96:111]
  v_mfma_f32_32x32x16_bf16 v[96:111], v[180:183], v[204:207], v[96:111]
  s_branch Lx2_46
Lst_47:
  s_waitcnt lgkmcnt(0)
  s_nop 0
  v_mfma_f32_32x32x16_bf16 v[96:111], v[168:171], v[192:195], v[96:111]
  v_mfma_f32_32x32x16_bf16 v[96:111], v[172:175], v[196:199], v[96:111]
  s_branch Lx2_46
Lst_48:
  s_waitcnt lgkmcnt(0)
  s_nop 0
  v_mfma_f32_32x32x16_bf16 v[96:111], v[176:179], v[200:203], v[96:111]
  v_mfma_f32_32x32x16_bf16 v[96:111], v[180:183], v[204:207], v[96:111]
  s_branch Lx2_46
Lst_49:
  s_waitcnt lgkmcnt(0)
  s_nop 0
  v_mfma_f32_32x32x16_bf16 v[96:111], v[168:171], v[192:195], v[96:111]
  v_mfma_f32_32x32x16_bf16 v[96:111], v[172:175], v[196:199], v[96:111]
  s_branch Lx2_46
Lst_50:
  s_waitcnt lgkmcnt(0)
  s_nop 0
  v_mfma_f32_32x32x16_bf16 v[96:111], v[176:179], v[200:203], v[96:111]
  v_mfma_f32_32x32x16_bf16 v[96:111], v[180:183], v[204:207], v[96:111]
  s_branch Lx2_46
Lst_51:
  s_waitcnt lgkmcnt(0)
  s_nop 0
  v_mfma_f32_32x32x16_bf16 v[96:111], v[168:171], v[192:195], v[96:111]
  v_mfma_f32_32x32x16_bf16 v[96:111], v[172:175], v[196:199], v[96:111]
  s_branch Lx2_46
Lst_52:
  s_waitcnt lgkmcnt(0)
  s_nop 0
  v_mfma_f32_32x32x16_bf16 v[96:111], v[176:179], v[200:203], v[96:111]
  v_mfma_f32_32x32x16_bf16 v[96:111], v[180:183], v[204:207], v[96:111]
  s_branch Lx2_46
Lst_53:
  s_waitcnt lgkmcnt(0)
  s_nop 0
  v_mfma_f32_32x32x16_bf16 v[96:111], v[168:171], v[192:195], v[96:111]
  v_mfma_f32_32x32x16_bf16 v[96:111], v[172:175], v[196:199], v[96:111]
  s_branch Lx2_46
Lx2_46:
  s_waitcnt lgkmcnt(0)
  s_waitcnt lgkmcnt(0)
  s_barrier
  s_mul_i32 s42, s33, 5120
  s_mul_i32 s40, s53, 102400
  s_add_u32 s40, s40, 393216
  s_add_u32 s40, s40, s42

  s_add_u32 m0, s42, 4096
  s_add_u32 s34, s40, 0
  buffer_load_dwordx4 v1, s[16:19], s34 offen sc1 lds
  buffer_load_dwordx4 v1, s[16:19], s34 offen offset:1024 sc1 lds
  buffer_load_dwordx4 v1, s[16:19], s34 offen offset:2048 sc1 lds
  buffer_load_dwordx4 v1, s[16:19], s34 offen offset:3072 sc1 lds
  s_add_u32 m0, s42, 8192
  s_add_u32 s34, s40, 4096
  buffer_load_dwordx4 v1, s[16:19], s34 offen sc1 lds
  s_add_u32 m0, s42, 24576
  s_add_u32 s34, s40, 20480
  buffer_load_dwordx4 v1, s[16:19], s34 offen sc1 lds
  buffer_load_dwordx4 v1, s[16:19], s34 offen offset:1024 sc1 lds
  buffer_load_dwordx4 v1, s[16:19], s34 offen offset:2048 sc1 lds
  buffer_load_dwordx4 v1, s[16:19], s34 offen offset:3072 sc1 lds
  s_add_u32 m0, s42, 28672
  s_add_u32 s34, s40, 24576
  buffer_load_dwordx4 v1, s[16:19], s34 offen sc1 lds
  s_add_u32 m0, s42, 45056
  s_add_u32 s34, s40, 40960
  buffer_load_dwordx4 v1, s[16:19], s34 offen sc1 lds
  buffer_load_dwordx4 v1, s[16:19], s34 offen offset:1024 sc1 lds
  buffer_load_dwordx4 v1, s[16:19], s34 offen offset:2048 sc1 lds
  buffer_load_dwordx4 v1, s[16:19], s34 offen offset:3072 sc1 lds
  s_add_u32 m0, s42, 49152
  s_add_u32 s34, s40, 45056
  buffer_load_dwordx4 v1, s[16:19], s34 offen sc1 lds
  s_add_u32 m0, s42, 65536
  s_add_u32 s34, s40, 61440
  buffer_load_dwordx4 v1, s[16:19], s34 offen sc1 lds
  buffer_load_dwordx4 v1, s[16:19], s34 offen offset:1024 sc1 lds
  buffer_load_dwordx4 v1, s[16:19], s34 offen offset:2048 sc1 lds
  buffer_load_dwordx4 v1, s[16:19], s34 offen offset:3072 sc1 lds
  s_add_u32 m0, s42, 69632
  s_add_u32 s34, s40, 65536
  buffer_load_dwordx4 v1, s[16:19], s34 offen sc1 lds
  s_cmp_eq_u32 s48, 0
  s_cbranch_scc1 Lafin_54
  ds_read_b64_tr_b16 v[112:113], v8 offset:0
  ds_read_b64_tr_b16 v[114:115], v15 offset:256
  ds_read_b64_tr_b16 v[116:117], v9 offset:0
  ds_read_b64_tr_b16 v[118:119], v8 offset:1280
  ds_read_b64_tr_b16 v[120:121], v15 offset:1536
  ds_read_b64_tr_b16 v[122:123], v9 offset:1280
  ds_read_b64_tr_b16 v[124:125], v8 offset:2560
  ds_read_b64_tr_b16 v[126:127], v15 offset:2816
  ds_read_b64_tr_b16 v[128:129], v9 offset:2560
  v_mov_b32 v4, v12
  v_mov_b32 v5, v12
  v_mov_b32 v6, v12
  v_mov_b32 v7, v12
  v_mov_b32 v32, v12
  v_mov_b32 v33, v12
  v_mov_b32 v34, v12
  v_mov_b32 v35, v12
  v_mov_b32 v36, v12
  v_mov_b32 v37, v12
  v_mov_b32 v38, v12
  v_mov_b32 v39, v12
  v_mov_b32 v40, v12
  v_mov_b32 v41, v12
  v_mov_b32 v42, v12
  v_mov_b32 v43, v12
  v_mov_b32 v44, v12
  v_mov_b32 v45, v12
  v_mov_b32 v46, v12
  v_mov_b32 v47, v12
  s_waitcnt lgkmcnt(6)
  v_mfma_f32_32x32x16_bf16 v[16:31], v[112:115], v[184:187], v[64:79]
  ds_read_b64_tr_b16 v[130:131], v8 offset:3840
  ds_read_b64_tr_b16 v[132:133], v15 offset:4096
  ds_read_b64_tr_b16 v[134:135], v9 offset:3840
  v_mfma_f32_32x32x8_bf16 v[16:31], v[116:117], v[188:189], v[16:31]
  s_cmp_eq_u32 s63, 0
  s_cbranch_scc1 Lx1_55
  s_waitcnt lgkmcnt(6)
  v_mfma_f32_32x32x16_bf16 v[32:47], v[118:121], v[184:187], 0
  ds_read_b64_tr_b16 v[136:137], v8 offset:5120
  ds_read_b64_tr_b16 v[138:139], v15 offset:5376
  ds_read_b64_tr_b16 v[140:141], v9 offset:5120
  s_nop 0
  v_max3_f32 v4, v4, v16, v17
  v_max3_f32 v5, v5, v18, v19
  v_max3_f32 v6, v6, v20, v21
  v_max3_f32 v7, v7, v22, v23
  v_mfma_f32_32x32x8_bf16 v[32:47], v[122:123], v[188:189], v[32:47]
  v_max3_f32 v4, v4, v24, v25
  v_max3_f32 v5, v5, v26, v27
  v_max3_f32 v6, v6, v28, v29
  v_max3_f32 v7, v7, v30, v31
  s_cmp_eq_u32 s63, 1
  s_cbranch_scc1 Lx1_55
  s_waitcnt lgkmcnt(6)
  v_mfma_f32_32x32x16_bf16 v[16:31], v[124:127], v[184:187], 0
  ds_read_b64_tr_b16 v[142:143], v8 offset:6400
  ds_read_b64_tr_b16 v[144:145], v15 offset:6656
  ds_read_b64_tr_b16 v[146:147], v9 offset:6400
  s_nop 0
  v_max3_f32 v4, v4, v32, v33
  v_max3_f32 v5, v5, v34, v35
  v_max3_f32 v6, v6, v36, v37
  v_max3_f32 v7, v7, v38, v39
  v_mfma_f32_32x32x8_bf16 v[16:31], v[128:129], v[188:189], v[16:31]
  v_max3_f32 v4, v4, v40, v41
  v_max3_f32 v5, v5, v42, v43
  v_max3_f32 v6, v6, v44, v45
  v_max3_f32 v7, v7, v46, v47
  s_cmp_eq_u32 s63, 2
  s_cbranch_scc1 Lx1_55
  s_waitcnt lgkmcnt(6)
  v_mfma_f32_32x32x16_bf16 v[32:47], v[130:133], v[184:187], 0
  ds_read_b64_tr_b16 v[148:149], v8 offset:7680
  ds_read_b64_tr_b16 v[150:151], v15 offset:7936
  ds_read_b64_tr_b16 v[152:153], v9 offset:7680
  s_nop 0
  v_max3_f32 v4, v4, v16, v17
  v_max3_f32 v5, v5, v18, v19
  v_max3_f32 v6, v6, v20, v21
  v_max3_f32 v7, v7, v22, v23
  v_mfma_f32_32x32x8_bf16 v[32:47], v[134:135], v[188:189], v[32:47]
  v_max3_f32 v4, v4, v24, v25
  v_max3_f32 v5, v5, v26, v27
  v_max3_f32 v6, v6, v28, v29
  v_max3_f32 v7, v7, v30, v31
  s_cmp_eq_u32 s63, 3
  s_cbranch_scc1 Lx1_55
  s_waitcnt lgkmcnt(6)
  v_mfma_f32_32x32x16_bf16 v[16:31], v[136:139], v[184:187], 0
  ds_read_b64_tr_b16 v[154:155], v8 offset:8960
  ds_read_b64_tr_b16 v[156:157], v15 offset:9216
  ds_read_b64_tr_b16 v[158:159], v9 offset:8960
  s_nop 0
  v_max3_f32 v4, v4, v32, v33
  v_max3_f32 v5, v5, v34, v35
  v_max3_f32 v6, v6, v36, v37
  v_max3_f32 v7, v7, v38, v39
  v_mfma_f32_32x32x8_bf16 v[16:31], v[140:141], v[188:189], v[16:31]
  v_max3_f32 v4, v4, v40, v41
  v_max3_f32 v5, v5, v42, v43
  v_max3_f32 v6, v6, v44, v45
  v_max3_f32 v7, v7, v46, v47
  s_cmp_eq_u32 s63, 4
  s_cbranch_scc1 Lx1_55
  s_waitcnt lgkmcnt(6)
  v_mfma_f32_32x32x16_bf16 v[32:47], v[142:145], v[184:187], 0
  s_nop 3
  v_max3_f32 v4, v4, v16, v17
  v_max3_f32 v5, v5, v18, v19
  v_max3_f32 v6, v6, v20, v21
  v_max3_f32 v7, v7, v22, v23
  v_mfma_f32_32x32x8_bf16 v[32:47], v[146:147], v[188:189], v[32:47]
  v_max3_f32 v4, v4, v24, v25
  v_max3_f32 v5, v5, v26, v27
  v_max3_f32 v6, v6, v28, v29
  v_max3_f32 v7, v7, v30, v31
  s_cmp_eq_u32 s63, 5
  s_cbranch_scc1 Lx1_55
  s_waitcnt lgkmcnt(3)
  v_mfma_f32_32x32x16_bf16 v[16:31], v[148:151], v[184:187], 0
  s_nop 3
  v_max3_f32 v4, v4, v32, v33
  v_max3_f32 v5, v5, v34, v35
  v_max3_f32 v6, v6, v36, v37
  v_max3_f32 v7, v7, v38, v39
  v_mfma_f32_32x32x8_bf16 v[16:31], v[152:153], v[188:189], v[16:31]
  v_max3_f32 v4, v4, v40, v41
  v_max3_f32 v5, v5, v42, v43
  v_max3_f32 v6, v6, v44, v45
  v_max3_f32 v7, v7, v46, v47
  s_cmp_eq_u32 s63, 6
  s_cbranch_scc1 Lx1_55
  s_waitcnt lgkmcnt(0)
  v_mfma_f32_32x32x16_bf16 v[32:47], v[154:157], v[184:187], 0
  s_nop 3
  v_max3_f32 v4, v4, v16, v17
  v_max3_f32 v5, v5, v18, v19
  v_max3_f32 v6, v6, v20, v21
  v_max3_f32 v7, v7, v22, v23
  v_mfma_f32_32x32x8_bf16 v[32:47], v[158:159], v[188:189], v[32:47]
  v_max3_f32 v4, v4, v24, v25
  v_max3_f32 v5, v5, v26, v27
  v_max3_f32 v6, v6, v28, v29
  v_max3_f32 v7, v7, v30, v31
Lx1_55:
  s_nop 13
  v_max3_f32 v4, v4, v16, v17
  v_max3_f32 v5, v5, v18, v19
  v_max3_f32 v6, v6, v20, v21
  v_max3_f32 v7, v7, v22, v23
  v_max3_f32 v4, v4, v24, v25
  v_max3_f32 v5, v5, v26, v27
  v_max3_f32 v6, v6, v28, v29
  v_max3_f32 v7, v7, v30, v31
  v_max3_f32 v4, v4, v32, v33
  v_max3_f32 v5, v5, v34, v35
  v_max3_f32 v6, v6, v36, v37
  v_max3_f32 v7, v7, v38, v39
  v_max3_f32 v4, v4, v40, v41
  v_max3_f32 v5, v5, v42, v43
  v_max3_f32 v6, v6, v44, v45
  v_max3_f32 v7, v7, v46, v47
  v_max3_f32 v4, v4, v5, v6
  v_max_f32 v4, v4, v7
  v_mov_b32 v5, v4
  s_nop 1
  v_permlane32_swap_b32 v4, v5
  s_nop 1
  v_max_f32 v4, v4, v5

  v_max_f32 v4, v4, v14
  v_sub_f32 v5, v14, v4
  v_exp_f32 v5, v5
  v_mov_b32 v14, v4
  s_nop 0

  v_mul_f32 v96, v96, v5
  v_mul_f32 v97, v97, v5
  v_mul_f32 v98, v98, v5
  v_mul_f32 v99, v99, v5
  v_mul_f32 v100, v100, v5
  v_mul_f32 v101, v101, v5
  v_mul_f32 v102, v102, v5
  v_mul_f32 v103, v103, v5
  v_mul_f32 v104, v104, v5
  v_mul_f32 v105, v105, v5
  v_mul_f32 v106, v106, v5
  v_mul_f32 v107, v107, v5
  v_mul_f32 v108, v108, v5
  v_mul_f32 v109, v109, v5
  v_mul_f32 v110, v110, v5
  v_mul_f32 v111, v111, v5
  v_sub_f32 v48, 0, v14
  v_sub_f32 v49, 0, v14
  v_sub_f32 v50, 0, v14
  v_sub_f32 v51, 0, v14
  v_sub_f32 v52, 0, v14
  v_sub_f32 v53, 0, v14
  v_sub_f32 v54, 0, v14
  v_sub_f32 v55, 0, v14
  v_sub_f32 v56, 0, v14
  v_sub_f32 v57, 0, v14
  v_sub_f32 v58, 0, v14
  v_sub_f32 v59, 0, v14
  v_sub_f32 v60, 0, v14
  v_sub_f32 v61, 0, v14
  v_sub_f32 v62, 0, v14
  v_sub_f32 v63, 0, v14
  v_sub_f32 v64, v64, v14
  v_sub_f32 v65, v65, v14
  v_sub_f32 v66, v66, v14
  v_sub_f32 v67, v67, v14
  v_sub_f32 v68, v68, v14
  v_sub_f32 v69, v69, v14
  v_sub_f32 v70, v70, v14
  v_sub_f32 v71, v71, v14
  v_sub_f32 v72, v72, v14
  v_sub_f32 v73, v73, v14
  v_sub_f32 v74, v74, v14
  v_sub_f32 v75, v75, v14
  v_sub_f32 v76, v76, v14
  v_sub_f32 v77, v77, v14
  v_sub_f32 v78, v78, v14
  v_sub_f32 v79, v79, v14
  s_waitcnt lgkmcnt(0)
  s_mov_b64 exec, s[56:57]
  ds_read_b128 v[168:171], v10 offset:0
  ds_read_b128 v[172:175], v10 offset:640
  s_mov_b64 exec, -1
  v_mfma_f32_32x32x16_bf16 v[16:31], v[112:115], v[184:187], v[64:79]
  v_mfma_f32_32x32x8_bf16 v[16:31], v[116:117], v[188:189], v[16:31]
  s_nop 11
  v_mfma_f32_32x32x16_bf16 v[32:47], v[118:121], v[184:187], v[48:63]
  v_exp_f32 v16, v16
  v_exp_f32 v17, v17
  v_exp_f32 v18, v18
  v_exp_f32 v19, v19
  v_cvt_pk_bf16_f32 v192, v16, v17
  v_mfma_f32_32x32x8_bf16 v[32:47], v[122:123], v[188:189], v[32:47]
  v_exp_f32 v20, v20
  v_exp_f32 v21, v21
  v_cvt_pk_bf16_f32 v193, v18, v19
  v_exp_f32 v22, v22
  v_exp_f32 v23, v23
  v_cvt_pk_bf16_f32 v194, v20, v21
  v_exp_f32 v24, v24
  v_exp_f32 v25, v25
  v_cvt_pk_bf16_f32 v195, v22, v23
  v_exp_f32 v26, v26
  v_exp_f32 v27, v27
  v_cvt_pk_bf16_f32 v196, v24, v25
  v_exp_f32 v28, v28
  v_exp_f32 v29, v29
  v_cvt_pk_bf16_f32 v197, v26, v27
  v_exp_f32 v30, v30
  v_exp_f32 v31, v31
  v_cvt_pk_bf16_f32 v198, v28, v29
  s_nop 0
  v_cvt_pk_bf16_f32 v199, v30, v31
  s_mov_b64 exec, s[56:57]
  ds_read_b128 v[176:179], v10 offset:1280
  ds_read_b128 v[180:183], v10 offset:1920
  s_mov_b64 exec, -1
  s_cmp_eq_u32 s63, 0
  s_cbranch_scc1 Lst_57
  v_mfma_f32_32x32x16_bf16 v[16:31], v[124:127], v[184:187], v[48:63]
  v_exp_f32 v32, v32
  v_exp_f32 v33, v33
  v_exp_f32 v34, v34
  v_exp_f32 v35, v35
  v_cvt_pk_bf16_f32 v200, v32, v33
  s_waitcnt lgkmcnt(2)
  v_mfma_f32_32x32x16_bf16 v[96:111], v[168:171], v[192:195], v[96:111]
  v_exp_f32 v36, v36
  v_exp_f32 v37, v37
  v_cvt_pk_bf16_f32 v201, v34, v35
  v_exp_f32 v38, v38
  v_exp_f32 v39, v39
  v_cvt_pk_bf16_f32 v202, v36, v37
  v_mfma_f32_32x32x8_bf16 v[16:31], v[128:129], v[188:189], v[16:31]
  v_exp_f32 v40, v40
  v_exp_f32 v41, v41
  v_cvt_pk_bf16_f32 v203, v38, v39
  v_exp_f32 v42, v42
  v_exp_f32 v43, v43
  v_cvt_pk_bf16_f32 v204, v40, v41
  v_mfma_f32_32x32x16_bf16 v[96:111], v[172:175], v[196:199], v[96:111]
  v_exp_f32 v44, v44
  v_exp_f32 v45, v45
  v_cvt_pk_bf16_f32 v205, v42, v43
  v_exp_f32 v46, v46
  v_exp_f32 v47, v47
  v_cvt_pk_bf16_f32 v206, v44, v45
  s_nop 0
  v_cvt_pk_bf16_f32 v207, v46, v47
  s_mov_b64 exec, s[56:57]
  ds_read_b128 v[168:171], v10 offset:2560
  ds_read_b128 v[172:175], v10 offset:3200
  s_mov_b64 exec, -1
  s_cmp_eq_u32 s63, 1
  s_cbranch_scc1 Lst_58
  v_mfma_f32_32x32x16_bf16 v[32:47], v[130:133], v[184:187], v[48:63]
  v_exp_f32 v16, v16
  v_exp_f32 v17, v17
  v_exp_f32 v18, v18
  v_exp_f32 v19, v19
  v_cvt_pk_bf16_f32 v192, v16, v17
  s_waitcnt lgkmcnt(2)
  v_mfma_f32_32x32x16_bf16 v[96:111], v[176:179], v[200:203], v[96:111]
  v_exp_f32 v20, v20
  v_exp_f32 v21, v21
  v_cvt_pk_bf16_f32 v193, v18, v19
  v_exp_f32 v22, v22
  v_exp_f32 v23, v23
  v_cvt_pk_bf16_f32 v194, v20, v21
  v_mfma_f32_32x32x8_bf16 v[32:47], v[134:135], v[188:189], v[32:47]
  v_exp_f32 v24, v24
  v_exp_f32 v25, v25
  v_cvt_pk_bf16_f32 v195, v22, v23
  v_exp_f32 v26, v26
  v_exp_f32 v27, v27
  v_cvt_pk_bf16_f32 v196, v24, v25
  v_mfma_f32_32x32x16_bf16 v[96:111], v[180:183], v[204:207], v[96:111]
  v_exp_f32 v28, v28
  v_exp_f32 v29, v29
  v_cvt_pk_bf16_f32 v197, v26, v27
  v_exp_f32 v30, v30
  v_exp_f32 v31, v31
  v_cvt_pk_bf16_f32 v198, v28, v29
  s_nop 0
  v_cvt_pk_bf16_f32 v199, v30, v31
  s_mov_b64 exec, s[56:57]
  ds_read_b128 v[176:179], v10 offset:3840
  ds_read_b128 v[180:183], v10 offset:4480
  s_mov_b64 exec, -1
  s_cmp_eq_u32 s63, 2
  s_cbranch_scc1 Lst_59
  v_mfma_f32_32x32x16_bf16 v[16:31], v[136:139], v[184:187], v[48:63]
  v_exp_f32 v32, v32
  v_exp_f32 v33, v33
  v_exp_f32 v34, v34
  v_exp_f32 v35, v35
  v_cvt_pk_bf16_f32 v200, v32, v33
  s_waitcnt lgkmcnt(2)
  v_mfma_f32_32x32x16_bf16 v[96:111], v[168:171], v[192:195], v[96:111]
  v_exp_f32 v36, v36
  v_exp_f32 v37, v37
  v_cvt_pk_bf16_f32 v201, v34, v35
  v_exp_f32 v38, v38
  v_exp_f32 v39, v39
  v_cvt_pk_bf16_f32 v202, v36, v37
  v_mfma_f32_32x32x8_bf16 v[16:31], v[140:141], v[188:189], v[16:31]
  v_exp_f32 v40, v40
  v_exp_f32 v41, v41
  v_cvt_pk_bf16_f32 v203, v38, v39
  v_exp_f32 v42, v42
  v_exp_f32 v43, v43
  v_cvt_pk_bf16_f32 v204, v40, v41
  v_mfma_f32_32x32x16_bf16 v[96:111], v[172:175], v[196:199], v[96:111]
  v_exp_f32 v44, v44
  v_exp_f32 v45, v45
  v_cvt_pk_bf16_f32 v205, v42, v43
  v_exp_f32 v46, v46
  v_exp_f32 v47, v47
  v_cvt_pk_bf16_f32 v206, v44, v45
  s_nop 0
  v_cvt_pk_bf16_f32 v207, v46, v47
  s_mov_b64 exec, s[56:57]
  ds_read_b128 v[168:171], v10 offset:5120
  ds_read_b128 v[172:175], v10 offset:5760
  s_mov_b64 exec, -1
  s_cmp_eq_u32 s63, 3
  s_cbranch_scc1 Lst_60
  v_mfma_f32_32x32x16_bf16 v[32:47], v[142:145], v[184:187], v[48:63]
  v_exp_f32 v16, v16
  v_exp_f32 v17, v17
  v_exp_f32 v18, v18
  v_exp_f32 v19, v19
  v_cvt_pk_bf16_f32 v192, v16, v17
  s_waitcnt lgkmcnt(2)
  v_mfma_f32_32x32x16_bf16 v[96:111], v[176:179], v[200:203], v[96:111]
  v_exp_f32 v20, v20
  v_exp_f32 v21, v21
  v_cvt_pk_bf16_f32 v193, v18, v19
  v_exp_f32 v22, v22
  v_exp_f32 v23, v23
  v_cvt_pk_bf16_f32 v194, v20, v21
  v_mfma_f32_32x32x8_bf16 v[32:47], v[146:147], v[188:189], v[32:47]
  v_exp_f32 v24, v24
  v_exp_f32 v25, v25
  v_cvt_pk_bf16_f32 v195, v22, v23
  v_exp_f32 v26, v26
  v_exp_f32 v27, v27
  v_cvt_pk_bf16_f32 v196, v24, v25
  v_mfma_f32_32x32x16_bf16 v[96:111], v[180:183], v[204:207], v[96:111]
  v_exp_f32 v28, v28
  v_exp_f32 v29, v29
  v_cvt_pk_bf16_f32 v197, v26, v27
  v_exp_f32 v30, v30
  v_exp_f32 v31, v31
  v_cvt_pk_bf16_f32 v198, v28, v29
  s_nop 0
  v_cvt_pk_bf16_f32 v199, v30, v31
  s_mov_b64 exec, s[56:57]
  ds_read_b128 v[176:179], v10 offset:6400
  ds_read_b128 v[180:183], v10 offset:7040
  s_mov_b64 exec, -1
  s_cmp_eq_u32 s63, 4
  s_cbranch_scc1 Lst_61
  v_mfma_f32_32x32x16_bf16 v[16:31], v[148:151], v[184:187], v[48:63]
  v_exp_f32 v32, v32
  v_exp_f32 v33, v33
  v_exp_f32 v34, v34
  v_exp_f32 v35, v35
  v_cvt_pk_bf16_f32 v200, v32, v33
  s_waitcnt lgkmcnt(2)
  v_mfma_f32_32x32x16_bf16 v[96:111], v[168:171], v[192:195], v[96:111]
  v_exp_f32 v36, v36
  v_exp_f32 v37, v37
  v_cvt_pk_bf16_f32 v201, v34, v35
  v_exp_f32 v38, v38
  v_exp_f32 v39, v39
  v_cvt_pk_bf16_f32 v202, v36, v37
  v_mfma_f32_32x32x8_bf16 v[16:31], v[152:153], v[188:189], v[16:31]
  v_exp_f32 v40, v40
  v_exp_f32 v41, v41
  v_cvt_pk_bf16_f32 v203, v38, v39
  v_exp_f32 v42, v42
  v_exp_f32 v43, v43
  v_cvt_pk_bf16_f32 v204, v40, v41
  v_mfma_f32_32x32x16_bf16 v[96:111], v[172:175], v[196:199], v[96:111]
  v_exp_f32 v44, v44
  v_exp_f32 v45, v45
  v_cvt_pk_bf16_f32 v205, v42, v43
  v_exp_f32 v46, v46
  v_exp_f32 v47, v47
  v_cvt_pk_bf16_f32 v206, v44, v45
  s_nop 0
  v_cvt_pk_bf16_f32 v207, v46, v47
  s_mov_b64 exec, s[56:57]
  ds_read_b128 v[168:171], v10 offset:7680
  ds_read_b128 v[172:175], v10 offset:8320
  s_mov_b64 exec, -1
  s_cmp_eq_u32 s63, 5
  s_cbranch_scc1 Lst_62
  v_mfma_f32_32x32x16_bf16 v[32:47], v[154:157], v[184:187], v[48:63]
  v_exp_f32 v16, v16
  v_exp_f32 v17, v17
  v_exp_f32 v18, v18
  v_exp_f32 v19, v19
  v_cvt_pk_bf16_f32 v192, v16, v17
  s_waitcnt lgkmcnt(2)
  v_mfma_f32_32x32x16_bf16 v[96:111], v[176:179], v[200:203], v[96:111]
  v_exp_f32 v20, v20
  v_exp_f32 v21, v21
  v_cvt_pk_bf16_f32 v193, v18, v19
  v_exp_f32 v22, v22
  v_exp_f32 v23, v23
  v_cvt_pk_bf16_f32 v194, v20, v21
  v_mfma_f32_32x32x8_bf16 v[32:47], v[158:159], v[188:189], v[32:47]
  v_exp_f32 v24, v24
  v_exp_f32 v25, v25
  v_cvt_pk_bf16_f32 v195, v22, v23
  v_exp_f32 v26, v26
  v_exp_f32 v27, v27
  v_cvt_pk_bf16_f32 v196, v24, v25
  v_mfma_f32_32x32x16_bf16 v[96:111], v[180:183], v[204:207], v[96:111]
  v_exp_f32 v28, v28
  v_exp_f32 v29, v29
  v_cvt_pk_bf16_f32 v197, v26, v27
  v_exp_f32 v30, v30
  v_exp_f32 v31, v31
  v_cvt_pk_bf16_f32 v198, v28, v29
  s_nop 0
  v_cvt_pk_bf16_f32 v199, v30, v31
  s_mov_b64 exec, s[56:57]
  ds_read_b128 v[176:179], v10 offset:8960
  ds_read_b128 v[180:183], v10 offset:9600
  s_mov_b64 exec, -1
  s_cmp_eq_u32 s63, 6
  s_cbranch_scc1 Lst_63
  s_waitcnt lgkmcnt(2)
  v_mfma_f32_32x32x16_bf16 v[96:111], v[168:171], v[192:195], v[96:111]
  v_exp_f32 v32, v32
  v_exp_f32 v33, v33
  v_exp_f32 v34, v34
  v_exp_f32 v35, v35
  v_cvt_pk_bf16_f32 v200, v32, v33
  v_mfma_f32_32x32x16_bf16 v[96:111], v[172:175], v[196:199], v[96:111]
  v_exp_f32 v36, v36
  v_exp_f32 v37, v37
  v_cvt_pk_bf16_f32 v201, v34, v35
  v_exp_f32 v38, v38
  v_exp_f32 v39, v39
  v_cvt_pk_bf16_f32 v202, v36, v37
  v_exp_f32 v40, v40
  v_exp_f32 v41, v41
  v_cvt_pk_bf16_f32 v203, v38, v39
  v_exp_f32 v42, v42
  v_exp_f32 v43, v43
  v_cvt_pk_bf16_f32 v204, v40, v41
  v_exp_f32 v44, v44
  v_exp_f32 v45, v45
  v_cvt_pk_bf16_f32 v205, v42, v43
  v_exp_f32 v46, v46
  v_exp_f32 v47, v47
  v_cvt_pk_bf16_f32 v206, v44, v45
  s_nop 0
  v_cvt_pk_bf16_f32 v207, v46, v47
  s_waitcnt lgkmcnt(0)
  s_nop 0
  v_mfma_f32_32x32x16_bf16 v[96:111], v[176:179], v[200:203], v[96:111]
  v_mfma_f32_32x32x16_bf16 v[96:111], v[180:183], v[204:207], v[96:111]
  s_branch Lx2_56
Lst_57:
  s_waitcnt lgkmcnt(0)
  s_nop 0
  v_mfma_f32_32x32x16_bf16 v[96:111], v[168:171], v[192:195], v[96:111]
  v_mfma_f32_32x32x16_bf16 v[96:111], v[172:175], v[196:199], v[96:111]
  s_branch Lx2_56
Lst_58:
  s_waitcnt lgkmcnt(0)
  s_nop 0
  v_mfma_f32_32x32x16_bf16 v[96:111], v[176:179], v[200:203], v[96:111]
  v_mfma_f32_32x32x16_bf16 v[96:111], v[180:183], v[204:207], v[96:111]
  s_branch Lx2_56
Lst_59:
  s_waitcnt lgkmcnt(0)
  s_nop 0
  v_mfma_f32_32x32x16_bf16 v[96:111], v[168:171], v[192:195], v[96:111]
  v_mfma_f32_32x32x16_bf16 v[96:111], v[172:175], v[196:199], v[96:111]
  s_branch Lx2_56
Lst_60:
  s_waitcnt lgkmcnt(0)
  s_nop 0
  v_mfma_f32_32x32x16_bf16 v[96:111], v[176:179], v[200:203], v[96:111]
  v_mfma_f32_32x32x16_bf16 v[96:111], v[180:183], v[204:207], v[96:111]
  s_branch Lx2_56
Lst_61:
  s_waitcnt lgkmcnt(0)
  s_nop 0
  v_mfma_f32_32x32x16_bf16 v[96:111], v[168:171], v[192:195], v[96:111]
  v_mfma_f32_32x32x16_bf16 v[96:111], v[172:175], v[196:199], v[96:111]
  s_branch Lx2_56
Lst_62:
  s_waitcnt lgkmcnt(0)
  s_nop 0
  v_mfma_f32_32x32x16_bf16 v[96:111], v[176:179], v[200:203], v[96:111]
  v_mfma_f32_32x32x16_bf16 v[96:111], v[180:183], v[204:207], v[96:111]
  s_branch Lx2_56
Lst_63:
  s_waitcnt lgkmcnt(0)
  s_nop 0
  v_mfma_f32_32x32x16_bf16 v[96:111], v[168:171], v[192:195], v[96:111]
  v_mfma_f32_32x32x16_bf16 v[96:111], v[172:175], v[196:199], v[96:111]
  s_branch Lx2_56
Lx2_56:
  s_waitcnt lgkmcnt(0)
Lafin_54:
  s_nop 13
  v_mov_b32 v4, v104
  v_mov_b32 v5, v104
  s_nop 1
  v_permlane32_swap_b32 v4, v5
  s_nop 1
  v_rcp_f32 v5, v5
  s_nop 0

  v_mul_f32 v96, v96, v5
  v_mul_f32 v97, v97, v5
  v_mul_f32 v98, v98, v5
  v_mul_f32 v99, v99, v5
  v_mul_f32 v100, v100, v5
  v_mul_f32 v101, v101, v5
  v_mul_f32 v102, v102, v5
  v_mul_f32 v103, v103, v5
  v_mul_f32 v104, v104, v5
  v_mul_f32 v105, v105, v5
  v_mul_f32 v106, v106, v5
  v_mul_f32 v107, v107, v5
  v_cvt_pk_bf16_f32 v192, v96, v97
  v_cvt_pk_bf16_f32 v193, v98, v99
  v_cvt_pk_bf16_f32 v194, v100, v101
  v_cvt_pk_bf16_f32 v195, v102, v103
  v_cvt_pk_bf16_f32 v196, v104, v105
  v_cvt_pk_bf16_f32 v197, v106, v107
  s_and_b32 s35, s49, 1
  s_lshl_b32 s37, s48, 2
  s_lshr_b32 s38, s50, 1
  s_add_u32 s37, s37, s38
  s_mul_i32 s37, s37, 81920
  s_add_u32 s37, s37, s32
  s_add_u32 s37, s37, 7864320
  s_and_b32 s38, s50, 1
  s_lshl_b32 s38, s38, 11
  s_add_u32 s37, s37, s38
  v_permlane32_swap_b32 v192, v194
  v_permlane32_swap_b32 v193, v195
  s_lshr_b32 s38, s49, 1
  s_mul_i32 s38, s38, 5
  s_lshl_b32 s39, s35, 1
  s_add_u32 s39, s39, s38
  v_and_b32 v4, 1, v3
  v_lshlrev_b32 v4, 10, v4
  v_lshl_add_u32 v4, v2, 4, v4
  v_lshrrev_b32 v5, 1, v3
  v_add_u32 v5, s39, v5
  v_lshrrev_b32 v6, 2, v5
  v_lshlrev_b32 v6, 12, v6
  v_and_b32 v5, 3, v5
  v_lshl_add_u32 v6, v5, 8, v6
  v_add_u32 v6, v6, v4
  buffer_store_dwordx4 v[192:195], v6, s[16:19], s37 offen sc0 sc1
  s_add_u32 s38, s38, 4
  s_lshr_b32 s39, s38, 2
  s_lshl_b32 s39, s39, 12
  s_and_b32 s38, s38, 3
  s_lshl_b32 s38, s38, 8
  s_add_u32 s39, s39, s38
  s_lshl_b32 s38, s35, 3
  s_add_u32 s39, s39, s38
  v_add_u32 v7, s39, v4
  s_mov_b32 exec_hi, 0
  buffer_store_dwordx2 v[196:197], v7, s[16:19], s37 offen sc0 sc1
  s_mov_b32 exec_hi, -1

  s_waitcnt vmcnt(0)
  s_lshl_b32 s43, s33, 12
  s_mul_i32 s41, s52, 81920
  s_add_u32 s41, s41, s32
  s_add_u32 s41, s41, 7864320
  s_add_u32 s41, s41, s43

  s_barrier
  s_cmp_lg_u32 s33, 0
  s_cbranch_scc1 Lnp_64
  s_lshl_b32 s34, s29, 2
  s_add_u32 s34, s34, s46
  s_add_u32 s34, s34, 8192
  v_mov_b32 v4, s34
  v_mov_b32 v5, s31
  s_mov_b64 exec, 1
  buffer_store_dword v5, v4, s[16:19], 0 offen offset:128
  buffer_store_dword v5, v4, s[16:19], 0 offen sc1
  s_mov_b64 exec, -1

  s_and_b32 s35, s28, 1
  s_lshl_b32 s35, s35, 9
  s_sub_u32 s34, s46, s35
  s_add_u32 s34, s34, 8192
  v_lshlrev_b32 v5, 9, v3
  v_lshl_add_u32 v5, v2, 2, v5
  v_add_u32 v48, s34, v5
  s_mov_b32 exec_lo, -1
  s_mov_b32 exec_hi, 0

Lpoll_66:
  buffer_load_dword v24, v48, s[16:19], 0 offen offset:128 sc1
  s_waitcnt vmcnt(0)
  v_cmp_ne_u32 vcc, s31, v24
  s_cmp_eq_u64 vcc, 0
  s_cbranch_scc1 Lpolled_65

  buffer_load_dword v24, v48, s[16:19], 0 offen offset:128 sc1
  s_waitcnt vmcnt(0)
  v_cmp_ne_u32 vcc, s31, v24
  s_cmp_eq_u64 vcc, 0
  s_cbranch_scc1 Lpolled_65

  buffer_load_dword v24, v48, s[16:19], 0 offen offset:128 sc1
  s_waitcnt vmcnt(0)
  v_cmp_ne_u32 vcc, s31, v24
  s_cmp_eq_u64 vcc, 0
  s_cbranch_scc1 Lpolled_65

  buffer_load_dword v24, v48, s[16:19], 0 offen sc1
  s_waitcnt vmcnt(0)
  v_cmp_ne_u32 vcc, s31, v24
  s_cmp_eq_u64 vcc, 0
  s_cbranch_scc0 Lpoll_66

Lpolled_65:
  s_mov_b64 exec, -1
Lnp_64:
  s_barrier
  s_add_u32 m0, s43, 86016
  s_add_u32 s34, s41, 0
  buffer_load_dwordx4 v1, s[16:19], s34 offen sc1 lds
  buffer_load_dwordx4 v1, s[16:19], s34 offen offset:1024 sc1 lds
  buffer_load_dwordx4 v1, s[16:19], s34 offen offset:2048 sc1 lds
  buffer_load_dwordx4 v1, s[16:19], s34 offen offset:3072 sc1 lds
  s_add_u32 m0, s43, 102400
  s_add_u32 s34, s41, 16384
  buffer_load_dwordx4 v1, s[16:19], s34 offen sc1 lds
  buffer_load_dwordx4 v1, s[16:19], s34 offen offset:1024 sc1 lds
  buffer_load_dwordx4 v1, s[16:19], s34 offen offset:2048 sc1 lds
  buffer_load_dwordx4 v1, s[16:19], s34 offen offset:3072 sc1 lds
  s_waitcnt vmcnt(4)
  s_barrier
  s_add_u32 m0, s43, 118784
  s_add_u32 s34, s41, 32768
  buffer_load_dwordx4 v1, s[16:19], s34 offen sc1 lds
  buffer_load_dwordx4 v1, s[16:19], s34 offen offset:1024 sc1 lds
  buffer_load_dwordx4 v1, s[16:19], s34 offen offset:2048 sc1 lds
  buffer_load_dwordx4 v1, s[16:19], s34 offen offset:3072 sc1 lds
  s_add_u32 m0, s43, 135168
  s_add_u32 s34, s41, 49152
  buffer_load_dwordx4 v1, s[16:19], s34 offen sc1 lds
  buffer_load_dwordx4 v1, s[16:19], s34 offen offset:1024 sc1 lds
  buffer_load_dwordx4 v1, s[16:19], s34 offen offset:2048 sc1 lds
  buffer_load_dwordx4 v1, s[16:19], s34 offen offset:3072 sc1 lds
  s_waitcnt vmcnt(8)
  s_barrier
  s_add_u32 m0, s42, 4096
  s_add_u32 s34, s40, 81920
  buffer_load_dwordx4 v1, s[16:19], s34 offen sc1 lds
  buffer_load_dwordx4 v1, s[16:19], s34 offen offset:1024 sc1 lds
  buffer_load_dwordx4 v1, s[16:19], s34 offen offset:2048 sc1 lds
  buffer_load_dwordx4 v1, s[16:19], s34 offen offset:3072 sc1 lds
  s_add_u32 m0, s42, 8192
  s_add_u32 s34, s40, 86016
  buffer_load_dwordx4 v1, s[16:19], s34 offen sc1 lds
  s_add_u32 m0, s43, 86016
  s_add_u32 s34, s41, 65536
  buffer_load_dwordx4 v1, s[16:19], s34 offen sc1 lds
  buffer_load_dwordx4 v1, s[16:19], s34 offen offset:1024 sc1 lds
  buffer_load_dwordx4 v1, s[16:19], s34 offen offset:2048 sc1 lds
  buffer_load_dwordx4 v1, s[16:19], s34 offen offset:3072 sc1 lds
  s_waitcnt vmcnt(13)
  s_barrier
  s_waitcnt vmcnt(9)
  s_barrier
  s_waitcnt vmcnt(0)
  s_barrier
  s_waitcnt lgkmcnt(0)
  s_barrier
  s_mul_i32 s42, s33, 6144
  s_mul_i32 s40, s29, 245760
  s_add_u32 s40, s40, 1212416
  s_add_u32 s40, s40, s42

  s_add_u32 m0, s42, 4096
  s_add_u32 s34, s40, 0
  buffer_load_dwordx4 v1, s[16:19], s34 offen sc1 lds
  buffer_load_dwordx4 v1, s[16:19], s34 offen offset:1024 sc1 lds
  buffer_load_dwordx4 v1, s[16:19], s34 offen offset:2048 sc1 lds
  buffer_load_dwordx4 v1, s[16:19], s34 offen offset:3072 sc1 lds
  s_add_u32 m0, s42, 8192
  s_add_u32 s34, s40, 4096
  buffer_load_dwordx4 v1, s[16:19], s34 offen sc1 lds
  buffer_load_dwordx4 v1, s[16:19], s34 offen offset:1024 sc1 lds
  s_add_u32 m0, s42, 28672
  s_add_u32 s34, s40, 24576
  buffer_load_dwordx4 v1, s[16:19], s34 offen sc1 lds
  buffer_load_dwordx4 v1, s[16:19], s34 offen offset:1024 sc1 lds
  buffer_load_dwordx4 v1, s[16:19], s34 offen offset:2048 sc1 lds
  buffer_load_dwordx4 v1, s[16:19], s34 offen offset:3072 sc1 lds
  s_add_u32 m0, s42, 32768
  s_add_u32 s34, s40, 28672
  buffer_load_dwordx4 v1, s[16:19], s34 offen sc1 lds
  buffer_load_dwordx4 v1, s[16:19], s34 offen offset:1024 sc1 lds
  s_add_u32 m0, s42, 53248
  s_add_u32 s34, s40, 49152
  buffer_load_dwordx4 v1, s[16:19], s34 offen sc1 lds
  buffer_load_dwordx4 v1, s[16:19], s34 offen offset:1024 sc1 lds
  buffer_load_dwordx4 v1, s[16:19], s34 offen offset:2048 sc1 lds
  buffer_load_dwordx4 v1, s[16:19], s34 offen offset:3072 sc1 lds
  s_add_u32 m0, s42, 57344
  s_add_u32 s34, s40, 53248
  buffer_load_dwordx4 v1, s[16:19], s34 offen sc1 lds
  buffer_load_dwordx4 v1, s[16:19], s34 offen offset:1024 sc1 lds
  s_lshl_b32 s43, s33, 12
  s_mul_i32 s41, s28, 163840
  s_add_u32 s41, s41, s32
  s_add_u32 s41, s41, 10485760
  s_add_u32 s41, s41, s43

  s_add_u32 s45, s32, 22020096
  s_barrier
  s_cmp_lg_u32 s33, 0
  s_cbranch_scc1 Lnp_67
  s_lshl_b32 s34, s29, 2
  s_add_u32 s34, s34, s46
  s_add_u32 s34, s34, 16384
  v_mov_b32 v4, s34
  v_mov_b32 v5, s31
  s_mov_b64 exec, 1
  buffer_store_dword v5, v4, s[16:19], 0 offen offset:128
  buffer_store_dword v5, v4, s[16:19], 0 offen sc1
  s_mov_b64 exec, -1

  s_add_u32 s34, s46, 16384
  v_lshl_add_u32 v48, v0, 2, s34
  s_mov_b64 exec, 0xffff

Lpoll_69:
  buffer_load_dword v24, v48, s[16:19], 0 offen offset:128 sc1
  s_waitcnt vmcnt(0)
  v_cmp_ne_u32 vcc, s31, v24
  s_cmp_eq_u64 vcc, 0
  s_cbranch_scc1 Lpolled_68

  buffer_load_dword v24, v48, s[16:19], 0 offen offset:128 sc1
  s_waitcnt vmcnt(0)
  v_cmp_ne_u32 vcc, s31, v24
  s_cmp_eq_u64 vcc, 0
  s_cbranch_scc1 Lpolled_68

  buffer_load_dword v24, v48, s[16:19], 0 offen offset:128 sc1
  s_waitcnt vmcnt(0)
  v_cmp_ne_u32 vcc, s31, v24
  s_cmp_eq_u64 vcc, 0
  s_cbranch_scc1 Lpolled_68

  buffer_load_dword v24, v48, s[16:19], 0 offen sc1
  s_waitcnt vmcnt(0)
  v_cmp_ne_u32 vcc, s31, v24
  s_cmp_eq_u64 vcc, 0
  s_cbranch_scc0 Lpoll_69

Lpolled_68:
  s_mov_b64 exec, -1
Lnp_67:
  s_barrier
  s_add_u32 m0, s43, 86016
  s_add_u32 s34, s41, 0
  buffer_load_dwordx4 v1, s[16:19], s34 offen sc1 lds
  buffer_load_dwordx4 v1, s[16:19], s34 offen offset:1024 sc1 lds
  buffer_load_dwordx4 v1, s[16:19], s34 offen offset:2048 sc1 lds
  buffer_load_dwordx4 v1, s[16:19], s34 offen offset:3072 sc1 lds
  s_add_u32 m0, s43, 102400
  s_add_u32 s34, s41, 16384
  buffer_load_dwordx4 v1, s[16:19], s34 offen sc1 lds
  buffer_load_dwordx4 v1, s[16:19], s34 offen offset:1024 sc1 lds
  buffer_load_dwordx4 v1, s[16:19], s34 offen offset:2048 sc1 lds
  buffer_load_dwordx4 v1, s[16:19], s34 offen offset:3072 sc1 lds
  s_waitcnt vmcnt(4)
  s_barrier
  s_add_u32 m0, s43, 118784
  s_add_u32 s34, s41, 32768
  buffer_load_dwordx4 v1, s[16:19], s34 offen sc1 lds
  buffer_load_dwordx4 v1, s[16:19], s34 offen offset:1024 sc1 lds
  buffer_load_dwordx4 v1, s[16:19], s34 offen offset:2048 sc1 lds
  buffer_load_dwordx4 v1, s[16:19], s34 offen offset:3072 sc1 lds
  s_add_u32 m0, s43, 135168
  s_add_u32 s34, s41, 49152
  buffer_load_dwordx4 v1, s[16:19], s34 offen sc1 lds
  buffer_load_dwordx4 v1, s[16:19], s34 offen offset:1024 sc1 lds
  buffer_load_dwordx4 v1, s[16:19], s34 offen offset:2048 sc1 lds
  buffer_load_dwordx4 v1, s[16:19], s34 offen offset:3072 sc1 lds
  v_lshrrev_b32 v4, 1, v3
  v_lshlrev_b32 v4, 10, v4
  v_and_b32 v5, 1, v3
  v_lshl_add_u32 v4, v5, 9, v4
  v_lshl_add_u32 v4, v2, 3, v4
  s_lshl_b32 s35, s28, 13
  s_add_u32 s35, s35, s45
  s_lshl_b32 s36, s33, 11
  s_add_u32 s35, s35, s36

  buffer_load_dwordx2 v[16:17], v4, s[16:19], s35 offen offset:0 sc1
  buffer_load_dwordx2 v[18:19], v4, s[16:19], s35 offen offset:128 sc1
  buffer_load_dwordx2 v[20:21], v4, s[16:19], s35 offen offset:256 sc1
  buffer_load_dwordx2 v[22:23], v4, s[16:19], s35 offen offset:384 sc1
  v_mul_u32_u24 v4, 12288, v3
  v_lshl_add_u32 v4, v2, 2, v4
  s_lshr_b32 s35, s33, 1
  s_mul_i32 s35, s35, 6144
  s_mul_i32 s36, s29, 384
  s_add_u32 s35, s35, s36
  s_and_b32 s36, s33, 1
  s_mul_i32 s36, s36, 192
  s_add_u32 s35, s35, s36
  s_add_u32 s35, s35, 10485760

  buffer_load_dword v28, v4, s[16:19], s35 offen offset:0 sc1
  buffer_load_dword v29, v4, s[16:19], s35 offen offset:64 sc1
  buffer_load_dword v30, v4, s[16:19], s35 offen offset:128 sc1
  s_add_u32 s35, s35, 49152
  buffer_load_dword v31, v4, s[16:19], s35 offen offset:0 sc1
  buffer_load_dword v32, v4, s[16:19], s35 offen offset:64 sc1
  buffer_load_dword v33, v4, s[16:19], s35 offen offset:128 sc1
  s_add_u32 s35, s35, 49152
  buffer_load_dword v34, v4, s[16:19], s35 offen offset:0 sc1
  buffer_load_dword v35, v4, s[16:19], s35 offen offset:64 sc1
  buffer_load_dword v36, v4, s[16:19], s35 offen offset:128 sc1
  s_add_u32 s35, s35, 49152
  buffer_load_dword v37, v4, s[16:19], s35 offen offset:0 sc1
  buffer_load_dword v38, v4, s[16:19], s35 offen offset:64 sc1
  buffer_load_dword v39, v4, s[16:19], s35 offen offset:128 sc1
  s_add_u32 s35, s35, 49152
  buffer_load_dword v40, v4, s[16:19], s35 offen offset:0 sc1
  buffer_load_dword v41, v4, s[16:19], s35 offen offset:64 sc1
  buffer_load_dword v42, v4, s[16:19], s35 offen offset:128 sc1
  s_waitcnt vmcnt(27)
  s_barrier
  s_add_u32 m0, s42, 4096
  s_add_u32 s34, s40, 73728
  buffer_load_dwordx4 v1, s[16:19], s34 offen sc1 lds
  buffer_load_dwordx4 v1, s[16:19], s34 offen offset:1024 sc1 lds
  buffer_load_dwordx4 v1, s[16:19], s34 offen offset:2048 sc1 lds
  buffer_load_dwordx4 v1, s[16:19], s34 offen offset:3072 sc1 lds
  s_add_u32 m0, s42, 8192
  s_add_u32 s34, s40, 77824
  buffer_load_dwordx4 v1, s[16:19], s34 offen sc1 lds
  buffer_load_dwordx4 v1, s[16:19], s34 offen offset:1024 sc1 lds
  s_add_u32 m0, s43, 86016
  s_add_u32 s34, s41, 65536
  buffer_load_dwordx4 v1, s[16:19], s34 offen sc1 lds
  buffer_load_dwordx4 v1, s[16:19], s34 offen offset:1024 sc1 lds
  buffer_load_dwordx4 v1, s[16:19], s34 offen offset:2048 sc1 lds
  buffer_load_dwordx4 v1, s[16:19], s34 offen offset:3072 sc1 lds
  s_waitcnt vmcnt(33)
  s_barrier
  s_add_u32 m0, s42, 28672
  s_add_u32 s34, s40, 98304
  buffer_load_dwordx4 v1, s[16:19], s34 offen sc1 lds
  buffer_load_dwordx4 v1, s[16:19], s34 offen offset:1024 sc1 lds
  buffer_load_dwordx4 v1, s[16:19], s34 offen offset:2048 sc1 lds
  buffer_load_dwordx4 v1, s[16:19], s34 offen offset:3072 sc1 lds
  s_add_u32 m0, s42, 32768
  s_add_u32 s34, s40, 102400
  buffer_load_dwordx4 v1, s[16:19], s34 offen sc1 lds
  buffer_load_dwordx4 v1, s[16:19], s34 offen offset:1024 sc1 lds
  s_add_u32 m0, s43, 102400
  s_add_u32 s34, s41, 81920
  buffer_load_dwordx4 v1, s[16:19], s34 offen sc1 lds
  buffer_load_dwordx4 v1, s[16:19], s34 offen offset:1024 sc1 lds
  buffer_load_dwordx4 v1, s[16:19], s34 offen offset:2048 sc1 lds
  buffer_load_dwordx4 v1, s[16:19], s34 offen offset:3072 sc1 lds
  s_waitcnt vmcnt(14)
  s_barrier
  s_add_u32 m0, s42, 53248
  s_add_u32 s34, s40, 122880
  buffer_load_dwordx4 v1, s[16:19], s34 offen sc1 lds
  buffer_load_dwordx4 v1, s[16:19], s34 offen offset:1024 sc1 lds
  buffer_load_dwordx4 v1, s[16:19], s34 offen offset:2048 sc1 lds
  buffer_load_dwordx4 v1, s[16:19], s34 offen offset:3072 sc1 lds
  s_add_u32 m0, s42, 57344
  s_add_u32 s34, s40, 126976
  buffer_load_dwordx4 v1, s[16:19], s34 offen sc1 lds
  buffer_load_dwordx4 v1, s[16:19], s34 offen offset:1024 sc1 lds
  s_add_u32 m0, s43, 118784
  s_add_u32 s34, s41, 98304
  buffer_load_dwordx4 v1, s[16:19], s34 offen sc1 lds
  buffer_load_dwordx4 v1, s[16:19], s34 offen offset:1024 sc1 lds
  buffer_load_dwordx4 v1, s[16:19], s34 offen offset:2048 sc1 lds
  buffer_load_dwordx4 v1, s[16:19], s34 offen offset:3072 sc1 lds
  v_add_f32 v16, v16, v18
  v_add_f32 v17, v17, v19
  v_add_f32 v20, v20, v22
  v_add_f32 v21, v21, v23
  v_add_f32 v16, v16, v20
  v_add_f32 v17, v17, v21
  v_mov_b32 v18, v16
  v_mov_b32 v19, v17
  s_nop 1
  v_permlane16_swap_b32 v16, v18
  v_permlane16_swap_b32 v17, v19
  s_nop 1
  v_add_f32 v16, v16, v18
  v_add_f32 v17, v17, v19

  s_mov_b32 s61, 0x3acccccd
  s_mov_b32 s62, 0x3727c5ac
  v_mul_f32 v16, s61, v16
  v_mul_f32 v17, s61, v17
  v_fma_f32 v17, -v16, v16, v17
  v_max_f32 v17, 0, v17

  v_cvt_pk_bf16_f32 v4, v16, v16
  v_lshlrev_b32 v16, 16, v4
  v_cvt_pk_bf16_f32 v4, v17, v17
  v_lshlrev_b32 v17, 16, v4
  v_add_f32 v17, s62, v17
  v_cvt_pk_bf16_f32 v4, v17, v17
  v_lshlrev_b32 v17, 16, v4
  v_sqrt_f32 v17, v17
  s_nop 0
  v_cvt_pk_bf16_f32 v4, v17, v17
  v_lshlrev_b32 v17, 16, v4
  v_rcp_f32 v17, v17
  v_lshrrev_b32 v4, 1, v3
  v_lshlrev_b32 v4, 6, v4
  v_lshl_add_u32 v4, v2, 2, v4
  s_lshl_b32 s35, s33, 7
  v_add_u32 v4, s35, v4
  s_mov_b32 exec_lo, 0xffff
  s_mov_b32 exec_hi, 0xffff

  ds_write_b32 v4, v16 offset:0
  ds_write_b32 v4, v17 offset:1024
  s_mov_b64 exec, -1

  s_waitcnt vmcnt(14)
  s_barrier
  s_add_u32 m0, s42, 4096
  s_add_u32 s34, s40, 147456
  buffer_load_dwordx4 v1, s[16:19], s34 offen sc1 lds
  buffer_load_dwordx4 v1, s[16:19], s34 offen offset:1024 sc1 lds
  buffer_load_dwordx4 v1, s[16:19], s34 offen offset:2048 sc1 lds
  buffer_load_dwordx4 v1, s[16:19], s34 offen offset:3072 sc1 lds
  s_add_u32 m0, s42, 8192
  s_add_u32 s34, s40, 151552
  buffer_load_dwordx4 v1, s[16:19], s34 offen sc1 lds
  buffer_load_dwordx4 v1, s[16:19], s34 offen offset:1024 sc1 lds
  s_add_u32 m0, s43, 135168
  s_add_u32 s34, s41, 114688
  buffer_load_dwordx4 v1, s[16:19], s34 offen sc1 lds
  buffer_load_dwordx4 v1, s[16:19], s34 offen offset:1024 sc1 lds
  buffer_load_dwordx4 v1, s[16:19], s34 offen offset:2048 sc1 lds
  buffer_load_dwordx4 v1, s[16:19], s34 offen offset:3072 sc1 lds
  v_add_f32 v28, v28, v31
  v_add_f32 v34, v34, v37
  v_add_f32 v29, v29, v32
  v_add_f32 v35, v35, v38
  v_add_f32 v30, v30, v33
  v_add_f32 v36, v36, v39
  v_add_f32 v28, v28, v40
  v_add_f32 v29, v29, v41
  v_add_f32 v30, v30, v42
  v_add_f32 v28, v28, v34
  v_add_f32 v29, v29, v35
  v_add_f32 v30, v30, v36
  v_mov_b32 v4, v28
  s_nop 1
  v_permlane16_swap_b32 v28, v4
  s_nop 1
  v_add_f32 v28, v28, v4
  v_mov_b32 v4, v28
  s_nop 1
  v_permlane32_swap_b32 v28, v4
  s_nop 1
  v_add_f32 v28, v28, v4

  v_mov_b32 v4, v29
  s_nop 1
  v_permlane16_swap_b32 v29, v4
  s_nop 1
  v_add_f32 v29, v29, v4
  v_mov_b32 v4, v29
  s_nop 1
  v_permlane32_swap_b32 v29, v4
  s_nop 1
  v_add_f32 v29, v29, v4

  v_mov_b32 v4, v30
  s_nop 1
  v_permlane16_swap_b32 v30, v4
  s_nop 1
  v_add_f32 v30, v30, v4
  v_mov_b32 v4, v30
  s_nop 1
  v_permlane32_swap_b32 v30, v4
  s_nop 1
  v_add_f32 v30, v30, v4

  s_mul_i32 s35, s33, 192
  v_lshl_add_u32 v4, v2, 2, s35
  s_mov_b64 exec, 0xffff
  ds_write_b32 v4, v28 offset:2304
  ds_write_b32 v4, v29 offset:2368
  ds_write_b32 v4, v30 offset:2432
  s_mov_b64 exec, -1

  s_waitcnt vmcnt(14)
  s_barrier
  s_add_u32 m0, s42, 28672
  s_add_u32 s34, s40, 172032
  buffer_load_dwordx4 v1, s[16:19], s34 offen sc1 lds
  buffer_load_dwordx4 v1, s[16:19], s34 offen offset:1024 sc1 lds
  buffer_load_dwordx4 v1, s[16:19], s34 offen offset:2048 sc1 lds
  buffer_load_dwordx4 v1, s[16:19], s34 offen offset:3072 sc1 lds
  s_add_u32 m0, s42, 32768
  s_add_u32 s34, s40, 176128
  buffer_load_dwordx4 v1, s[16:19], s34 offen sc1 lds
  buffer_load_dwordx4 v1, s[16:19], s34 offen offset:1024 sc1 lds
  s_add_u32 m0, s43, 86016
  s_add_u32 s34, s41, 131072
  buffer_load_dwordx4 v1, s[16:19], s34 offen sc1 lds
  buffer_load_dwordx4 v1, s[16:19], s34 offen offset:1024 sc1 lds
  buffer_load_dwordx4 v1, s[16:19], s34 offen offset:2048 sc1 lds
  buffer_load_dwordx4 v1, s[16:19], s34 offen offset:3072 sc1 lds
  s_waitcnt vmcnt(14)
  s_barrier
  s_add_u32 m0, s42, 53248
  s_add_u32 s34, s40, 196608
  buffer_load_dwordx4 v1, s[16:19], s34 offen sc1 lds
  buffer_load_dwordx4 v1, s[16:19], s34 offen offset:1024 sc1 lds
  buffer_load_dwordx4 v1, s[16:19], s34 offen offset:2048 sc1 lds
  buffer_load_dwordx4 v1, s[16:19], s34 offen offset:3072 sc1 lds
  s_add_u32 m0, s42, 57344
  s_add_u32 s34, s40, 200704
  buffer_load_dwordx4 v1, s[16:19], s34 offen sc1 lds
  buffer_load_dwordx4 v1, s[16:19], s34 offen offset:1024 sc1 lds
  s_add_u32 m0, s43, 102400
  s_add_u32 s34, s41, 147456
  buffer_load_dwordx4 v1, s[16:19], s34 offen sc1 lds
  buffer_load_dwordx4 v1, s[16:19], s34 offen offset:1024 sc1 lds
  buffer_load_dwordx4 v1, s[16:19], s34 offen offset:2048 sc1 lds
  buffer_load_dwordx4 v1, s[16:19], s34 offen offset:3072 sc1 lds
  s_waitcnt vmcnt(14)
  s_barrier
  s_add_u32 m0, s42, 4096
  s_add_u32 s34, s40, 221184
  buffer_load_dwordx4 v1, s[16:19], s34 offen sc1 lds
  buffer_load_dwordx4 v1, s[16:19], s34 offen offset:1024 sc1 lds
  buffer_load_dwordx4 v1, s[16:19], s34 offen offset:2048 sc1 lds
  buffer_load_dwordx4 v1, s[16:19], s34 offen offset:3072 sc1 lds
  s_add_u32 m0, s42, 8192
  s_add_u32 s34, s40, 225280
  buffer_load_dwordx4 v1, s[16:19], s34 offen sc1 lds
  buffer_load_dwordx4 v1, s[16:19], s34 offen offset:1024 sc1 lds
  s_waitcnt vmcnt(10)
  s_barrier
  s_waitcnt vmcnt(0)
  s_barrier
  s_waitcnt lgkmcnt(0)
  s_barrier
  s_mul_i32 s42, s33, 5120
  s_mul_i32 s40, s53, 245760
  s_add_u32 s40, s40, 5144576
  s_add_u32 s40, s40, s42

  s_add_u32 m0, s42, 4096
  s_add_u32 s34, s40, 0
  buffer_load_dwordx4 v1, s[16:19], s34 offen sc1 lds
  buffer_load_dwordx4 v1, s[16:19], s34 offen offset:1024 sc1 lds
  buffer_load_dwordx4 v1, s[16:19], s34 offen offset:2048 sc1 lds
  buffer_load_dwordx4 v1, s[16:19], s34 offen offset:3072 sc1 lds
  s_add_u32 m0, s42, 8192
  s_add_u32 s34, s40, 4096
  buffer_load_dwordx4 v1, s[16:19], s34 offen sc1 lds
  s_add_u32 m0, s42, 24576
  s_add_u32 s34, s40, 20480
  buffer_load_dwordx4 v1, s[16:19], s34 offen sc1 lds
  buffer_load_dwordx4 v1, s[16:19], s34 offen offset:1024 sc1 lds
  buffer_load_dwordx4 v1, s[16:19], s34 offen offset:2048 sc1 lds
  buffer_load_dwordx4 v1, s[16:19], s34 offen offset:3072 sc1 lds
  s_add_u32 m0, s42, 28672
  s_add_u32 s34, s40, 24576
  buffer_load_dwordx4 v1, s[16:19], s34 offen sc1 lds
  s_add_u32 m0, s42, 45056
  s_add_u32 s34, s40, 40960
  buffer_load_dwordx4 v1, s[16:19], s34 offen sc1 lds
  buffer_load_dwordx4 v1, s[16:19], s34 offen offset:1024 sc1 lds
  buffer_load_dwordx4 v1, s[16:19], s34 offen offset:2048 sc1 lds
  buffer_load_dwordx4 v1, s[16:19], s34 offen offset:3072 sc1 lds
  s_add_u32 m0, s42, 49152
  s_add_u32 s34, s40, 45056
  buffer_load_dwordx4 v1, s[16:19], s34 offen sc1 lds
  s_add_u32 m0, s42, 65536
  s_add_u32 s34, s40, 61440
  buffer_load_dwordx4 v1, s[16:19], s34 offen sc1 lds
  buffer_load_dwordx4 v1, s[16:19], s34 offen offset:1024 sc1 lds
  buffer_load_dwordx4 v1, s[16:19], s34 offen offset:2048 sc1 lds
  buffer_load_dwordx4 v1, s[16:19], s34 offen offset:3072 sc1 lds
  s_add_u32 m0, s42, 69632
  s_add_u32 s34, s40, 65536
  buffer_load_dwordx4 v1, s[16:19], s34 offen sc1 lds
  s_lshl_b32 s43, s33, 12
  s_mul_i32 s41, s52, 196608
  s_add_u32 s41, s41, s32
  s_add_u32 s41, s41, 13107200
  s_add_u32 s41, s41, s43

  s_barrier
  s_cmp_lg_u32 s33, 0
  s_cbranch_scc1 Lnp_70
  s_lshl_b32 s34, s29, 2
  s_add_u32 s34, s34, s46
  s_add_u32 s34, s34, 24576
  v_mov_b32 v4, s34
  v_mov_b32 v5, s31
  s_mov_b64 exec, 1
  buffer_store_dword v5, v4, s[16:19], 0 offen offset:128
  buffer_store_dword v5, v4, s[16:19], 0 offen sc1
  s_mov_b64 exec, -1

  s_add_u32 s34, s46, 24576
  v_lshl_add_u32 v48, v0, 2, s34
  s_mov_b64 exec, 0xffff

Lpoll_72:
  buffer_load_dword v24, v48, s[16:19], 0 offen offset:128 sc1
  s_waitcnt vmcnt(0)
  v_cmp_ne_u32 vcc, s31, v24
  s_cmp_eq_u64 vcc, 0
  s_cbranch_scc1 Lpolled_71

  buffer_load_dword v24, v48, s[16:19], 0 offen offset:128 sc1
  s_waitcnt vmcnt(0)
  v_cmp_ne_u32 vcc, s31, v24
  s_cmp_eq_u64 vcc, 0
  s_cbranch_scc1 Lpolled_71

  buffer_load_dword v24, v48, s[16:19], 0 offen offset:128 sc1
  s_waitcnt vmcnt(0)
  v_cmp_ne_u32 vcc, s31, v24
  s_cmp_eq_u64 vcc, 0
  s_cbranch_scc1 Lpolled_71

  buffer_load_dword v24, v48, s[16:19], 0 offen sc1
  s_waitcnt vmcnt(0)
  v_cmp_ne_u32 vcc, s31, v24
  s_cmp_eq_u64 vcc, 0
  s_cbranch_scc0 Lpoll_72

Lpolled_71:
  s_mov_b64 exec, -1
Lnp_70:
  s_barrier
  s_add_u32 m0, s43, 86016
  s_add_u32 s34, s41, 0
  buffer_load_dwordx4 v1, s[16:19], s34 offen sc1 lds
  buffer_load_dwordx4 v1, s[16:19], s34 offen offset:1024 sc1 lds
  buffer_load_dwordx4 v1, s[16:19], s34 offen offset:2048 sc1 lds
  buffer_load_dwordx4 v1, s[16:19], s34 offen offset:3072 sc1 lds
  s_add_u32 m0, s43, 102400
  s_add_u32 s34, s41, 16384
  buffer_load_dwordx4 v1, s[16:19], s34 offen sc1 lds
  buffer_load_dwordx4 v1, s[16:19], s34 offen offset:1024 sc1 lds
  buffer_load_dwordx4 v1, s[16:19], s34 offen offset:2048 sc1 lds
  buffer_load_dwordx4 v1, s[16:19], s34 offen offset:3072 sc1 lds
  s_waitcnt vmcnt(4)
  s_barrier
  s_add_u32 m0, s43, 118784
  s_add_u32 s34, s41, 32768
  buffer_load_dwordx4 v1, s[16:19], s34 offen sc1 lds
  buffer_load_dwordx4 v1, s[16:19], s34 offen offset:1024 sc1 lds
  buffer_load_dwordx4 v1, s[16:19], s34 offen offset:2048 sc1 lds
  buffer_load_dwordx4 v1, s[16:19], s34 offen offset:3072 sc1 lds
  s_add_u32 m0, s43, 135168
  s_add_u32 s34, s41, 49152
  buffer_load_dwordx4 v1, s[16:19], s34 offen sc1 lds
  buffer_load_dwordx4 v1, s[16:19], s34 offen offset:1024 sc1 lds
  buffer_load_dwordx4 v1, s[16:19], s34 offen offset:2048 sc1 lds
  buffer_load_dwordx4 v1, s[16:19], s34 offen offset:3072 sc1 lds
  s_waitcnt vmcnt(8)
  s_barrier
  s_add_u32 m0, s42, 4096
  s_add_u32 s34, s40, 81920
  buffer_load_dwordx4 v1, s[16:19], s34 offen sc1 lds
  buffer_load_dwordx4 v1, s[16:19], s34 offen offset:1024 sc1 lds
  buffer_load_dwordx4 v1, s[16:19], s34 offen offset:2048 sc1 lds
  buffer_load_dwordx4 v1, s[16:19], s34 offen offset:3072 sc1 lds
  s_add_u32 m0, s42, 8192
  s_add_u32 s34, s40, 86016
  buffer_load_dwordx4 v1, s[16:19], s34 offen sc1 lds
  s_add_u32 m0, s43, 86016
  s_add_u32 s34, s41, 65536
  buffer_load_dwordx4 v1, s[16:19], s34 offen sc1 lds
  buffer_load_dwordx4 v1, s[16:19], s34 offen offset:1024 sc1 lds
  buffer_load_dwordx4 v1, s[16:19], s34 offen offset:2048 sc1 lds
  buffer_load_dwordx4 v1, s[16:19], s34 offen offset:3072 sc1 lds
  s_waitcnt vmcnt(13)
  s_barrier
  s_add_u32 m0, s42, 24576
  s_add_u32 s34, s40, 102400
  buffer_load_dwordx4 v1, s[16:19], s34 offen sc1 lds
  buffer_load_dwordx4 v1, s[16:19], s34 offen offset:1024 sc1 lds
  buffer_load_dwordx4 v1, s[16:19], s34 offen offset:2048 sc1 lds
  buffer_load_dwordx4 v1, s[16:19], s34 offen offset:3072 sc1 lds
  s_add_u32 m0, s42, 28672
  s_add_u32 s34, s40, 106496
  buffer_load_dwordx4 v1, s[16:19], s34 offen sc1 lds
  s_add_u32 m0, s43, 102400
  s_add_u32 s34, s41, 81920
  buffer_load_dwordx4 v1, s[16:19], s34 offen sc1 lds
  buffer_load_dwordx4 v1, s[16:19], s34 offen offset:1024 sc1 lds
  buffer_load_dwordx4 v1, s[16:19], s34 offen offset:2048 sc1 lds
  buffer_load_dwordx4 v1, s[16:19], s34 offen offset:3072 sc1 lds
  s_waitcnt vmcnt(18)
  s_barrier
  s_add_u32 m0, s42, 45056
  s_add_u32 s34, s40, 122880
  buffer_load_dwordx4 v1, s[16:19], s34 offen sc1 lds
  buffer_load_dwordx4 v1, s[16:19], s34 offen offset:1024 sc1 lds
  buffer_load_dwordx4 v1, s[16:19], s34 offen offset:2048 sc1 lds
  buffer_load_dwordx4 v1, s[16:19], s34 offen offset:3072 sc1 lds
  s_add_u32 m0, s42, 49152
  s_add_u32 s34, s40, 126976
  buffer_load_dwordx4 v1, s[16:19], s34 offen sc1 lds
  s_add_u32 m0, s43, 118784
  s_add_u32 s34, s41, 98304
  buffer_load_dwordx4 v1, s[16:19], s34 offen sc1 lds
  buffer_load_dwordx4 v1, s[16:19], s34 offen offset:1024 sc1 lds
  buffer_load_dwordx4 v1, s[16:19], s34 offen offset:2048 sc1 lds
  buffer_load_dwordx4 v1, s[16:19], s34 offen offset:3072 sc1 lds
  s_waitcnt vmcnt(18)
  s_barrier
  s_add_u32 m0, s42, 65536
  s_add_u32 s34, s40, 143360
  buffer_load_dwordx4 v1, s[16:19], s34 offen sc1 lds
  buffer_load_dwordx4 v1, s[16:19], s34 offen offset:1024 sc1 lds
  buffer_load_dwordx4 v1, s[16:19], s34 offen offset:2048 sc1 lds
  buffer_load_dwordx4 v1, s[16:19], s34 offen offset:3072 sc1 lds
  s_add_u32 m0, s42, 69632
  s_add_u32 s34, s40, 147456
  buffer_load_dwordx4 v1, s[16:19], s34 offen sc1 lds
  s_add_u32 m0, s43, 135168
  s_add_u32 s34, s41, 114688
  buffer_load_dwordx4 v1, s[16:19], s34 offen sc1 lds
  buffer_load_dwordx4 v1, s[16:19], s34 offen offset:1024 sc1 lds
  buffer_load_dwordx4 v1, s[16:19], s34 offen offset:2048 sc1 lds
  buffer_load_dwordx4 v1, s[16:19], s34 offen offset:3072 sc1 lds
  s_waitcnt vmcnt(18)
  s_barrier
  s_add_u32 m0, s42, 4096
  s_add_u32 s34, s40, 163840
  buffer_load_dwordx4 v1, s[16:19], s34 offen sc1 lds
  buffer_load_dwordx4 v1, s[16:19], s34 offen offset:1024 sc1 lds
  buffer_load_dwordx4 v1, s[16:19], s34 offen offset:2048 sc1 lds
  buffer_load_dwordx4 v1, s[16:19], s34 offen offset:3072 sc1 lds
  s_add_u32 m0, s42, 8192
  s_add_u32 s34, s40, 167936
  buffer_load_dwordx4 v1, s[16:19], s34 offen sc1 lds
  s_add_u32 m0, s43, 86016
  s_add_u32 s34, s41, 131072
  buffer_load_dwordx4 v1, s[16:19], s34 offen sc1 lds
  buffer_load_dwordx4 v1, s[16:19], s34 offen offset:1024 sc1 lds
  buffer_load_dwordx4 v1, s[16:19], s34 offen offset:2048 sc1 lds
  buffer_load_dwordx4 v1, s[16:19], s34 offen offset:3072 sc1 lds
  s_waitcnt vmcnt(18)
  s_barrier
  s_add_u32 m0, s42, 24576
  s_add_u32 s34, s40, 184320
  buffer_load_dwordx4 v1, s[16:19], s34 offen sc1 lds
  buffer_load_dwordx4 v1, s[16:19], s34 offen offset:1024 sc1 lds
  buffer_load_dwordx4 v1, s[16:19], s34 offen offset:2048 sc1 lds
  buffer_load_dwordx4 v1, s[16:19], s34 offen offset:3072 sc1 lds
  s_add_u32 m0, s42, 28672
  s_add_u32 s34, s40, 188416
  buffer_load_dwordx4 v1, s[16:19], s34 offen sc1 lds
  s_add_u32 m0, s43, 102400
  s_add_u32 s34, s41, 147456
  buffer_load_dwordx4 v1, s[16:19], s34 offen sc1 lds
  buffer_load_dwordx4 v1, s[16:19], s34 offen offset:1024 sc1 lds
  buffer_load_dwordx4 v1, s[16:19], s34 offen offset:2048 sc1 lds
  buffer_load_dwordx4 v1, s[16:19], s34 offen offset:3072 sc1 lds
  s_waitcnt vmcnt(18)
  s_barrier
  s_add_u32 m0, s42, 45056
  s_add_u32 s34, s40, 204800
  buffer_load_dwordx4 v1, s[16:19], s34 offen sc1 lds
  buffer_load_dwordx4 v1, s[16:19], s34 offen offset:1024 sc1 lds
  buffer_load_dwordx4 v1, s[16:19], s34 offen offset:2048 sc1 lds
  buffer_load_dwordx4 v1, s[16:19], s34 offen offset:3072 sc1 lds
  s_add_u32 m0, s42, 49152
  s_add_u32 s34, s40, 208896
  buffer_load_dwordx4 v1, s[16:19], s34 offen sc1 lds
  s_add_u32 m0, s43, 118784
  s_add_u32 s34, s41, 163840
  buffer_load_dwordx4 v1, s[16:19], s34 offen sc1 lds
  buffer_load_dwordx4 v1, s[16:19], s34 offen offset:1024 sc1 lds
  buffer_load_dwordx4 v1, s[16:19], s34 offen offset:2048 sc1 lds
  buffer_load_dwordx4 v1, s[16:19], s34 offen offset:3072 sc1 lds
  s_waitcnt vmcnt(18)
  s_barrier
  s_add_u32 m0, s42, 65536
  s_add_u32 s34, s40, 225280
  buffer_load_dwordx4 v1, s[16:19], s34 offen sc1 lds
  buffer_load_dwordx4 v1, s[16:19], s34 offen offset:1024 sc1 lds
  buffer_load_dwordx4 v1, s[16:19], s34 offen offset:2048 sc1 lds
  buffer_load_dwordx4 v1, s[16:19], s34 offen offset:3072 sc1 lds
  s_add_u32 m0, s42, 69632
  s_add_u32 s34, s40, 229376
  buffer_load_dwordx4 v1, s[16:19], s34 offen sc1 lds
  s_add_u32 m0, s43, 135168
  s_add_u32 s34, s41, 180224
  buffer_load_dwordx4 v1, s[16:19], s34 offen sc1 lds
  buffer_load_dwordx4 v1, s[16:19], s34 offen offset:1024 sc1 lds
  buffer_load_dwordx4 v1, s[16:19], s34 offen offset:2048 sc1 lds
  buffer_load_dwordx4 v1, s[16:19], s34 offen offset:3072 sc1 lds
  s_waitcnt vmcnt(18)
  s_barrier
  s_waitcnt vmcnt(9)
  s_barrier
  s_waitcnt vmcnt(0)
  s_barrier
  s_waitcnt lgkmcnt(0)
  s_barrier
  s_cmp_eq_u32 s30, 1
  s_cbranch_scc1 LM_done
  s_mul_i32 s42, s33, 2048
  s_mul_i32 s40, s49, 81920
  s_add_u32 s40, s40, 7340032
  s_add_u32 s40, s40, s42

  s_add_u32 m0, s42, 4096
  s_add_u32 s34, s40, 0
  buffer_load_dwordx4 v1, s[16:19], s34 offen sc1 lds
  buffer_load_dwordx4 v1, s[16:19], s34 offen offset:1024 sc1 lds
  s_add_u32 m0, s42, 12288
  s_add_u32 s34, s40, 8192
  buffer_load_dwordx4 v1, s[16:19], s34 offen sc1 lds
  buffer_load_dwordx4 v1, s[16:19], s34 offen offset:1024 sc1 lds
  s_add_u32 m0, s42, 20480
  s_add_u32 s34, s40, 16384
  buffer_load_dwordx4 v1, s[16:19], s34 offen sc1 lds
  buffer_load_dwordx4 v1, s[16:19], s34 offen offset:1024 sc1 lds
  s_add_u32 m0, s42, 28672
  s_add_u32 s34, s40, 24576
  buffer_load_dwordx4 v1, s[16:19], s34 offen sc1 lds
  buffer_load_dwordx4 v1, s[16:19], s34 offen offset:1024 sc1 lds
  s_add_u32 m0, s42, 36864
  s_add_u32 s34, s40, 32768
  buffer_load_dwordx4 v1, s[16:19], s34 offen sc1 lds
  buffer_load_dwordx4 v1, s[16:19], s34 offen offset:1024 sc1 lds
  s_add_u32 m0, s42, 45056
  s_add_u32 s34, s40, 40960
  buffer_load_dwordx4 v1, s[16:19], s34 offen sc1 lds
  buffer_load_dwordx4 v1, s[16:19], s34 offen offset:1024 sc1 lds
  s_lshl_b32 s43, s33, 13
  s_mov_b32 s24, s16
  s_mov_b32 s25, s17
  s_mov_b32 s26, s18
  s_lshl_b32 s35, s48, 1
  s_lshr_b32 s36, s33, 1
  s_add_u32 s35, s35, s36
  s_mul_i32 s41, s35, 163840
  s_and_b32 s36, s33, 1
  s_lshl_b32 s36, s36, 13
  s_add_u32 s41, s41, s36
  s_add_u32 s41, s41, 31981568
  s_movk_i32 s44, 16384
  s_movk_i32 s47, 4096
  s_mov_b32 s45, 34734080
  v_mov_b32 v12, v1
  v_mov_b32 v13, v1
  v_mov_b32 v14, v1
  v_mov_b32 v15, v1

  s_barrier
  s_cmp_lg_u32 s33, 0
  s_cbranch_scc1 Lnp_73
  s_lshl_b32 s34, s29, 2
  s_add_u32 s34, s34, s46
  s_add_u32 s34, s34, 32768
  v_mov_b32 v4, s34
  v_mov_b32 v5, s31
  s_mov_b64 exec, 1
  buffer_store_dword v5, v4, s[16:19], 0 offen offset:128
  buffer_store_dword v5, v4, s[16:19], 0 offen sc1
  s_mov_b64 exec, -1

  s_and_b32 s35, s28, 1
  s_lshl_b32 s35, s35, 9
  s_sub_u32 s34, s46, s35
  s_add_u32 s34, s34, 32768
  v_lshlrev_b32 v5, 9, v3
  v_lshl_add_u32 v5, v2, 2, v5
  v_add_u32 v48, s34, v5
  s_mov_b32 exec_lo, -1
  s_mov_b32 exec_hi, 0

Lpoll_75:
  buffer_load_dword v24, v48, s[16:19], 0 offen offset:128 sc1
  s_waitcnt vmcnt(0)
  v_cmp_ne_u32 vcc, s31, v24
  s_cmp_eq_u64 vcc, 0
  s_cbranch_scc1 Lpolled_74

  buffer_load_dword v24, v48, s[16:19], 0 offen offset:128 sc1
  s_waitcnt vmcnt(0)
  v_cmp_ne_u32 vcc, s31, v24
  s_cmp_eq_u64 vcc, 0
  s_cbranch_scc1 Lpolled_74

  buffer_load_dword v24, v48, s[16:19], 0 offen offset:128 sc1
  s_waitcnt vmcnt(0)
  v_cmp_ne_u32 vcc, s31, v24
  s_cmp_eq_u64 vcc, 0
  s_cbranch_scc1 Lpolled_74

  buffer_load_dword v24, v48, s[16:19], 0 offen sc1
  s_waitcnt vmcnt(0)
  v_cmp_ne_u32 vcc, s31, v24
  s_cmp_eq_u64 vcc, 0
  s_cbranch_scc0 Lpoll_75

Lpolled_74:
  s_mov_b64 exec, -1
Lnp_73:
  s_barrier
  s_mov_b32 s30, 1
  s_add_u32 s32, s32, 25165824
  s_add_u32 s46, s46, 40960

  s_mul_i32 s39, s44, 0
  s_add_u32 s39, s39, s41
  s_add_u32 m0, s43, 53248
  s_nop 0
  buffer_load_dwordx4 v12, s[24:27], s39 offen sc1 lds
  buffer_load_dwordx4 v13, s[24:27], s39 offen offset:1024 sc1 lds
  buffer_load_dwordx4 v14, s[24:27], s39 offen offset:2048 sc1 lds
  buffer_load_dwordx4 v15, s[24:27], s39 offen offset:3072 sc1 lds
  s_add_u32 m0, s43, 57344
  s_add_u32 s39, s39, s47
  buffer_load_dwordx4 v12, s[24:27], s39 offen sc1 lds
  buffer_load_dwordx4 v13, s[24:27], s39 offen offset:1024 sc1 lds
  buffer_load_dwordx4 v14, s[24:27], s39 offen offset:2048 sc1 lds
  buffer_load_dwordx4 v15, s[24:27], s39 offen offset:3072 sc1 lds
  s_mul_i32 s39, s44, 1
  s_add_u32 s39, s39, s41
  s_add_u32 m0, s43, 86016
  s_nop 0
  buffer_load_dwordx4 v12, s[24:27], s39 offen sc1 lds
  buffer_load_dwordx4 v13, s[24:27], s39 offen offset:1024 sc1 lds
  buffer_load_dwordx4 v14, s[24:27], s39 offen offset:2048 sc1 lds
  buffer_load_dwordx4 v15, s[24:27], s39 offen offset:3072 sc1 lds
  s_add_u32 m0, s43, 90112
  s_add_u32 s39, s39, s47
  buffer_load_dwordx4 v12, s[24:27], s39 offen sc1 lds
  buffer_load_dwordx4 v13, s[24:27], s39 offen offset:1024 sc1 lds
  buffer_load_dwordx4 v14, s[24:27], s39 offen offset:2048 sc1 lds
  buffer_load_dwordx4 v15, s[24:27], s39 offen offset:3072 sc1 lds
  s_waitcnt vmcnt(8)
  s_barrier
  s_mul_i32 s39, s44, 2
  s_add_u32 s39, s39, s41
  s_add_u32 m0, s43, 118784
  s_nop 0
  buffer_load_dwordx4 v12, s[24:27], s39 offen sc1 lds
  buffer_load_dwordx4 v13, s[24:27], s39 offen offset:1024 sc1 lds
  buffer_load_dwordx4 v14, s[24:27], s39 offen offset:2048 sc1 lds
  buffer_load_dwordx4 v15, s[24:27], s39 offen offset:3072 sc1 lds
  s_add_u32 m0, s43, 122880
  s_add_u32 s39, s39, s47
  buffer_load_dwordx4 v12, s[24:27], s39 offen sc1 lds
  buffer_load_dwordx4 v13, s[24:27], s39 offen offset:1024 sc1 lds
  buffer_load_dwordx4 v14, s[24:27], s39 offen offset:2048 sc1 lds
  buffer_load_dwordx4 v15, s[24:27], s39 offen offset:3072 sc1 lds
  v_lshlrev_b32 v4, 10, v3
  v_lshl_add_u32 v4, v2, 3, v4
  s_lshl_b32 s35, s48, 14
  s_add_u32 s35, s35, s45
  s_lshl_b32 s36, s33, 12
  s_add_u32 s35, s35, s36

  buffer_load_dwordx2 v[28:29], v4, s[16:19], s35 offen offset:0 sc1
  buffer_load_dwordx2 v[30:31], v4, s[16:19], s35 offen offset:128 sc1
  buffer_load_dwordx2 v[32:33], v4, s[16:19], s35 offen offset:256 sc1
  buffer_load_dwordx2 v[34:35], v4, s[16:19], s35 offen offset:384 sc1
  buffer_load_dwordx2 v[36:37], v4, s[16:19], s35 offen offset:512 sc1
  buffer_load_dwordx2 v[38:39], v4, s[16:19], s35 offen offset:640 sc1
  buffer_load_dwordx2 v[40:41], v4, s[16:19], s35 offen offset:768 sc1
  buffer_load_dwordx2 v[42:43], v4, s[16:19], s35 offen offset:896 sc1
  s_waitcnt vmcnt(16)
  s_barrier
  s_add_u32 m0, s42, 4096
  s_add_u32 s34, s40, 49152
  buffer_load_dwordx4 v1, s[16:19], s34 offen sc1 lds
  buffer_load_dwordx4 v1, s[16:19], s34 offen offset:1024 sc1 lds
  s_mul_i32 s39, s44, 3
  s_add_u32 s39, s39, s41
  s_add_u32 m0, s43, 53248
  s_nop 0
  buffer_load_dwordx4 v12, s[24:27], s39 offen sc1 lds
  buffer_load_dwordx4 v13, s[24:27], s39 offen offset:1024 sc1 lds
  buffer_load_dwordx4 v14, s[24:27], s39 offen offset:2048 sc1 lds
  buffer_load_dwordx4 v15, s[24:27], s39 offen offset:3072 sc1 lds
  s_add_u32 m0, s43, 57344
  s_add_u32 s39, s39, s47
  buffer_load_dwordx4 v12, s[24:27], s39 offen sc1 lds
  buffer_load_dwordx4 v13, s[24:27], s39 offen offset:1024 sc1 lds
  buffer_load_dwordx4 v14, s[24:27], s39 offen offset:2048 sc1 lds
  buffer_load_dwordx4 v15, s[24:27], s39 offen offset:3072 sc1 lds
  s_waitcnt vmcnt(18)
  s_barrier
  s_add_u32 m0, s42, 12288
  s_add_u32 s34, s40, 57344
  buffer_load_dwordx4 v1, s[16:19], s34 offen sc1 lds
  buffer_load_dwordx4 v1, s[16:19], s34 offen offset:1024 sc1 lds
  s_mul_i32 s39, s44, 4
  s_add_u32 s39, s39, s41
  s_add_u32 m0, s43, 86016
  s_nop 0
  buffer_load_dwordx4 v12, s[24:27], s39 offen sc1 lds
  buffer_load_dwordx4 v13, s[24:27], s39 offen offset:1024 sc1 lds
  buffer_load_dwordx4 v14, s[24:27], s39 offen offset:2048 sc1 lds
  buffer_load_dwordx4 v15, s[24:27], s39 offen offset:3072 sc1 lds
  s_add_u32 m0, s43, 90112
  s_add_u32 s39, s39, s47
  buffer_load_dwordx4 v12, s[24:27], s39 offen sc1 lds
  buffer_load_dwordx4 v13, s[24:27], s39 offen offset:1024 sc1 lds
  buffer_load_dwordx4 v14, s[24:27], s39 offen offset:2048 sc1 lds
  buffer_load_dwordx4 v15, s[24:27], s39 offen offset:3072 sc1 lds
  s_waitcnt vmcnt(10)
  s_barrier
  s_add_u32 m0, s42, 20480
  s_add_u32 s34, s40, 65536
  buffer_load_dwordx4 v1, s[16:19], s34 offen sc1 lds
  buffer_load_dwordx4 v1, s[16:19], s34 offen offset:1024 sc1 lds
  s_mul_i32 s39, s44, 5
  s_add_u32 s39, s39, s41
  s_add_u32 m0, s43, 118784
  s_nop 0
  buffer_load_dwordx4 v12, s[24:27], s39 offen sc1 lds
  buffer_load_dwordx4 v13, s[24:27], s39 offen offset:1024 sc1 lds
  buffer_load_dwordx4 v14, s[24:27], s39 offen offset:2048 sc1 lds
  buffer_load_dwordx4 v15, s[24:27], s39 offen offset:3072 sc1 lds
  s_add_u32 m0, s43, 122880
  s_add_u32 s39, s39, s47
  buffer_load_dwordx4 v12, s[24:27], s39 offen sc1 lds
  buffer_load_dwordx4 v13, s[24:27], s39 offen offset:1024 sc1 lds
  buffer_load_dwordx4 v14, s[24:27], s39 offen offset:2048 sc1 lds
  buffer_load_dwordx4 v15, s[24:27], s39 offen offset:3072 sc1 lds
  v_add_f32 v16, v28, v30
  v_add_f32 v17, v29, v31
  v_add_f32 v16, v16, v32
  v_add_f32 v17, v17, v33
  v_add_f32 v16, v16, v34
  v_add_f32 v17, v17, v35
  v_add_f32 v16, v16, v36
  v_add_f32 v17, v17, v37
  v_add_f32 v16, v16, v38
  v_add_f32 v17, v17, v39
  v_add_f32 v16, v16, v40
  v_add_f32 v17, v17, v41
  v_add_f32 v16, v16, v42
  v_add_f32 v17, v17, v43
  s_mov_b32 s61, 0x3acccccd
  s_mov_b32 s62, 0x3727c5ac
  v_mul_f32 v16, s61, v16
  v_mul_f32 v17, s61, v17
  v_fma_f32 v17, -v16, v16, v17
  v_max_f32 v17, 0, v17

  v_cvt_pk_bf16_f32 v4, v16, v16
  v_lshlrev_b32 v16, 16, v4
  v_cvt_pk_bf16_f32 v4, v17, v17
  v_lshlrev_b32 v17, 16, v4
  v_add_f32 v17, s62, v17
  v_cvt_pk_bf16_f32 v4, v17, v17
  v_lshlrev_b32 v17, 16, v4
  v_sqrt_f32 v17, v17
  s_nop 0
  v_cvt_pk_bf16_f32 v4, v17, v17
  v_lshlrev_b32 v17, 16, v4
  v_rcp_f32 v17, v17
  v_lshlrev_b32 v4, 2, v0
  s_lshl_b32 s35, s33, 8
  v_add_u32 v4, s35, v4

  ds_write_b32 v4, v16 offset:0
  ds_write_b32 v4, v17 offset:1024
  s_mov_b64 exec, -1

  s_waitcnt vmcnt(10)
  s_barrier
  s_add_u32 m0, s42, 28672
  s_add_u32 s34, s40, 73728
  buffer_load_dwordx4 v1, s[16:19], s34 offen sc1 lds
  buffer_load_dwordx4 v1, s[16:19], s34 offen offset:1024 sc1 lds
  s_mul_i32 s39, s44, 6
  s_add_u32 s39, s39, s41
  s_add_u32 m0, s43, 53248
  s_nop 0
  buffer_load_dwordx4 v12, s[24:27], s39 offen sc1 lds
  buffer_load_dwordx4 v13, s[24:27], s39 offen offset:1024 sc1 lds
  buffer_load_dwordx4 v14, s[24:27], s39 offen offset:2048 sc1 lds
  buffer_load_dwordx4 v15, s[24:27], s39 offen offset:3072 sc1 lds
  s_add_u32 m0, s43, 57344
  s_add_u32 s39, s39, s47
  buffer_load_dwordx4 v12, s[24:27], s39 offen sc1 lds
  buffer_load_dwordx4 v13, s[24:27], s39 offen offset:1024 sc1 lds
  buffer_load_dwordx4 v14, s[24:27], s39 offen offset:2048 sc1 lds
  buffer_load_dwordx4 v15, s[24:27], s39 offen offset:3072 sc1 lds
  s_waitcnt vmcnt(10)
  s_barrier
  s_mul_i32 s39, s44, 7
  s_add_u32 s39, s39, s41
  s_add_u32 m0, s43, 86016
  s_nop 0
  buffer_load_dwordx4 v12, s[24:27], s39 offen sc1 lds
  buffer_load_dwordx4 v13, s[24:27], s39 offen offset:1024 sc1 lds
  buffer_load_dwordx4 v14, s[24:27], s39 offen offset:2048 sc1 lds
  buffer_load_dwordx4 v15, s[24:27], s39 offen offset:3072 sc1 lds
  s_add_u32 m0, s43, 90112
  s_add_u32 s39, s39, s47
  buffer_load_dwordx4 v12, s[24:27], s39 offen sc1 lds
  buffer_load_dwordx4 v13, s[24:27], s39 offen offset:1024 sc1 lds
  buffer_load_dwordx4 v14, s[24:27], s39 offen offset:2048 sc1 lds
  buffer_load_dwordx4 v15, s[24:27], s39 offen offset:3072 sc1 lds
  s_waitcnt vmcnt(8)
  s_barrier
  s_mul_i32 s39, s44, 8
  s_add_u32 s39, s39, s41
  s_add_u32 m0, s43, 118784
  s_nop 0
  buffer_load_dwordx4 v12, s[24:27], s39 offen sc1 lds
  buffer_load_dwordx4 v13, s[24:27], s39 offen offset:1024 sc1 lds
  buffer_load_dwordx4 v14, s[24:27], s39 offen offset:2048 sc1 lds
  buffer_load_dwordx4 v15, s[24:27], s39 offen offset:3072 sc1 lds
  s_add_u32 m0, s43, 122880
  s_add_u32 s39, s39, s47
  buffer_load_dwordx4 v12, s[24:27], s39 offen sc1 lds
  buffer_load_dwordx4 v13, s[24:27], s39 offen offset:1024 sc1 lds
  buffer_load_dwordx4 v14, s[24:27], s39 offen offset:2048 sc1 lds
  buffer_load_dwordx4 v15, s[24:27], s39 offen offset:3072 sc1 lds
  s_waitcnt vmcnt(8)
  s_barrier
  s_mul_i32 s39, s44, 9
  s_add_u32 s39, s39, s41
  s_add_u32 m0, s43, 53248
  s_nop 0
  buffer_load_dwordx4 v12, s[24:27], s39 offen sc1 lds
  buffer_load_dwordx4 v13, s[24:27], s39 offen offset:1024 sc1 lds
  buffer_load_dwordx4 v14, s[24:27], s39 offen offset:2048 sc1 lds
  buffer_load_dwordx4 v15, s[24:27], s39 offen offset:3072 sc1 lds
  s_add_u32 m0, s43, 57344
  s_add_u32 s39, s39, s47
  buffer_load_dwordx4 v12, s[24:27], s39 offen sc1 lds
  buffer_load_dwordx4 v13, s[24:27], s39 offen offset:1024 sc1 lds
  buffer_load_dwordx4 v14, s[24:27], s39 offen offset:2048 sc1 lds
  buffer_load_dwordx4 v15, s[24:27], s39 offen offset:3072 sc1 lds
  s_waitcnt vmcnt(8)
  s_barrier
  s_waitcnt vmcnt(0)
  s_barrier
  s_waitcnt lgkmcnt(0)
  s_barrier
  s_branch LL_afterP1
LM_done:
  LM_exit:
  s_endpgm
.section .rodata,"a"
.p2align 6
.amdhsa_kernel prep_kernel
  .amdhsa_next_free_vgpr 56
  .amdhsa_next_free_sgpr 102
  .amdhsa_accum_offset 56
  .amdhsa_group_segment_fixed_size 0
  .amdhsa_kernarg_size 80
  .amdhsa_user_sgpr_count 2
  .amdhsa_user_sgpr_kernarg_segment_ptr 1
  .amdhsa_system_sgpr_workgroup_id_x 1
.end_amdhsa_kernel
.p2align 6
.amdhsa_kernel main_kernel
  .amdhsa_next_free_vgpr 256
  .amdhsa_next_free_sgpr 102
  .amdhsa_accum_offset 256
  .amdhsa_group_segment_fixed_size 0
  .amdhsa_kernarg_size 80
  .amdhsa_user_sgpr_count 2
  .amdhsa_user_sgpr_kernarg_segment_ptr 1
  .amdhsa_system_sgpr_workgroup_id_x 1
.end_amdhsa_kernel
```
